```python
import torch

def _softmax(x, axis=-1):
    return torch.softmax(x, dim=axis)

def _gelu(x):
    return torch.nn.functional.gelu(x, approximate='tanh')

def _silu(x):
    return torch.nn.functional.silu(x)

def _sigmoid(x):
    return torch.sigmoid(x)

def _layernorm(x, axis=-1, eps=1e-05):
    m = x.mean(dim=axis, keepdim=True)
    v = x.var(dim=axis, keepdim=True, unbiased=False)
    return (x - m) / torch.sqrt(v + eps)

def _scatter_add(tgt, idx, src, axis=0):
    return tgt.clone().index_add_(axis, idx, src)

def _segment_sum(src, seg, n):
    out = torch.zeros((n,) + src.shape[1:], dtype=src.dtype)
    return out.index_add_(0, seg, src)

def _pad(x, pw):
    flat = tuple((v for pair in reversed(pw) for v in pair))
    return torch.nn.functional.pad(x, flat)
kernel_name = 'concat_heads__linear_kernel_hedgehog__memory_aug_recurrent_mem_tr__prompt'

def setup_inputs():

    _w = lambda a: (lambda t: t.to(torch.bfloat16) if t.is_floating_point() else t)(torch.as_tensor(a))

    def _A_setup():
        B, S, D, H = (1, 2048, 448, 16)
        Dh = D // H
        return {'x': _w((lambda *s: torch.randn(*s, dtype=torch.bfloat16) * 0.4)(B, S, D)), 'wqkv': _w((lambda *s: torch.randn(*s, dtype=torch.bfloat16) * 0.4)(D, 3 * D)), 'w_phi': _w((lambda *s: torch.randn(*s, dtype=torch.bfloat16) * 0.4)(H, Dh, Dh) * Dh ** (-0.5)), 'wo': _w((lambda *s: torch.randn(*s, dtype=torch.bfloat16) * 0.05)(D, D))}
    _A_in = _A_setup()

    def _B_setup():
        B, S, Dm = (1, 2048, 448)
        H, Dh = (16, 256)
        M, seg = (8, 32)
        seg = min(seg, S)
        S = S // seg * seg
        return {'x': _w((lambda *s: torch.randn(*s, dtype=torch.bfloat16) * 0.05)(B, S, Dm)), 'mem0': _w((lambda *s: torch.randn(*s, dtype=torch.bfloat16) * 0.8)(B, M, Dm)), 'Wq': _w((lambda *s: torch.randn(*s, dtype=torch.bfloat16) * 1.6)(Dm, H, Dh) * Dm ** (-0.5)), 'Wk': _w((lambda *s: torch.randn(*s, dtype=torch.bfloat16) * 1.6)(Dm, H, Dh) * Dm ** (-0.5)), 'Wv': _w((lambda *s: torch.randn(*s, dtype=torch.bfloat16) * 0.8)(Dm, H, Dh) * Dm ** (-0.5)), 'Wo': _w((lambda *s: torch.randn(*s, dtype=torch.bfloat16) * 0.8)(H, Dh, Dm) * (H * Dh) ** (-0.5)), 'seg_len': seg}
    _B_in = _B_setup()
    return {'A_x': _A_in['x'], 'A_wqkv': _A_in['wqkv'], 'A_w_phi': _A_in['w_phi'], 'A_wo': _A_in['wo'], 'B_x': _B_in['x'], 'B_mem0': _B_in['mem0'], 'B_Wq': _B_in['Wq'], 'B_Wk': _B_in['Wk'], 'B_Wv': _B_in['Wv'], 'B_Wo': _B_in['Wo'], 'B_seg_len': _B_in['seg_len']}

def reference(A_x, A_wqkv, A_w_phi, A_wo, B_x, B_mem0, B_Wq, B_Wk, B_Wv, B_Wo, B_seg_len):

    def _A_ref(x, wqkv, w_phi, wo):
        B, S, D = x.shape
        H = 16
        Dh = D // H
        qkv = (lambda x, *d: x.permute(*d))((x @ wqkv).reshape(B, S, 3, H, Dh), 2, 0, 3, 1, 4)
        q, k, v = (qkv[0], qkv[1], qkv[2])
        pq = torch.einsum('bhsd,hdf->bhsf', q, w_phi)
        pk = torch.einsum('bhsd,hdf->bhsf', k, w_phi)
        phi_q = torch.concatenate([_softmax(pq, axis=-1), _softmax(-pq, axis=-1)], axis=-1)
        phi_k = torch.concatenate([_softmax(pk, axis=-1), _softmax(-pk, axis=-1)], axis=-1)
        kv = torch.einsum('bhsf,bhsd->bhfd', phi_k, v)
        z = torch.einsum('bhsf->bhf', phi_k)
        num = torch.einsum('bhqf,bhfd->bhqd', phi_q, kv)
        den = torch.einsum('bhqf,bhf->bhq', phi_q, z)[..., None] + 1e-06
        o = num / den
        return (lambda x, *d: x.permute(*d))(o, 0, 2, 1, 3).reshape(B, S, D) @ wo

    def _B_ref(x, mem0, Wq, Wk, Wv, Wo, seg_len):
        B, S, Dm = x.shape
        H, Dh = (Wq.shape[1], Wq.shape[2])
        M = mem0.shape[1]
        scale = Dh ** (-0.5)
        n_seg = S // seg_len
        L = M + seg_len
        idx = torch.arange(L)
        mask = (idx[:, None] < M) | (idx[:, None] >= idx[None, :])
        mem = mem0
        outs = []
        for s in range(n_seg):
            xs = x[:, s * seg_len:(s + 1) * seg_len, :].clone()
            h = torch.concatenate([mem, xs], axis=1)
            q = torch.einsum('btd,dhe->bhte', h, Wq)
            k = torch.einsum('btd,dhe->bhte', h, Wk)
            v = torch.einsum('btd,dhe->bhte', h, Wv)
            scores = torch.einsum('bhqe,bhke->bhqk', q, k) * scale
            scores = torch.where(mask[None, None], scores, -1000000000.0)
            p = _softmax(scores, axis=-1)
            o = torch.einsum('bhqk,bhke->bhqe', p, v)
            o = torch.einsum('bhte,hed->btd', o, Wo)
            mem = o[:, :M, :].clone()
            outs.append(o[:, M:, :])
        return torch.concatenate(outs, axis=1)
    a = _A_ref(A_x, A_wqkv, A_w_phi, A_wo)
    b = _B_ref(B_x, B_mem0, B_Wq, B_Wk, B_Wv, B_Wo, B_seg_len)
    return torch.concatenate([a, b], axis=-1)
```

```asm
; @launch grid=(256,1,1) block=(256,1,1) lds=139264
.amdgcn_target "amdgcn-amd-amdhsa--gfx950"
.text

.globl concat_heads__linear_kernel_hedgehog__memory_aug_recurrent_mem_tr__prompt_kernel
.p2align 8
.type concat_heads__linear_kernel_hedgehog__memory_aug_recurrent_mem_tr__prompt_kernel,@function
concat_heads__linear_kernel_hedgehog__memory_aug_recurrent_mem_tr__prompt_kernel:

    s_cmp_ge_u32 s2, 256
    s_cbranch_scc1 M_end
    s_load_dwordx8 s[16:23], s[0:1], 48
    s_load_dwordx2 s[4:5], s[0:1], 104
    s_load_dwordx2 s[6:7], s[0:1], 96
    s_load_dwordx2 s[8:9], s[0:1], 32
    s_load_dwordx2 s[10:11], s[0:1], 88
    s_load_dwordx2 s[12:13], s[0:1], 0
    s_load_dwordx2 s[24:25], s[0:1], 40
    v_and_b32 v1, 63, v0
    v_lshrrev_b32 v2, 6, v0
    s_mov_b32 s15, 0x400000

    v_readfirstlane_b32 s3, v2
    s_waitcnt lgkmcnt(0)

    s_cmp_lg_u32 s2, 248
    s_cbranch_scc1 Q_nm0
    v_lshlrev_b32 v6, 4, v0
    v_add_u32 v7, 4096, v6
    v_min_u32 v7, 7152, v7
    global_load_dwordx4 a[0:3], v6, s[24:25]
    global_load_dwordx4 a[4:7], v7, s[24:25]
Q_nm0:
    s_and_b32 s26, s2, 7
    s_lshr_b32 s27, s2, 3
    s_cmp_lg_u32 s3, 0
    s_cbranch_scc1 Q_nmb
    s_lshl_b32 s28, s2, 8
    s_add_u32 s28, s28, 0x37c0000
    v_mov_b32 v6, s28
    v_mov_b32 v7, 0
    s_mov_b64 exec, 1
    global_store_dword v6, v7, s[4:5] sc1
    s_cmp_lg_u32 s26, 0
    s_cbranch_scc1 Q_nxc
    s_cmp_ge_u32 s27, 30
    s_cbranch_scc1 Q_nxc
    s_getreg_b32 s28, hwreg(HW_REG_XCC_ID)
    s_and_b32 s28, s28, 15
    s_add_u32 s28, s28, 1
    s_lshl_b32 s29, s27, 2
    s_add_u32 s29, s29, 64
    v_mov_b32 v6, s29
    v_mov_b32 v7, s28
    global_store_dword v6, v7, s[6:7] sc1
Q_nxc:
    s_mov_b64 exec, -1
Q_nmb:
    v_and_b32 v3, 15, v1
    v_lshrrev_b32 v4, 4, v1
    v_lshrrev_b32 v5, 5, v1
    v_and_b32 v6, 31, v1
    v_min_u32 v13, 55, v1
    v_mul_u32_u24 v14, 4682, v13
    v_lshrrev_b32 v14, 16, v14
    v_mul_u32_u24 v2, 14, v14
    v_sub_u32 v13, v13, v2
    s_cmp_eq_u32 s26, 0
    s_cbranch_scc1 Q_c0
    s_sub_u32 s28, s26, 1
    s_lshl_b32 s28, s28, 5
    s_add_u32 s28, s28, s27
    s_mul_i32 s29, s28, 4682
    s_lshr_b32 s29, s29, 16
    s_mul_i32 s30, s29, 14
    s_sub_u32 s30, s28, s30
    s_and_b32 s31, s30, 1
    s_lshr_b32 s30, s30, 1
    s_mul_i32 s32, s31, 7
    s_lshl_b32 s33, s3, 1
    s_add_u32 s32, s32, s33
    s_lshl_b32 s36, s29, 9
    s_lshl_b32 s37, s30, 6
    s_lshl_b32 s38, s3, 4
    s_add_u32 s37, s37, s38
    v_add_u32 v8, s37, v5
    v_lshlrev_b32 v8, 13, v8
    v_lshl_add_u32 v8, v6, 4, v8
    v_add_u32 v8, s36, v8

    global_load_dwordx4 v[144:147], v8, s[18:19]
    v_add_u32 v8, 16384, v8
    global_load_dwordx4 v[148:151], v8, s[18:19]
    v_add_u32 v8, 16384, v8
    global_load_dwordx4 v[152:155], v8, s[18:19]
    v_add_u32 v8, 16384, v8
    global_load_dwordx4 v[156:159], v8, s[18:19]
    v_add_u32 v8, 16384, v8
    global_load_dwordx4 v[160:163], v8, s[18:19]
    v_add_u32 v8, 16384, v8
    global_load_dwordx4 v[164:167], v8, s[18:19]
    v_add_u32 v8, 16384, v8
    global_load_dwordx4 v[168:171], v8, s[18:19]
    v_add_u32 v8, 16384, v8
    global_load_dwordx4 v[172:175], v8, s[18:19]

    v_add_u32 v12, s38, v5
    v_mul_u32_u24 v12, 528, v12
    v_lshl_add_u32 v12, v6, 4, v12
    s_lshl_b32 s37, s32, 5
    v_add_u32 v7, s37, v5
    v_lshlrev_b32 v7, 13, v7
    v_lshl_add_u32 v7, v6, 4, v7
    v_add_u32 v7, s36, v7
    s_mul_i32 s37, s3, 8448
    s_add_u32 s37, s37, 33792
    v_mul_u32_u24 v9, 528, v5
    v_lshl_add_u32 v9, v6, 4, v9
    v_add_u32 v9, s37, v9
    v_mul_u32_u24 v11, 528, v3
    v_lshl_add_u32 v11, v4, 4, v11
    v_add_u32 v10, s37, v11
    s_mul_i32 s37, s29, 229376
    s_lshl_b32 s38, s30, 7
    s_add_u32 s37, s37, s38
    s_lshl_b32 s38, s3, 6
    v_lshrrev_b32 v15, 3, v1
    v_add_u32 v15, s38, v15
    v_and_b32 v8, 7, v1
    v_mul_u32_u24 v2, 896, v15
    v_lshl_add_u32 v2, v8, 4, v2
    v_add_u32 v2, s37, v2
    v_mul_u32_u24 v15, 240, v15
    v_lshl_add_u32 v15, v8, 4, v15
    v_add_u32 v15, 67584, v15
    s_cmp_eq_u32 s3, 3
    s_cbranch_scc1 Q_v1

Q_v0:
    v_add_u32 v8, 0, v7
    global_load_dwordx4 v[16:19], v8, s[16:17]
    v_add_u32 v8, 16384, v7
    global_load_dwordx4 v[20:23], v8, s[16:17]
    v_add_u32 v8, 65536, v7
    global_load_dwordx4 v[24:27], v8, s[16:17]
    v_add_u32 v8, 81920, v7
    global_load_dwordx4 v[28:31], v8, s[16:17]
    v_add_u32 v8, 131072, v7
    global_load_dwordx4 v[32:35], v8, s[16:17]
    v_add_u32 v8, 147456, v7
    global_load_dwordx4 v[36:39], v8, s[16:17]
    v_add_u32 v8, 196608, v7
    global_load_dwordx4 v[40:43], v8, s[16:17]
    v_add_u32 v8, 212992, v7
    global_load_dwordx4 v[44:47], v8, s[16:17]
    v_add_u32 v8, 32768, v7
    global_load_dwordx4 v[48:51], v8, s[16:17]
    v_add_u32 v8, 49152, v7
    global_load_dwordx4 v[52:55], v8, s[16:17]
    v_add_u32 v8, 98304, v7
    global_load_dwordx4 v[56:59], v8, s[16:17]
    v_add_u32 v8, 114688, v7
    global_load_dwordx4 v[60:63], v8, s[16:17]
    v_add_u32 v8, 163840, v7
    global_load_dwordx4 v[64:67], v8, s[16:17]
    v_add_u32 v8, 180224, v7
    global_load_dwordx4 v[68:71], v8, s[16:17]
    v_add_u32 v8, 229376, v7
    global_load_dwordx4 v[72:75], v8, s[16:17]
    v_add_u32 v8, 245760, v7
    global_load_dwordx4 v[76:79], v8, s[16:17]
    v_add_u32 v8, 262144, v7
    global_load_dwordx4 v[80:83], v8, s[16:17]
    v_add_u32 v8, 278528, v7
    global_load_dwordx4 v[84:87], v8, s[16:17]
    v_add_u32 v8, 327680, v7
    global_load_dwordx4 v[88:91], v8, s[16:17]
    v_add_u32 v8, 344064, v7
    global_load_dwordx4 v[92:95], v8, s[16:17]
    v_add_u32 v8, 393216, v7
    global_load_dwordx4 v[96:99], v8, s[16:17]
    v_add_u32 v8, 409600, v7
    global_load_dwordx4 v[100:103], v8, s[16:17]
    v_add_u32 v8, 458752, v7
    global_load_dwordx4 v[104:107], v8, s[16:17]
    v_add_u32 v8, 475136, v7
    global_load_dwordx4 v[108:111], v8, s[16:17]
    v_add_u32 v8, 294912, v7
    global_load_dwordx4 v[112:115], v8, s[16:17]
    v_add_u32 v8, 311296, v7
    global_load_dwordx4 v[116:119], v8, s[16:17]
    v_add_u32 v8, 360448, v7
    global_load_dwordx4 v[120:123], v8, s[16:17]
    v_add_u32 v8, 376832, v7
    global_load_dwordx4 v[124:127], v8, s[16:17]
    v_add_u32 v8, 425984, v7
    global_load_dwordx4 v[128:131], v8, s[16:17]
    v_add_u32 v8, 442368, v7
    global_load_dwordx4 v[132:135], v8, s[16:17]
    v_add_u32 v8, 491520, v7
    global_load_dwordx4 v[136:139], v8, s[16:17]
    v_add_u32 v8, 507904, v7
    global_load_dwordx4 v[140:143], v8, s[16:17]

    v_mov_b32 v240, -1
    v_mov_b32 v241, -1
    v_mov_b32 v242, -1
    v_mov_b32 v243, -1
    v_mov_b32 v244, 0
    v_mov_b32 v245, 0
    v_mov_b32 v246, 0
    v_mov_b32 v247, 0
    s_add_u32 s44, s4, 0xe84000
    s_addc_u32 s45, s5, 0
    s_and_b32 s45, s45, 0xffff
    s_mov_b32 s46, 2113536
    s_mov_b32 s47, 0x00020000
    s_add_u32 s48, s4, 0x1100000
    s_addc_u32 s49, s5, 0
    s_and_b32 s49, s49, 0xffff
    s_mov_b32 s50, 147456
    s_mov_b32 s51, 0x00020000
    s_add_u32 s52, s4, 0x1200000
    s_addc_u32 s53, s5, 0
    s_and_b32 s53, s53, 0xffff
    s_mov_b32 s54, 2621440
    s_mov_b32 s55, 0x00020000
    s_lshl_b32 s37, s2, 12
    v_lshl_add_u32 v248, v0, 4, s37
    v_add_u32 v249, 0x100000, v248
    v_add_u32 v250, 0x200000, v248

    buffer_store_dwordx4 v[244:247], v248, s[48:51], 0 offen sc1
    buffer_store_dwordx4 v[240:243], v248, s[44:47], 0 offen sc1
    buffer_store_dwordx4 v[240:243], v249, s[44:47], 0 offen sc1
    buffer_store_dwordx4 v[240:243], v250, s[44:47], 0 offen sc1
    buffer_store_dwordx4 v[240:243], v248, s[52:55], 0 offen sc1
    buffer_store_dwordx4 v[240:243], v249, s[52:55], 0 offen sc1
    buffer_store_dwordx4 v[240:243], v250, s[52:55], 0 offen sc1
    s_waitcnt vmcnt(46)
    ds_write_b128 v12, v[144:147] offset:0
    s_waitcnt vmcnt(45)
    ds_write_b128 v12, v[148:151] offset:1056
    s_waitcnt vmcnt(44)
    ds_write_b128 v12, v[152:155] offset:2112
    s_waitcnt vmcnt(43)
    ds_write_b128 v12, v[156:159] offset:3168
    s_waitcnt vmcnt(42)
    ds_write_b128 v12, v[160:163] offset:4224
    s_waitcnt vmcnt(41)
    ds_write_b128 v12, v[164:167] offset:5280
    s_waitcnt vmcnt(40)
    ds_write_b128 v12, v[168:171] offset:6336
    s_waitcnt vmcnt(39)
    ds_write_b128 v12, v[172:175] offset:7392
    s_waitcnt vmcnt(38)
    ds_write_b128 v9, v[16:19] offset:0
    s_waitcnt vmcnt(37)
    ds_write_b128 v9, v[20:23] offset:1056
    s_waitcnt vmcnt(36)
    ds_write_b128 v9, v[24:27] offset:2112
    s_waitcnt vmcnt(35)
    ds_write_b128 v9, v[28:31] offset:3168
    s_waitcnt vmcnt(34)
    ds_write_b128 v9, v[32:35] offset:4224
    s_waitcnt vmcnt(33)
    ds_write_b128 v9, v[36:39] offset:5280
    s_waitcnt vmcnt(32)
    ds_write_b128 v9, v[40:43] offset:6336
    s_waitcnt vmcnt(31)
    ds_write_b128 v9, v[44:47] offset:7392
    ds_read_b128 v[16:19], v10 offset:0
    ds_read_b128 v[20:23], v10 offset:64
    ds_read_b128 v[24:27], v10 offset:128
    ds_read_b128 v[28:31], v10 offset:192
    ds_read_b128 v[32:35], v10 offset:256
    ds_read_b128 v[36:39], v10 offset:320
    ds_read_b128 v[40:43], v10 offset:384
    ds_read_b128 v[44:47], v10 offset:448
    s_waitcnt vmcnt(30)
    ds_write_b128 v9, v[48:51] offset:0
    s_waitcnt vmcnt(29)
    ds_write_b128 v9, v[52:55] offset:1056
    s_waitcnt vmcnt(28)
    ds_write_b128 v9, v[56:59] offset:2112
    s_waitcnt vmcnt(27)
    ds_write_b128 v9, v[60:63] offset:3168
    s_waitcnt vmcnt(26)
    ds_write_b128 v9, v[64:67] offset:4224
    s_waitcnt vmcnt(25)
    ds_write_b128 v9, v[68:71] offset:5280
    s_waitcnt vmcnt(24)
    ds_write_b128 v9, v[72:75] offset:6336
    s_waitcnt vmcnt(23)
    ds_write_b128 v9, v[76:79] offset:7392
    ds_read_b128 v[48:51], v10 offset:0
    ds_read_b128 v[52:55], v10 offset:64
    ds_read_b128 v[56:59], v10 offset:128
    ds_read_b128 v[60:63], v10 offset:192
    ds_read_b128 v[64:67], v10 offset:256
    ds_read_b128 v[68:71], v10 offset:320
    ds_read_b128 v[72:75], v10 offset:384
    ds_read_b128 v[76:79], v10 offset:448
    s_waitcnt vmcnt(22)
    ds_write_b128 v9, v[80:83] offset:0
    s_waitcnt vmcnt(21)
    ds_write_b128 v9, v[84:87] offset:1056
    s_waitcnt vmcnt(20)
    ds_write_b128 v9, v[88:91] offset:2112
    s_waitcnt vmcnt(19)
    ds_write_b128 v9, v[92:95] offset:3168
    s_waitcnt vmcnt(18)
    ds_write_b128 v9, v[96:99] offset:4224
    s_waitcnt vmcnt(17)
    ds_write_b128 v9, v[100:103] offset:5280
    s_waitcnt vmcnt(16)
    ds_write_b128 v9, v[104:107] offset:6336
    s_waitcnt vmcnt(15)
    ds_write_b128 v9, v[108:111] offset:7392
    ds_read_b128 v[80:83], v10 offset:0
    ds_read_b128 v[84:87], v10 offset:64
    ds_read_b128 v[88:91], v10 offset:128
    ds_read_b128 v[92:95], v10 offset:192
    ds_read_b128 v[96:99], v10 offset:256
    ds_read_b128 v[100:103], v10 offset:320
    ds_read_b128 v[104:107], v10 offset:384
    ds_read_b128 v[108:111], v10 offset:448
    s_waitcnt vmcnt(14)
    ds_write_b128 v9, v[112:115] offset:0
    s_waitcnt vmcnt(13)
    ds_write_b128 v9, v[116:119] offset:1056
    s_waitcnt vmcnt(12)
    ds_write_b128 v9, v[120:123] offset:2112
    s_waitcnt vmcnt(11)
    ds_write_b128 v9, v[124:127] offset:3168
    s_waitcnt vmcnt(10)
    ds_write_b128 v9, v[128:131] offset:4224
    s_waitcnt vmcnt(9)
    ds_write_b128 v9, v[132:135] offset:5280
    s_waitcnt vmcnt(8)
    ds_write_b128 v9, v[136:139] offset:6336
    s_waitcnt vmcnt(7)
    ds_write_b128 v9, v[140:143] offset:7392
    ds_read_b128 v[112:115], v10 offset:0
    ds_read_b128 v[116:119], v10 offset:64
    ds_read_b128 v[120:123], v10 offset:128
    ds_read_b128 v[124:127], v10 offset:192
    ds_read_b128 v[128:131], v10 offset:256
    ds_read_b128 v[132:135], v10 offset:320
    ds_read_b128 v[136:139], v10 offset:384
    ds_read_b128 v[140:143], v10 offset:448

    s_mul_i32 s37, s29, 392
    s_mul_i32 s38, s30, 56
    s_add_u32 s37, s37, s38
    s_add_u32 s37, s37, s32
    s_lshl_b32 s37, s37, 10
    v_lshl_add_u32 v8, v1, 4, s37
    s_mov_b32 s38, 0x3db8aa3b
    s_waitcnt lgkmcnt(0)
    s_barrier

    ds_read_b128 v[144:147], v11 offset:0
    ds_read_b128 v[148:151], v11 offset:64
    ds_read_b128 v[152:155], v11 offset:128
    ds_read_b128 v[156:159], v11 offset:192
    ds_read_b128 v[160:163], v11 offset:256
    ds_read_b128 v[164:167], v11 offset:320
    ds_read_b128 v[168:171], v11 offset:384
    ds_read_b128 v[172:175], v11 offset:448
    s_waitcnt lgkmcnt(7)
    v_mfma_f32_16x16x32_bf16 v[208:211], v[16:19], v[144:147], 0
    v_mfma_f32_16x16x32_bf16 v[212:215], v[48:51], v[144:147], 0
    v_mfma_f32_16x16x32_bf16 v[216:219], v[80:83], v[144:147], 0
    v_mfma_f32_16x16x32_bf16 v[220:223], v[112:115], v[144:147], 0
    ds_read_b128 v[176:179], v11 offset:8448
    s_waitcnt lgkmcnt(7)
    v_mfma_f32_16x16x32_bf16 v[208:211], v[20:23], v[148:151], v[208:211]
    v_mfma_f32_16x16x32_bf16 v[212:215], v[52:55], v[148:151], v[212:215]
    v_mfma_f32_16x16x32_bf16 v[216:219], v[84:87], v[148:151], v[216:219]
    v_mfma_f32_16x16x32_bf16 v[220:223], v[116:119], v[148:151], v[220:223]
    ds_read_b128 v[180:183], v11 offset:8512
    s_waitcnt lgkmcnt(7)
    v_mfma_f32_16x16x32_bf16 v[208:211], v[24:27], v[152:155], v[208:211]
    v_mfma_f32_16x16x32_bf16 v[212:215], v[56:59], v[152:155], v[212:215]
    v_mfma_f32_16x16x32_bf16 v[216:219], v[88:91], v[152:155], v[216:219]
    v_mfma_f32_16x16x32_bf16 v[220:223], v[120:123], v[152:155], v[220:223]
    ds_read_b128 v[184:187], v11 offset:8576
    s_waitcnt lgkmcnt(7)
    v_mfma_f32_16x16x32_bf16 v[208:211], v[28:31], v[156:159], v[208:211]
    v_mfma_f32_16x16x32_bf16 v[212:215], v[60:63], v[156:159], v[212:215]
    v_mfma_f32_16x16x32_bf16 v[216:219], v[92:95], v[156:159], v[216:219]
    v_mfma_f32_16x16x32_bf16 v[220:223], v[124:127], v[156:159], v[220:223]
    ds_read_b128 v[188:191], v11 offset:8640
    s_waitcnt lgkmcnt(7)
    v_mfma_f32_16x16x32_bf16 v[208:211], v[32:35], v[160:163], v[208:211]
    v_mfma_f32_16x16x32_bf16 v[212:215], v[64:67], v[160:163], v[212:215]
    v_mfma_f32_16x16x32_bf16 v[216:219], v[96:99], v[160:163], v[216:219]
    v_mfma_f32_16x16x32_bf16 v[220:223], v[128:131], v[160:163], v[220:223]
    ds_read_b128 v[192:195], v11 offset:8704
    s_waitcnt lgkmcnt(7)
    v_mfma_f32_16x16x32_bf16 v[208:211], v[36:39], v[164:167], v[208:211]
    v_mfma_f32_16x16x32_bf16 v[212:215], v[68:71], v[164:167], v[212:215]
    v_mfma_f32_16x16x32_bf16 v[216:219], v[100:103], v[164:167], v[216:219]
    v_mfma_f32_16x16x32_bf16 v[220:223], v[132:135], v[164:167], v[220:223]
    ds_read_b128 v[196:199], v11 offset:8768
    s_waitcnt lgkmcnt(7)
    v_mfma_f32_16x16x32_bf16 v[208:211], v[40:43], v[168:171], v[208:211]
    v_mfma_f32_16x16x32_bf16 v[212:215], v[72:75], v[168:171], v[212:215]
    v_mfma_f32_16x16x32_bf16 v[216:219], v[104:107], v[168:171], v[216:219]
    v_mfma_f32_16x16x32_bf16 v[220:223], v[136:139], v[168:171], v[220:223]
    ds_read_b128 v[200:203], v11 offset:8832
    s_waitcnt lgkmcnt(7)
    v_mfma_f32_16x16x32_bf16 v[208:211], v[44:47], v[172:175], v[208:211]
    v_mfma_f32_16x16x32_bf16 v[212:215], v[76:79], v[172:175], v[212:215]
    v_mfma_f32_16x16x32_bf16 v[216:219], v[108:111], v[172:175], v[216:219]
    v_mfma_f32_16x16x32_bf16 v[220:223], v[140:143], v[172:175], v[220:223]
    ds_read_b128 v[204:207], v11 offset:8896
    s_waitcnt lgkmcnt(7)
    v_mfma_f32_16x16x32_bf16 v[224:227], v[16:19], v[176:179], 0
    v_mfma_f32_16x16x32_bf16 v[228:231], v[48:51], v[176:179], 0
    v_mfma_f32_16x16x32_bf16 v[232:235], v[80:83], v[176:179], 0
    v_mfma_f32_16x16x32_bf16 v[236:239], v[112:115], v[176:179], 0
    ds_read_b128 v[144:147], v11 offset:16896
    s_waitcnt lgkmcnt(7)
    v_mfma_f32_16x16x32_bf16 v[224:227], v[20:23], v[180:183], v[224:227]
    v_mfma_f32_16x16x32_bf16 v[228:231], v[52:55], v[180:183], v[228:231]
    v_mfma_f32_16x16x32_bf16 v[232:235], v[84:87], v[180:183], v[232:235]
    v_mfma_f32_16x16x32_bf16 v[236:239], v[116:119], v[180:183], v[236:239]
    ds_read_b128 v[148:151], v11 offset:16960
    s_waitcnt lgkmcnt(7)
    v_mfma_f32_16x16x32_bf16 v[224:227], v[24:27], v[184:187], v[224:227]
    v_mfma_f32_16x16x32_bf16 v[228:231], v[56:59], v[184:187], v[228:231]
    v_mfma_f32_16x16x32_bf16 v[232:235], v[88:91], v[184:187], v[232:235]
    v_mfma_f32_16x16x32_bf16 v[236:239], v[120:123], v[184:187], v[236:239]
    ds_read_b128 v[152:155], v11 offset:17024
    v_mul_f32 v208, s38, v208
    v_mul_f32 v209, s38, v209
    v_mul_f32 v210, s38, v210
    v_mul_f32 v211, s38, v211
    v_mul_f32 v212, s38, v212
    v_mul_f32 v213, s38, v213
    v_mul_f32 v214, s38, v214
    v_mul_f32 v215, s38, v215
    v_cvt_pk_bf16_f32 v240, v208, v209
    v_cvt_pk_bf16_f32 v241, v210, v211
    v_cvt_pk_bf16_f32 v242, v212, v213
    v_cvt_pk_bf16_f32 v243, v214, v215
    global_store_dwordx4 v8, v[240:243], s[4:5] offset:0 sc1
    v_mul_f32 v216, s38, v216
    v_mul_f32 v217, s38, v217
    v_mul_f32 v218, s38, v218
    v_mul_f32 v219, s38, v219
    v_mul_f32 v220, s38, v220
    v_mul_f32 v221, s38, v221
    v_mul_f32 v222, s38, v222
    v_mul_f32 v223, s38, v223
    v_cvt_pk_bf16_f32 v244, v216, v217
    v_cvt_pk_bf16_f32 v245, v218, v219
    v_cvt_pk_bf16_f32 v246, v220, v221
    v_cvt_pk_bf16_f32 v247, v222, v223
    global_store_dwordx4 v8, v[244:247], s[4:5] offset:1024 sc1
    v_add_u32 v8, 14336, v8
    s_waitcnt lgkmcnt(7)
    v_mfma_f32_16x16x32_bf16 v[224:227], v[28:31], v[188:191], v[224:227]
    v_mfma_f32_16x16x32_bf16 v[228:231], v[60:63], v[188:191], v[228:231]
    v_mfma_f32_16x16x32_bf16 v[232:235], v[92:95], v[188:191], v[232:235]
    v_mfma_f32_16x16x32_bf16 v[236:239], v[124:127], v[188:191], v[236:239]
    ds_read_b128 v[156:159], v11 offset:17088
    s_waitcnt lgkmcnt(7)
    v_mfma_f32_16x16x32_bf16 v[224:227], v[32:35], v[192:195], v[224:227]
    v_mfma_f32_16x16x32_bf16 v[228:231], v[64:67], v[192:195], v[228:231]
    v_mfma_f32_16x16x32_bf16 v[232:235], v[96:99], v[192:195], v[232:235]
    v_mfma_f32_16x16x32_bf16 v[236:239], v[128:131], v[192:195], v[236:239]
    ds_read_b128 v[160:163], v11 offset:17152
    s_waitcnt lgkmcnt(7)
    v_mfma_f32_16x16x32_bf16 v[224:227], v[36:39], v[196:199], v[224:227]
    v_mfma_f32_16x16x32_bf16 v[228:231], v[68:71], v[196:199], v[228:231]
    v_mfma_f32_16x16x32_bf16 v[232:235], v[100:103], v[196:199], v[232:235]
    v_mfma_f32_16x16x32_bf16 v[236:239], v[132:135], v[196:199], v[236:239]
    ds_read_b128 v[164:167], v11 offset:17216
    s_waitcnt lgkmcnt(7)
    v_mfma_f32_16x16x32_bf16 v[224:227], v[40:43], v[200:203], v[224:227]
    v_mfma_f32_16x16x32_bf16 v[228:231], v[72:75], v[200:203], v[228:231]
    v_mfma_f32_16x16x32_bf16 v[232:235], v[104:107], v[200:203], v[232:235]
    v_mfma_f32_16x16x32_bf16 v[236:239], v[136:139], v[200:203], v[236:239]
    ds_read_b128 v[168:171], v11 offset:17280
    s_waitcnt lgkmcnt(7)
    v_mfma_f32_16x16x32_bf16 v[224:227], v[44:47], v[204:207], v[224:227]
    v_mfma_f32_16x16x32_bf16 v[228:231], v[76:79], v[204:207], v[228:231]
    v_mfma_f32_16x16x32_bf16 v[232:235], v[108:111], v[204:207], v[232:235]
    v_mfma_f32_16x16x32_bf16 v[236:239], v[140:143], v[204:207], v[236:239]
    ds_read_b128 v[172:175], v11 offset:17344
    s_waitcnt lgkmcnt(7)
    v_mfma_f32_16x16x32_bf16 v[208:211], v[16:19], v[144:147], 0
    v_mfma_f32_16x16x32_bf16 v[212:215], v[48:51], v[144:147], 0
    v_mfma_f32_16x16x32_bf16 v[216:219], v[80:83], v[144:147], 0
    v_mfma_f32_16x16x32_bf16 v[220:223], v[112:115], v[144:147], 0
    ds_read_b128 v[176:179], v11 offset:25344
    s_waitcnt lgkmcnt(7)
    v_mfma_f32_16x16x32_bf16 v[208:211], v[20:23], v[148:151], v[208:211]
    v_mfma_f32_16x16x32_bf16 v[212:215], v[52:55], v[148:151], v[212:215]
    v_mfma_f32_16x16x32_bf16 v[216:219], v[84:87], v[148:151], v[216:219]
    v_mfma_f32_16x16x32_bf16 v[220:223], v[116:119], v[148:151], v[220:223]
    ds_read_b128 v[180:183], v11 offset:25408
    s_waitcnt lgkmcnt(7)
    v_mfma_f32_16x16x32_bf16 v[208:211], v[24:27], v[152:155], v[208:211]
    v_mfma_f32_16x16x32_bf16 v[212:215], v[56:59], v[152:155], v[212:215]
    v_mfma_f32_16x16x32_bf16 v[216:219], v[88:91], v[152:155], v[216:219]
    v_mfma_f32_16x16x32_bf16 v[220:223], v[120:123], v[152:155], v[220:223]
    ds_read_b128 v[184:187], v11 offset:25472
    v_mul_f32 v224, s38, v224
    v_mul_f32 v225, s38, v225
    v_mul_f32 v226, s38, v226
    v_mul_f32 v227, s38, v227
    v_mul_f32 v228, s38, v228
    v_mul_f32 v229, s38, v229
    v_mul_f32 v230, s38, v230
    v_mul_f32 v231, s38, v231
    v_cvt_pk_bf16_f32 v248, v224, v225
    v_cvt_pk_bf16_f32 v249, v226, v227
    v_cvt_pk_bf16_f32 v250, v228, v229
    v_cvt_pk_bf16_f32 v251, v230, v231
    global_store_dwordx4 v8, v[248:251], s[4:5] offset:0 sc1
    v_mul_f32 v232, s38, v232
    v_mul_f32 v233, s38, v233
    v_mul_f32 v234, s38, v234
    v_mul_f32 v235, s38, v235
    v_mul_f32 v236, s38, v236
    v_mul_f32 v237, s38, v237
    v_mul_f32 v238, s38, v238
    v_mul_f32 v239, s38, v239
    v_cvt_pk_bf16_f32 v252, v232, v233
    v_cvt_pk_bf16_f32 v253, v234, v235
    v_cvt_pk_bf16_f32 v254, v236, v237
    v_cvt_pk_bf16_f32 v255, v238, v239
    global_store_dwordx4 v8, v[252:255], s[4:5] offset:1024 sc1
    v_add_u32 v8, 14336, v8
    s_waitcnt lgkmcnt(7)
    v_mfma_f32_16x16x32_bf16 v[208:211], v[28:31], v[156:159], v[208:211]
    v_mfma_f32_16x16x32_bf16 v[212:215], v[60:63], v[156:159], v[212:215]
    v_mfma_f32_16x16x32_bf16 v[216:219], v[92:95], v[156:159], v[216:219]
    v_mfma_f32_16x16x32_bf16 v[220:223], v[124:127], v[156:159], v[220:223]
    ds_read_b128 v[188:191], v11 offset:25536
    s_waitcnt lgkmcnt(7)
    v_mfma_f32_16x16x32_bf16 v[208:211], v[32:35], v[160:163], v[208:211]
    v_mfma_f32_16x16x32_bf16 v[212:215], v[64:67], v[160:163], v[212:215]
    v_mfma_f32_16x16x32_bf16 v[216:219], v[96:99], v[160:163], v[216:219]
    v_mfma_f32_16x16x32_bf16 v[220:223], v[128:131], v[160:163], v[220:223]
    ds_read_b128 v[192:195], v11 offset:25600
    s_waitcnt lgkmcnt(7)
    v_mfma_f32_16x16x32_bf16 v[208:211], v[36:39], v[164:167], v[208:211]
    v_mfma_f32_16x16x32_bf16 v[212:215], v[68:71], v[164:167], v[212:215]
    v_mfma_f32_16x16x32_bf16 v[216:219], v[100:103], v[164:167], v[216:219]
    v_mfma_f32_16x16x32_bf16 v[220:223], v[132:135], v[164:167], v[220:223]
    ds_read_b128 v[196:199], v11 offset:25664
    s_waitcnt lgkmcnt(7)
    v_mfma_f32_16x16x32_bf16 v[208:211], v[40:43], v[168:171], v[208:211]
    v_mfma_f32_16x16x32_bf16 v[212:215], v[72:75], v[168:171], v[212:215]
    v_mfma_f32_16x16x32_bf16 v[216:219], v[104:107], v[168:171], v[216:219]
    v_mfma_f32_16x16x32_bf16 v[220:223], v[136:139], v[168:171], v[220:223]
    ds_read_b128 v[200:203], v11 offset:25728
    s_waitcnt lgkmcnt(7)
    v_mfma_f32_16x16x32_bf16 v[208:211], v[44:47], v[172:175], v[208:211]
    v_mfma_f32_16x16x32_bf16 v[212:215], v[76:79], v[172:175], v[212:215]
    v_mfma_f32_16x16x32_bf16 v[216:219], v[108:111], v[172:175], v[216:219]
    v_mfma_f32_16x16x32_bf16 v[220:223], v[140:143], v[172:175], v[220:223]
    ds_read_b128 v[204:207], v11 offset:25792
    s_waitcnt lgkmcnt(7)
    v_mfma_f32_16x16x32_bf16 v[224:227], v[16:19], v[176:179], 0
    v_mfma_f32_16x16x32_bf16 v[228:231], v[48:51], v[176:179], 0
    v_mfma_f32_16x16x32_bf16 v[232:235], v[80:83], v[176:179], 0
    v_mfma_f32_16x16x32_bf16 v[236:239], v[112:115], v[176:179], 0
    s_waitcnt lgkmcnt(6)
    v_mfma_f32_16x16x32_bf16 v[224:227], v[20:23], v[180:183], v[224:227]
    v_mfma_f32_16x16x32_bf16 v[228:231], v[52:55], v[180:183], v[228:231]
    v_mfma_f32_16x16x32_bf16 v[232:235], v[84:87], v[180:183], v[232:235]
    v_mfma_f32_16x16x32_bf16 v[236:239], v[116:119], v[180:183], v[236:239]
    s_waitcnt lgkmcnt(5)
    v_mfma_f32_16x16x32_bf16 v[224:227], v[24:27], v[184:187], v[224:227]
    v_mfma_f32_16x16x32_bf16 v[228:231], v[56:59], v[184:187], v[228:231]
    v_mfma_f32_16x16x32_bf16 v[232:235], v[88:91], v[184:187], v[232:235]
    v_mfma_f32_16x16x32_bf16 v[236:239], v[120:123], v[184:187], v[236:239]
    v_mul_f32 v208, s38, v208
    v_mul_f32 v209, s38, v209
    v_mul_f32 v210, s38, v210
    v_mul_f32 v211, s38, v211
    v_mul_f32 v212, s38, v212
    v_mul_f32 v213, s38, v213
    v_mul_f32 v214, s38, v214
    v_mul_f32 v215, s38, v215
    v_cvt_pk_bf16_f32 v240, v208, v209
    v_cvt_pk_bf16_f32 v241, v210, v211
    v_cvt_pk_bf16_f32 v242, v212, v213
    v_cvt_pk_bf16_f32 v243, v214, v215
    global_store_dwordx4 v8, v[240:243], s[4:5] offset:0 sc1
    v_mul_f32 v216, s38, v216
    v_mul_f32 v217, s38, v217
    v_mul_f32 v218, s38, v218
    v_mul_f32 v219, s38, v219
    v_mul_f32 v220, s38, v220
    v_mul_f32 v221, s38, v221
    v_mul_f32 v222, s38, v222
    v_mul_f32 v223, s38, v223
    v_cvt_pk_bf16_f32 v244, v216, v217
    v_cvt_pk_bf16_f32 v245, v218, v219
    v_cvt_pk_bf16_f32 v246, v220, v221
    v_cvt_pk_bf16_f32 v247, v222, v223
    global_store_dwordx4 v8, v[244:247], s[4:5] offset:1024 sc1
    v_add_u32 v8, 14336, v8
    s_waitcnt lgkmcnt(4)
    v_mfma_f32_16x16x32_bf16 v[224:227], v[28:31], v[188:191], v[224:227]
    v_mfma_f32_16x16x32_bf16 v[228:231], v[60:63], v[188:191], v[228:231]
    v_mfma_f32_16x16x32_bf16 v[232:235], v[92:95], v[188:191], v[232:235]
    v_mfma_f32_16x16x32_bf16 v[236:239], v[124:127], v[188:191], v[236:239]
    s_waitcnt lgkmcnt(3)
    v_mfma_f32_16x16x32_bf16 v[224:227], v[32:35], v[192:195], v[224:227]
    v_mfma_f32_16x16x32_bf16 v[228:231], v[64:67], v[192:195], v[228:231]
    v_mfma_f32_16x16x32_bf16 v[232:235], v[96:99], v[192:195], v[232:235]
    v_mfma_f32_16x16x32_bf16 v[236:239], v[128:131], v[192:195], v[236:239]
    s_waitcnt lgkmcnt(2)
    v_mfma_f32_16x16x32_bf16 v[224:227], v[36:39], v[196:199], v[224:227]
    v_mfma_f32_16x16x32_bf16 v[228:231], v[68:71], v[196:199], v[228:231]
    v_mfma_f32_16x16x32_bf16 v[232:235], v[100:103], v[196:199], v[232:235]
    v_mfma_f32_16x16x32_bf16 v[236:239], v[132:135], v[196:199], v[236:239]
    s_waitcnt lgkmcnt(1)
    v_mfma_f32_16x16x32_bf16 v[224:227], v[40:43], v[200:203], v[224:227]
    v_mfma_f32_16x16x32_bf16 v[228:231], v[72:75], v[200:203], v[228:231]
    v_mfma_f32_16x16x32_bf16 v[232:235], v[104:107], v[200:203], v[232:235]
    v_mfma_f32_16x16x32_bf16 v[236:239], v[136:139], v[200:203], v[236:239]
    s_waitcnt lgkmcnt(0)
    v_mfma_f32_16x16x32_bf16 v[224:227], v[44:47], v[204:207], v[224:227]
    v_mfma_f32_16x16x32_bf16 v[228:231], v[76:79], v[204:207], v[228:231]
    v_mfma_f32_16x16x32_bf16 v[232:235], v[108:111], v[204:207], v[232:235]
    v_mfma_f32_16x16x32_bf16 v[236:239], v[140:143], v[204:207], v[236:239]
    s_nop 7
    s_nop 1
    v_mul_f32 v224, s38, v224
    v_mul_f32 v225, s38, v225
    v_mul_f32 v226, s38, v226
    v_mul_f32 v227, s38, v227
    v_mul_f32 v228, s38, v228
    v_mul_f32 v229, s38, v229
    v_mul_f32 v230, s38, v230
    v_mul_f32 v231, s38, v231
    v_cvt_pk_bf16_f32 v248, v224, v225
    v_cvt_pk_bf16_f32 v249, v226, v227
    v_cvt_pk_bf16_f32 v250, v228, v229
    v_cvt_pk_bf16_f32 v251, v230, v231
    global_store_dwordx4 v8, v[248:251], s[4:5] offset:0 sc1
    v_mul_f32 v232, s38, v232
    v_mul_f32 v233, s38, v233
    v_mul_f32 v234, s38, v234
    v_mul_f32 v235, s38, v235
    v_mul_f32 v236, s38, v236
    v_mul_f32 v237, s38, v237
    v_mul_f32 v238, s38, v238
    v_mul_f32 v239, s38, v239
    v_cvt_pk_bf16_f32 v252, v232, v233
    v_cvt_pk_bf16_f32 v253, v234, v235
    v_cvt_pk_bf16_f32 v254, v236, v237
    v_cvt_pk_bf16_f32 v255, v238, v239
    global_store_dwordx4 v8, v[252:255], s[4:5] offset:1024 sc1
    v_add_u32 v8, 14336, v8
    v_add_u32 v6, 0, v7
    global_load_dwordx4 a[0:3], v6, s[20:21]
    v_add_u32 v6, 16384, v7
    global_load_dwordx4 a[4:7], v6, s[20:21]
    v_add_u32 v6, 65536, v7
    global_load_dwordx4 a[8:11], v6, s[20:21]
    v_add_u32 v6, 81920, v7
    global_load_dwordx4 a[12:15], v6, s[20:21]
    v_add_u32 v6, 131072, v7
    global_load_dwordx4 a[16:19], v6, s[20:21]
    v_add_u32 v6, 147456, v7
    global_load_dwordx4 a[20:23], v6, s[20:21]
    v_add_u32 v6, 196608, v7
    global_load_dwordx4 a[24:27], v6, s[20:21]
    v_add_u32 v6, 212992, v7
    global_load_dwordx4 a[28:31], v6, s[20:21]
    v_add_u32 v6, 32768, v7
    global_load_dwordx4 a[32:35], v6, s[20:21]
    v_add_u32 v6, 49152, v7
    global_load_dwordx4 a[36:39], v6, s[20:21]
    v_add_u32 v6, 98304, v7
    global_load_dwordx4 a[40:43], v6, s[20:21]
    v_add_u32 v6, 114688, v7
    global_load_dwordx4 a[44:47], v6, s[20:21]
    v_add_u32 v6, 163840, v7
    global_load_dwordx4 a[48:51], v6, s[20:21]
    v_add_u32 v6, 180224, v7
    global_load_dwordx4 a[52:55], v6, s[20:21]
    v_add_u32 v6, 229376, v7
    global_load_dwordx4 a[56:59], v6, s[20:21]
    v_add_u32 v6, 245760, v7
    global_load_dwordx4 a[60:63], v6, s[20:21]
    s_waitcnt vmcnt(16)
    s_barrier

    s_cmp_lg_u32 s3, 0
    s_cbranch_scc1 Q_nf1
    s_lshr_b32 s37, s29, 1
    s_lshl_b32 s37, s37, 2
    s_add_u32 s37, s37, 24
    s_and_b32 s38, s29, 1
    s_lshl_b32 s38, s38, 4
    s_lshl_b32 s38, 1, s38
    v_mov_b32 v13, s37
    v_mov_b32 v14, s38
    s_mov_b64 exec, 1
    global_atomic_add v13, v14, s[6:7]
    s_mov_b64 exec, -1
Q_nf1:

    v_add_u32 v6, 262144, v7
    global_load_dwordx4 a[64:67], v6, s[20:21]
    v_add_u32 v6, 278528, v7
    global_load_dwordx4 a[68:71], v6, s[20:21]
    v_add_u32 v6, 327680, v7
    global_load_dwordx4 a[72:75], v6, s[20:21]
    v_add_u32 v6, 344064, v7
    global_load_dwordx4 a[76:79], v6, s[20:21]
    v_add_u32 v6, 393216, v7
    global_load_dwordx4 a[80:83], v6, s[20:21]
    v_add_u32 v6, 409600, v7
    global_load_dwordx4 a[84:87], v6, s[20:21]
    v_add_u32 v6, 458752, v7
    global_load_dwordx4 a[88:91], v6, s[20:21]
    v_add_u32 v6, 475136, v7
    global_load_dwordx4 a[92:95], v6, s[20:21]
    v_add_u32 v6, 294912, v7
    global_load_dwordx4 a[96:99], v6, s[20:21]
    v_add_u32 v6, 311296, v7
    global_load_dwordx4 a[100:103], v6, s[20:21]
    v_add_u32 v6, 360448, v7
    global_load_dwordx4 a[104:107], v6, s[20:21]
    v_add_u32 v6, 376832, v7
    global_load_dwordx4 a[108:111], v6, s[20:21]
    v_add_u32 v6, 425984, v7
    global_load_dwordx4 a[112:115], v6, s[20:21]
    v_add_u32 v6, 442368, v7
    global_load_dwordx4 a[116:119], v6, s[20:21]
    v_add_u32 v6, 491520, v7
    global_load_dwordx4 a[120:123], v6, s[20:21]
    v_add_u32 v6, 507904, v7
    global_load_dwordx4 a[124:127], v6, s[20:21]
    global_load_dwordx4 a[128:131], v2, s[22:23]
    v_add_u32 v2, 7168, v2
    global_load_dwordx4 a[132:135], v2, s[22:23]
    v_add_u32 v2, 7168, v2
    global_load_dwordx4 a[136:139], v2, s[22:23]
    v_add_u32 v2, 7168, v2
    global_load_dwordx4 a[140:143], v2, s[22:23]
    v_add_u32 v2, 7168, v2
    global_load_dwordx4 a[144:147], v2, s[22:23]
    v_add_u32 v2, 7168, v2
    global_load_dwordx4 a[148:151], v2, s[22:23]
    v_add_u32 v2, 7168, v2
    global_load_dwordx4 a[152:155], v2, s[22:23]
    v_add_u32 v2, 7168, v2
    global_load_dwordx4 a[156:159], v2, s[22:23]
    v_add_u32 v2, 7168, v2
    s_waitcnt vmcnt(39)
    ds_write_b128 v9, a[0:3] offset:0
    s_waitcnt vmcnt(38)
    ds_write_b128 v9, a[4:7] offset:1056
    s_waitcnt vmcnt(37)
    ds_write_b128 v9, a[8:11] offset:2112
    s_waitcnt vmcnt(36)
    ds_write_b128 v9, a[12:15] offset:3168
    s_waitcnt vmcnt(35)
    ds_write_b128 v9, a[16:19] offset:4224
    s_waitcnt vmcnt(34)
    ds_write_b128 v9, a[20:23] offset:5280
    s_waitcnt vmcnt(33)
    ds_write_b128 v9, a[24:27] offset:6336
    s_waitcnt vmcnt(32)
    ds_write_b128 v9, a[28:31] offset:7392
    ds_read_b128 v[16:19], v10 offset:0
    ds_read_b128 v[20:23], v10 offset:64
    ds_read_b128 v[24:27], v10 offset:128
    ds_read_b128 v[28:31], v10 offset:192
    ds_read_b128 v[32:35], v10 offset:256
    ds_read_b128 v[36:39], v10 offset:320
    ds_read_b128 v[40:43], v10 offset:384
    ds_read_b128 v[44:47], v10 offset:448
    s_waitcnt vmcnt(31)
    ds_write_b128 v9, a[32:35] offset:0
    s_waitcnt vmcnt(30)
    ds_write_b128 v9, a[36:39] offset:1056
    s_waitcnt vmcnt(29)
    ds_write_b128 v9, a[40:43] offset:2112
    s_waitcnt vmcnt(28)
    ds_write_b128 v9, a[44:47] offset:3168
    s_waitcnt vmcnt(27)
    ds_write_b128 v9, a[48:51] offset:4224
    s_waitcnt vmcnt(26)
    ds_write_b128 v9, a[52:55] offset:5280
    s_waitcnt vmcnt(25)
    ds_write_b128 v9, a[56:59] offset:6336
    s_waitcnt vmcnt(24)
    ds_write_b128 v9, a[60:63] offset:7392
    ds_read_b128 v[48:51], v10 offset:0
    ds_read_b128 v[52:55], v10 offset:64
    ds_read_b128 v[56:59], v10 offset:128
    ds_read_b128 v[60:63], v10 offset:192
    ds_read_b128 v[64:67], v10 offset:256
    ds_read_b128 v[68:71], v10 offset:320
    ds_read_b128 v[72:75], v10 offset:384
    ds_read_b128 v[76:79], v10 offset:448
    s_waitcnt vmcnt(23)
    ds_write_b128 v9, a[64:67] offset:0
    s_waitcnt vmcnt(22)
    ds_write_b128 v9, a[68:71] offset:1056
    s_waitcnt vmcnt(21)
    ds_write_b128 v9, a[72:75] offset:2112
    s_waitcnt vmcnt(20)
    ds_write_b128 v9, a[76:79] offset:3168
    s_waitcnt vmcnt(19)
    ds_write_b128 v9, a[80:83] offset:4224
    s_waitcnt vmcnt(18)
    ds_write_b128 v9, a[84:87] offset:5280
    s_waitcnt vmcnt(17)
    ds_write_b128 v9, a[88:91] offset:6336
    s_waitcnt vmcnt(16)
    ds_write_b128 v9, a[92:95] offset:7392
    ds_read_b128 v[80:83], v10 offset:0
    ds_read_b128 v[84:87], v10 offset:64
    ds_read_b128 v[88:91], v10 offset:128
    ds_read_b128 v[92:95], v10 offset:192
    ds_read_b128 v[96:99], v10 offset:256
    ds_read_b128 v[100:103], v10 offset:320
    ds_read_b128 v[104:107], v10 offset:384
    ds_read_b128 v[108:111], v10 offset:448
    s_waitcnt vmcnt(15)
    ds_write_b128 v9, a[96:99] offset:0
    s_waitcnt vmcnt(14)
    ds_write_b128 v9, a[100:103] offset:1056
    s_waitcnt vmcnt(13)
    ds_write_b128 v9, a[104:107] offset:2112
    s_waitcnt vmcnt(12)
    ds_write_b128 v9, a[108:111] offset:3168
    s_waitcnt vmcnt(11)
    ds_write_b128 v9, a[112:115] offset:4224
    s_waitcnt vmcnt(10)
    ds_write_b128 v9, a[116:119] offset:5280
    s_waitcnt vmcnt(9)
    ds_write_b128 v9, a[120:123] offset:6336
    s_waitcnt vmcnt(8)
    ds_write_b128 v9, a[124:127] offset:7392
    ds_read_b128 v[112:115], v10 offset:0
    ds_read_b128 v[116:119], v10 offset:64
    ds_read_b128 v[120:123], v10 offset:128
    ds_read_b128 v[124:127], v10 offset:192
    ds_read_b128 v[128:131], v10 offset:256
    ds_read_b128 v[132:135], v10 offset:320
    ds_read_b128 v[136:139], v10 offset:384
    ds_read_b128 v[140:143], v10 offset:448
    s_waitcnt vmcnt(7)
    ds_write_b128 v15, a[128:131] offset:0
    s_waitcnt vmcnt(6)
    ds_write_b128 v15, a[132:135] offset:1920
    s_waitcnt vmcnt(5)
    ds_write_b128 v15, a[136:139] offset:3840
    s_waitcnt vmcnt(4)
    ds_write_b128 v15, a[140:143] offset:5760
    s_waitcnt vmcnt(3)
    ds_write_b128 v15, a[144:147] offset:7680
    s_waitcnt vmcnt(2)
    ds_write_b128 v15, a[148:151] offset:9600
    s_waitcnt vmcnt(1)
    ds_write_b128 v15, a[152:155] offset:11520
    s_waitcnt vmcnt(0)
    ds_write_b128 v15, a[156:159] offset:13440

    v_lshrrev_b32 v12, 2, v3
    v_lshl_add_u32 v12, v4, 3, v12
    v_mul_u32_u24 v12, 240, v12
    v_and_b32 v8, 3, v3
    v_lshl_add_u32 v12, v8, 3, v12
    v_add_u32 v12, 67584, v12
    s_lshl_b32 s37, s30, 6
    s_add_u32 s37, s37, s29
    s_mul_i32 s37, s37, 14
    s_add_u32 s37, s37, s32
    s_lshl_b32 s37, s37, 10
    s_add_u32 s37, s37, 0x640000
    v_lshl_add_u32 v8, v1, 4, s37
    s_waitcnt vmcnt(0) lgkmcnt(0)
    s_barrier

    ds_read_b64_tr_b16 v[144:145], v12 offset:0
    ds_read_b64_tr_b16 v[146:147], v12 offset:960
    ds_read_b64_tr_b16 v[148:149], v12 offset:7680
    ds_read_b64_tr_b16 v[150:151], v12 offset:8640
    ds_read_b64_tr_b16 v[152:153], v12 offset:15360
    ds_read_b64_tr_b16 v[154:155], v12 offset:16320
    ds_read_b64_tr_b16 v[156:157], v12 offset:23040
    ds_read_b64_tr_b16 v[158:159], v12 offset:24000
    ds_read_b64_tr_b16 v[160:161], v12 offset:30720
    ds_read_b64_tr_b16 v[162:163], v12 offset:31680
    ds_read_b64_tr_b16 v[164:165], v12 offset:38400
    ds_read_b64_tr_b16 v[166:167], v12 offset:39360
    ds_read_b64_tr_b16 v[168:169], v12 offset:46080
    ds_read_b64_tr_b16 v[170:171], v12 offset:47040
    ds_read_b64_tr_b16 v[172:173], v12 offset:53760
    ds_read_b64_tr_b16 v[174:175], v12 offset:54720
    s_waitcnt lgkmcnt(14)
    v_mfma_f32_16x16x32_bf16 v[208:211], v[16:19], v[144:147], 0
    v_mfma_f32_16x16x32_bf16 v[212:215], v[48:51], v[144:147], 0
    v_mfma_f32_16x16x32_bf16 v[216:219], v[80:83], v[144:147], 0
    v_mfma_f32_16x16x32_bf16 v[220:223], v[112:115], v[144:147], 0
    ds_read_b64_tr_b16 v[176:177], v12 offset:32
    ds_read_b64_tr_b16 v[178:179], v12 offset:992
    s_waitcnt lgkmcnt(14)
    v_mfma_f32_16x16x32_bf16 v[208:211], v[20:23], v[148:151], v[208:211]
    v_mfma_f32_16x16x32_bf16 v[212:215], v[52:55], v[148:151], v[212:215]
    v_mfma_f32_16x16x32_bf16 v[216:219], v[84:87], v[148:151], v[216:219]
    v_mfma_f32_16x16x32_bf16 v[220:223], v[116:119], v[148:151], v[220:223]
    ds_read_b64_tr_b16 v[180:181], v12 offset:7712
    ds_read_b64_tr_b16 v[182:183], v12 offset:8672
    s_waitcnt lgkmcnt(14)
    v_mfma_f32_16x16x32_bf16 v[208:211], v[24:27], v[152:155], v[208:211]
    v_mfma_f32_16x16x32_bf16 v[212:215], v[56:59], v[152:155], v[212:215]
    v_mfma_f32_16x16x32_bf16 v[216:219], v[88:91], v[152:155], v[216:219]
    v_mfma_f32_16x16x32_bf16 v[220:223], v[120:123], v[152:155], v[220:223]
    ds_read_b64_tr_b16 v[184:185], v12 offset:15392
    ds_read_b64_tr_b16 v[186:187], v12 offset:16352
    s_waitcnt lgkmcnt(14)
    v_mfma_f32_16x16x32_bf16 v[208:211], v[28:31], v[156:159], v[208:211]
    v_mfma_f32_16x16x32_bf16 v[212:215], v[60:63], v[156:159], v[212:215]
    v_mfma_f32_16x16x32_bf16 v[216:219], v[92:95], v[156:159], v[216:219]
    v_mfma_f32_16x16x32_bf16 v[220:223], v[124:127], v[156:159], v[220:223]
    ds_read_b64_tr_b16 v[188:189], v12 offset:23072
    ds_read_b64_tr_b16 v[190:191], v12 offset:24032
    s_waitcnt lgkmcnt(14)
    v_mfma_f32_16x16x32_bf16 v[208:211], v[32:35], v[160:163], v[208:211]
    v_mfma_f32_16x16x32_bf16 v[212:215], v[64:67], v[160:163], v[212:215]
    v_mfma_f32_16x16x32_bf16 v[216:219], v[96:99], v[160:163], v[216:219]
    v_mfma_f32_16x16x32_bf16 v[220:223], v[128:131], v[160:163], v[220:223]
    ds_read_b64_tr_b16 v[192:193], v12 offset:30752
    ds_read_b64_tr_b16 v[194:195], v12 offset:31712
    s_waitcnt lgkmcnt(14)
    v_mfma_f32_16x16x32_bf16 v[208:211], v[36:39], v[164:167], v[208:211]
    v_mfma_f32_16x16x32_bf16 v[212:215], v[68:71], v[164:167], v[212:215]
    v_mfma_f32_16x16x32_bf16 v[216:219], v[100:103], v[164:167], v[216:219]
    v_mfma_f32_16x16x32_bf16 v[220:223], v[132:135], v[164:167], v[220:223]
    ds_read_b64_tr_b16 v[196:197], v12 offset:38432
    ds_read_b64_tr_b16 v[198:199], v12 offset:39392
    s_waitcnt lgkmcnt(14)
    v_mfma_f32_16x16x32_bf16 v[208:211], v[40:43], v[168:171], v[208:211]
    v_mfma_f32_16x16x32_bf16 v[212:215], v[72:75], v[168:171], v[212:215]
    v_mfma_f32_16x16x32_bf16 v[216:219], v[104:107], v[168:171], v[216:219]
    v_mfma_f32_16x16x32_bf16 v[220:223], v[136:139], v[168:171], v[220:223]
    ds_read_b64_tr_b16 v[200:201], v12 offset:46112
    ds_read_b64_tr_b16 v[202:203], v12 offset:47072
    s_waitcnt lgkmcnt(14)
    v_mfma_f32_16x16x32_bf16 v[208:211], v[44:47], v[172:175], v[208:211]
    v_mfma_f32_16x16x32_bf16 v[212:215], v[76:79], v[172:175], v[212:215]
    v_mfma_f32_16x16x32_bf16 v[216:219], v[108:111], v[172:175], v[216:219]
    v_mfma_f32_16x16x32_bf16 v[220:223], v[140:143], v[172:175], v[220:223]
    ds_read_b64_tr_b16 v[204:205], v12 offset:53792
    ds_read_b64_tr_b16 v[206:207], v12 offset:54752
    s_waitcnt lgkmcnt(14)
    v_mfma_f32_16x16x32_bf16 v[224:227], v[16:19], v[176:179], 0
    v_mfma_f32_16x16x32_bf16 v[228:231], v[48:51], v[176:179], 0
    v_mfma_f32_16x16x32_bf16 v[232:235], v[80:83], v[176:179], 0
    v_mfma_f32_16x16x32_bf16 v[236:239], v[112:115], v[176:179], 0
    ds_read_b64_tr_b16 v[144:145], v12 offset:64
    ds_read_b64_tr_b16 v[146:147], v12 offset:1024
    s_waitcnt lgkmcnt(14)
    v_mfma_f32_16x16x32_bf16 v[224:227], v[20:23], v[180:183], v[224:227]
    v_mfma_f32_16x16x32_bf16 v[228:231], v[52:55], v[180:183], v[228:231]
    v_mfma_f32_16x16x32_bf16 v[232:235], v[84:87], v[180:183], v[232:235]
    v_mfma_f32_16x16x32_bf16 v[236:239], v[116:119], v[180:183], v[236:239]
    ds_read_b64_tr_b16 v[148:149], v12 offset:7744
    ds_read_b64_tr_b16 v[150:151], v12 offset:8704
    s_waitcnt lgkmcnt(14)
    v_mfma_f32_16x16x32_bf16 v[224:227], v[24:27], v[184:187], v[224:227]
    v_mfma_f32_16x16x32_bf16 v[228:231], v[56:59], v[184:187], v[228:231]
    v_mfma_f32_16x16x32_bf16 v[232:235], v[88:91], v[184:187], v[232:235]
    v_mfma_f32_16x16x32_bf16 v[236:239], v[120:123], v[184:187], v[236:239]
    ds_read_b64_tr_b16 v[152:153], v12 offset:15424
    ds_read_b64_tr_b16 v[154:155], v12 offset:16384
    v_cvt_pk_bf16_f32 v240, v208, v209
    v_cvt_pk_bf16_f32 v241, v210, v211
    v_cvt_pk_bf16_f32 v242, v212, v213
    v_cvt_pk_bf16_f32 v243, v214, v215
    global_store_dwordx4 v8, v[240:243], s[4:5] offset:0 sc1
    v_cvt_pk_bf16_f32 v244, v216, v217
    v_cvt_pk_bf16_f32 v245, v218, v219
    v_cvt_pk_bf16_f32 v246, v220, v221
    v_cvt_pk_bf16_f32 v247, v222, v223
    global_store_dwordx4 v8, v[244:247], s[4:5] offset:1024 sc1
    v_add_u32 v8, 229376, v8
    s_waitcnt lgkmcnt(14)
    v_mfma_f32_16x16x32_bf16 v[224:227], v[28:31], v[188:191], v[224:227]
    v_mfma_f32_16x16x32_bf16 v[228:231], v[60:63], v[188:191], v[228:231]
    v_mfma_f32_16x16x32_bf16 v[232:235], v[92:95], v[188:191], v[232:235]
    v_mfma_f32_16x16x32_bf16 v[236:239], v[124:127], v[188:191], v[236:239]
    ds_read_b64_tr_b16 v[156:157], v12 offset:23104
    ds_read_b64_tr_b16 v[158:159], v12 offset:24064
    s_waitcnt lgkmcnt(14)
    v_mfma_f32_16x16x32_bf16 v[224:227], v[32:35], v[192:195], v[224:227]
    v_mfma_f32_16x16x32_bf16 v[228:231], v[64:67], v[192:195], v[228:231]
    v_mfma_f32_16x16x32_bf16 v[232:235], v[96:99], v[192:195], v[232:235]
    v_mfma_f32_16x16x32_bf16 v[236:239], v[128:131], v[192:195], v[236:239]
    ds_read_b64_tr_b16 v[160:161], v12 offset:30784
    ds_read_b64_tr_b16 v[162:163], v12 offset:31744
    s_waitcnt lgkmcnt(14)
    v_mfma_f32_16x16x32_bf16 v[224:227], v[36:39], v[196:199], v[224:227]
    v_mfma_f32_16x16x32_bf16 v[228:231], v[68:71], v[196:199], v[228:231]
    v_mfma_f32_16x16x32_bf16 v[232:235], v[100:103], v[196:199], v[232:235]
    v_mfma_f32_16x16x32_bf16 v[236:239], v[132:135], v[196:199], v[236:239]
    ds_read_b64_tr_b16 v[164:165], v12 offset:38464
    ds_read_b64_tr_b16 v[166:167], v12 offset:39424
    s_waitcnt lgkmcnt(14)
    v_mfma_f32_16x16x32_bf16 v[224:227], v[40:43], v[200:203], v[224:227]
    v_mfma_f32_16x16x32_bf16 v[228:231], v[72:75], v[200:203], v[228:231]
    v_mfma_f32_16x16x32_bf16 v[232:235], v[104:107], v[200:203], v[232:235]
    v_mfma_f32_16x16x32_bf16 v[236:239], v[136:139], v[200:203], v[236:239]
    ds_read_b64_tr_b16 v[168:169], v12 offset:46144
    ds_read_b64_tr_b16 v[170:171], v12 offset:47104
    s_waitcnt lgkmcnt(14)
    v_mfma_f32_16x16x32_bf16 v[224:227], v[44:47], v[204:207], v[224:227]
    v_mfma_f32_16x16x32_bf16 v[228:231], v[76:79], v[204:207], v[228:231]
    v_mfma_f32_16x16x32_bf16 v[232:235], v[108:111], v[204:207], v[232:235]
    v_mfma_f32_16x16x32_bf16 v[236:239], v[140:143], v[204:207], v[236:239]
    ds_read_b64_tr_b16 v[172:173], v12 offset:53824
    ds_read_b64_tr_b16 v[174:175], v12 offset:54784
    s_waitcnt lgkmcnt(14)
    v_mfma_f32_16x16x32_bf16 v[208:211], v[16:19], v[144:147], 0
    v_mfma_f32_16x16x32_bf16 v[212:215], v[48:51], v[144:147], 0
    v_mfma_f32_16x16x32_bf16 v[216:219], v[80:83], v[144:147], 0
    v_mfma_f32_16x16x32_bf16 v[220:223], v[112:115], v[144:147], 0
    ds_read_b64_tr_b16 v[176:177], v12 offset:96
    ds_read_b64_tr_b16 v[178:179], v12 offset:1056
    s_waitcnt lgkmcnt(14)
    v_mfma_f32_16x16x32_bf16 v[208:211], v[20:23], v[148:151], v[208:211]
    v_mfma_f32_16x16x32_bf16 v[212:215], v[52:55], v[148:151], v[212:215]
    v_mfma_f32_16x16x32_bf16 v[216:219], v[84:87], v[148:151], v[216:219]
    v_mfma_f32_16x16x32_bf16 v[220:223], v[116:119], v[148:151], v[220:223]
    ds_read_b64_tr_b16 v[180:181], v12 offset:7776
    ds_read_b64_tr_b16 v[182:183], v12 offset:8736
    s_waitcnt lgkmcnt(14)
    v_mfma_f32_16x16x32_bf16 v[208:211], v[24:27], v[152:155], v[208:211]
    v_mfma_f32_16x16x32_bf16 v[212:215], v[56:59], v[152:155], v[212:215]
    v_mfma_f32_16x16x32_bf16 v[216:219], v[88:91], v[152:155], v[216:219]
    v_mfma_f32_16x16x32_bf16 v[220:223], v[120:123], v[152:155], v[220:223]
    ds_read_b64_tr_b16 v[184:185], v12 offset:15456
    ds_read_b64_tr_b16 v[186:187], v12 offset:16416
    v_cvt_pk_bf16_f32 v248, v224, v225
    v_cvt_pk_bf16_f32 v249, v226, v227
    v_cvt_pk_bf16_f32 v250, v228, v229
    v_cvt_pk_bf16_f32 v251, v230, v231
    global_store_dwordx4 v8, v[248:251], s[4:5] offset:0 sc1
    v_cvt_pk_bf16_f32 v252, v232, v233
    v_cvt_pk_bf16_f32 v253, v234, v235
    v_cvt_pk_bf16_f32 v254, v236, v237
    v_cvt_pk_bf16_f32 v255, v238, v239
    global_store_dwordx4 v8, v[252:255], s[4:5] offset:1024 sc1
    v_add_u32 v8, 229376, v8
    s_waitcnt lgkmcnt(14)
    v_mfma_f32_16x16x32_bf16 v[208:211], v[28:31], v[156:159], v[208:211]
    v_mfma_f32_16x16x32_bf16 v[212:215], v[60:63], v[156:159], v[212:215]
    v_mfma_f32_16x16x32_bf16 v[216:219], v[92:95], v[156:159], v[216:219]
    v_mfma_f32_16x16x32_bf16 v[220:223], v[124:127], v[156:159], v[220:223]
    ds_read_b64_tr_b16 v[188:189], v12 offset:23136
    ds_read_b64_tr_b16 v[190:191], v12 offset:24096
    s_waitcnt lgkmcnt(14)
    v_mfma_f32_16x16x32_bf16 v[208:211], v[32:35], v[160:163], v[208:211]
    v_mfma_f32_16x16x32_bf16 v[212:215], v[64:67], v[160:163], v[212:215]
    v_mfma_f32_16x16x32_bf16 v[216:219], v[96:99], v[160:163], v[216:219]
    v_mfma_f32_16x16x32_bf16 v[220:223], v[128:131], v[160:163], v[220:223]
    ds_read_b64_tr_b16 v[192:193], v12 offset:30816
    ds_read_b64_tr_b16 v[194:195], v12 offset:31776
    s_waitcnt lgkmcnt(14)
    v_mfma_f32_16x16x32_bf16 v[208:211], v[36:39], v[164:167], v[208:211]
    v_mfma_f32_16x16x32_bf16 v[212:215], v[68:71], v[164:167], v[212:215]
    v_mfma_f32_16x16x32_bf16 v[216:219], v[100:103], v[164:167], v[216:219]
    v_mfma_f32_16x16x32_bf16 v[220:223], v[132:135], v[164:167], v[220:223]
    ds_read_b64_tr_b16 v[196:197], v12 offset:38496
    ds_read_b64_tr_b16 v[198:199], v12 offset:39456
    s_waitcnt lgkmcnt(14)
    v_mfma_f32_16x16x32_bf16 v[208:211], v[40:43], v[168:171], v[208:211]
    v_mfma_f32_16x16x32_bf16 v[212:215], v[72:75], v[168:171], v[212:215]
    v_mfma_f32_16x16x32_bf16 v[216:219], v[104:107], v[168:171], v[216:219]
    v_mfma_f32_16x16x32_bf16 v[220:223], v[136:139], v[168:171], v[220:223]
    ds_read_b64_tr_b16 v[200:201], v12 offset:46176
    ds_read_b64_tr_b16 v[202:203], v12 offset:47136
    s_waitcnt lgkmcnt(14)
    v_mfma_f32_16x16x32_bf16 v[208:211], v[44:47], v[172:175], v[208:211]
    v_mfma_f32_16x16x32_bf16 v[212:215], v[76:79], v[172:175], v[212:215]
    v_mfma_f32_16x16x32_bf16 v[216:219], v[108:111], v[172:175], v[216:219]
    v_mfma_f32_16x16x32_bf16 v[220:223], v[140:143], v[172:175], v[220:223]
    ds_read_b64_tr_b16 v[204:205], v12 offset:53856
    ds_read_b64_tr_b16 v[206:207], v12 offset:54816
    s_waitcnt lgkmcnt(14)
    v_mfma_f32_16x16x32_bf16 v[224:227], v[16:19], v[176:179], 0
    v_mfma_f32_16x16x32_bf16 v[228:231], v[48:51], v[176:179], 0
    v_mfma_f32_16x16x32_bf16 v[232:235], v[80:83], v[176:179], 0
    v_mfma_f32_16x16x32_bf16 v[236:239], v[112:115], v[176:179], 0
    s_waitcnt lgkmcnt(12)
    v_mfma_f32_16x16x32_bf16 v[224:227], v[20:23], v[180:183], v[224:227]
    v_mfma_f32_16x16x32_bf16 v[228:231], v[52:55], v[180:183], v[228:231]
    v_mfma_f32_16x16x32_bf16 v[232:235], v[84:87], v[180:183], v[232:235]
    v_mfma_f32_16x16x32_bf16 v[236:239], v[116:119], v[180:183], v[236:239]
    s_waitcnt lgkmcnt(10)
    v_mfma_f32_16x16x32_bf16 v[224:227], v[24:27], v[184:187], v[224:227]
    v_mfma_f32_16x16x32_bf16 v[228:231], v[56:59], v[184:187], v[228:231]
    v_mfma_f32_16x16x32_bf16 v[232:235], v[88:91], v[184:187], v[232:235]
    v_mfma_f32_16x16x32_bf16 v[236:239], v[120:123], v[184:187], v[236:239]
    v_cvt_pk_bf16_f32 v240, v208, v209
    v_cvt_pk_bf16_f32 v241, v210, v211
    v_cvt_pk_bf16_f32 v242, v212, v213
    v_cvt_pk_bf16_f32 v243, v214, v215
    global_store_dwordx4 v8, v[240:243], s[4:5] offset:0 sc1
    v_cvt_pk_bf16_f32 v244, v216, v217
    v_cvt_pk_bf16_f32 v245, v218, v219
    v_cvt_pk_bf16_f32 v246, v220, v221
    v_cvt_pk_bf16_f32 v247, v222, v223
    global_store_dwordx4 v8, v[244:247], s[4:5] offset:1024 sc1
    v_add_u32 v8, 229376, v8
    s_waitcnt lgkmcnt(8)
    v_mfma_f32_16x16x32_bf16 v[224:227], v[28:31], v[188:191], v[224:227]
    v_mfma_f32_16x16x32_bf16 v[228:231], v[60:63], v[188:191], v[228:231]
    v_mfma_f32_16x16x32_bf16 v[232:235], v[92:95], v[188:191], v[232:235]
    v_mfma_f32_16x16x32_bf16 v[236:239], v[124:127], v[188:191], v[236:239]
    s_waitcnt lgkmcnt(6)
    v_mfma_f32_16x16x32_bf16 v[224:227], v[32:35], v[192:195], v[224:227]
    v_mfma_f32_16x16x32_bf16 v[228:231], v[64:67], v[192:195], v[228:231]
    v_mfma_f32_16x16x32_bf16 v[232:235], v[96:99], v[192:195], v[232:235]
    v_mfma_f32_16x16x32_bf16 v[236:239], v[128:131], v[192:195], v[236:239]
    s_waitcnt lgkmcnt(4)
    v_mfma_f32_16x16x32_bf16 v[224:227], v[36:39], v[196:199], v[224:227]
    v_mfma_f32_16x16x32_bf16 v[228:231], v[68:71], v[196:199], v[228:231]
    v_mfma_f32_16x16x32_bf16 v[232:235], v[100:103], v[196:199], v[232:235]
    v_mfma_f32_16x16x32_bf16 v[236:239], v[132:135], v[196:199], v[236:239]
    s_waitcnt lgkmcnt(2)
    v_mfma_f32_16x16x32_bf16 v[224:227], v[40:43], v[200:203], v[224:227]
    v_mfma_f32_16x16x32_bf16 v[228:231], v[72:75], v[200:203], v[228:231]
    v_mfma_f32_16x16x32_bf16 v[232:235], v[104:107], v[200:203], v[232:235]
    v_mfma_f32_16x16x32_bf16 v[236:239], v[136:139], v[200:203], v[236:239]
    s_waitcnt lgkmcnt(0)
    v_mfma_f32_16x16x32_bf16 v[224:227], v[44:47], v[204:207], v[224:227]
    v_mfma_f32_16x16x32_bf16 v[228:231], v[76:79], v[204:207], v[228:231]
    v_mfma_f32_16x16x32_bf16 v[232:235], v[108:111], v[204:207], v[232:235]
    v_mfma_f32_16x16x32_bf16 v[236:239], v[140:143], v[204:207], v[236:239]
    s_nop 7
    s_nop 1
    v_cvt_pk_bf16_f32 v248, v224, v225
    v_cvt_pk_bf16_f32 v249, v226, v227
    v_cvt_pk_bf16_f32 v250, v228, v229
    v_cvt_pk_bf16_f32 v251, v230, v231
    global_store_dwordx4 v8, v[248:251], s[4:5] offset:0 sc1
    v_cvt_pk_bf16_f32 v252, v232, v233
    v_cvt_pk_bf16_f32 v253, v234, v235
    v_cvt_pk_bf16_f32 v254, v236, v237
    v_cvt_pk_bf16_f32 v255, v238, v239
    global_store_dwordx4 v8, v[252:255], s[4:5] offset:1024 sc1
    v_add_u32 v8, 229376, v8
    s_branch Q_done
Q_v1:
    v_add_u32 v8, 0, v7
    global_load_dwordx4 v[16:19], v8, s[16:17]
    v_add_u32 v8, 16384, v7
    global_load_dwordx4 v[20:23], v8, s[16:17]
    v_add_u32 v8, 65536, v7
    global_load_dwordx4 v[24:27], v8, s[16:17]
    v_add_u32 v8, 81920, v7
    global_load_dwordx4 v[28:31], v8, s[16:17]
    v_add_u32 v8, 131072, v7
    global_load_dwordx4 v[32:35], v8, s[16:17]
    v_add_u32 v8, 147456, v7
    global_load_dwordx4 v[36:39], v8, s[16:17]
    v_add_u32 v8, 196608, v7
    global_load_dwordx4 v[40:43], v8, s[16:17]
    v_add_u32 v8, 212992, v7
    global_load_dwordx4 v[44:47], v8, s[16:17]
    v_add_u32 v8, 32768, v7
    global_load_dwordx4 v[48:51], v8, s[16:17]
    v_add_u32 v8, 49152, v7
    global_load_dwordx4 v[52:55], v8, s[16:17]
    v_add_u32 v8, 98304, v7
    global_load_dwordx4 v[56:59], v8, s[16:17]
    v_add_u32 v8, 114688, v7
    global_load_dwordx4 v[60:63], v8, s[16:17]
    v_add_u32 v8, 163840, v7
    global_load_dwordx4 v[64:67], v8, s[16:17]
    v_add_u32 v8, 180224, v7
    global_load_dwordx4 v[68:71], v8, s[16:17]
    v_add_u32 v8, 229376, v7
    global_load_dwordx4 v[72:75], v8, s[16:17]
    v_add_u32 v8, 245760, v7
    global_load_dwordx4 v[76:79], v8, s[16:17]

    s_lshr_b32 s37, s2, 2
    s_and_b32 s38, s2, 3
    s_mul_i32 s37, s37, 28672
    s_mul_i32 s38, s38, 224
    s_add_u32 s37, s37, s38
    v_mul_u32_u24 v8, 896, v14
    v_lshl_add_u32 v8, v13, 4, v8
    v_add_u32 v8, s37, v8

    global_load_dwordx4 v[80:83], v8, s[8:9] offset:0
    global_load_dwordx4 v[84:87], v8, s[8:9] offset:3584
    v_add_u32 v8, 7168, v8
    global_load_dwordx4 v[88:91], v8, s[8:9] offset:0
    global_load_dwordx4 v[92:95], v8, s[8:9] offset:3584
    v_add_u32 v8, 7168, v8
    global_load_dwordx4 v[96:99], v8, s[8:9] offset:0
    global_load_dwordx4 v[100:103], v8, s[8:9] offset:3584
    v_add_u32 v8, 7168, v8
    global_load_dwordx4 v[104:107], v8, s[8:9] offset:0
    global_load_dwordx4 v[108:111], v8, s[8:9] offset:3584

    v_mov_b32 v240, -1
    v_mov_b32 v241, -1
    v_mov_b32 v242, -1
    v_mov_b32 v243, -1
    v_mov_b32 v244, 0
    v_mov_b32 v245, 0
    v_mov_b32 v246, 0
    v_mov_b32 v247, 0
    s_add_u32 s44, s4, 0xe84000
    s_addc_u32 s45, s5, 0
    s_and_b32 s45, s45, 0xffff
    s_mov_b32 s46, 2113536
    s_mov_b32 s47, 0x00020000
    s_add_u32 s48, s4, 0x1100000
    s_addc_u32 s49, s5, 0
    s_and_b32 s49, s49, 0xffff
    s_mov_b32 s50, 147456
    s_mov_b32 s51, 0x00020000
    s_add_u32 s52, s4, 0x1200000
    s_addc_u32 s53, s5, 0
    s_and_b32 s53, s53, 0xffff
    s_mov_b32 s54, 2621440
    s_mov_b32 s55, 0x00020000
    s_lshl_b32 s37, s2, 12
    v_lshl_add_u32 v248, v0, 4, s37
    v_add_u32 v249, 0x100000, v248
    v_add_u32 v250, 0x200000, v248

    buffer_store_dwordx4 v[244:247], v248, s[48:51], 0 offen sc1
    buffer_store_dwordx4 v[240:243], v248, s[44:47], 0 offen sc1
    buffer_store_dwordx4 v[240:243], v249, s[44:47], 0 offen sc1
    buffer_store_dwordx4 v[240:243], v250, s[44:47], 0 offen sc1
    buffer_store_dwordx4 v[240:243], v248, s[52:55], 0 offen sc1
    buffer_store_dwordx4 v[240:243], v249, s[52:55], 0 offen sc1
    buffer_store_dwordx4 v[240:243], v250, s[52:55], 0 offen sc1
    s_waitcnt vmcnt(38)
    ds_write_b128 v12, v[144:147] offset:0
    s_waitcnt vmcnt(37)
    ds_write_b128 v12, v[148:151] offset:1056
    s_waitcnt vmcnt(36)
    ds_write_b128 v12, v[152:155] offset:2112
    s_waitcnt vmcnt(35)
    ds_write_b128 v12, v[156:159] offset:3168
    s_waitcnt vmcnt(34)
    ds_write_b128 v12, v[160:163] offset:4224
    s_waitcnt vmcnt(33)
    ds_write_b128 v12, v[164:167] offset:5280
    s_waitcnt vmcnt(32)
    ds_write_b128 v12, v[168:171] offset:6336
    s_waitcnt vmcnt(31)
    ds_write_b128 v12, v[172:175] offset:7392
    s_waitcnt vmcnt(30)
    ds_write_b128 v9, v[16:19] offset:0
    s_waitcnt vmcnt(29)
    ds_write_b128 v9, v[20:23] offset:1056
    s_waitcnt vmcnt(28)
    ds_write_b128 v9, v[24:27] offset:2112
    s_waitcnt vmcnt(27)
    ds_write_b128 v9, v[28:31] offset:3168
    s_waitcnt vmcnt(26)
    ds_write_b128 v9, v[32:35] offset:4224
    s_waitcnt vmcnt(25)
    ds_write_b128 v9, v[36:39] offset:5280
    s_waitcnt vmcnt(24)
    ds_write_b128 v9, v[40:43] offset:6336
    s_waitcnt vmcnt(23)
    ds_write_b128 v9, v[44:47] offset:7392
    ds_read_b128 v[16:19], v10 offset:0
    ds_read_b128 v[20:23], v10 offset:64
    ds_read_b128 v[24:27], v10 offset:128
    ds_read_b128 v[28:31], v10 offset:192
    ds_read_b128 v[32:35], v10 offset:256
    ds_read_b128 v[36:39], v10 offset:320
    ds_read_b128 v[40:43], v10 offset:384
    ds_read_b128 v[44:47], v10 offset:448
    s_waitcnt vmcnt(22)
    ds_write_b128 v9, v[48:51] offset:0
    s_waitcnt vmcnt(21)
    ds_write_b128 v9, v[52:55] offset:1056
    s_waitcnt vmcnt(20)
    ds_write_b128 v9, v[56:59] offset:2112
    s_waitcnt vmcnt(19)
    ds_write_b128 v9, v[60:63] offset:3168
    s_waitcnt vmcnt(18)
    ds_write_b128 v9, v[64:67] offset:4224
    s_waitcnt vmcnt(17)
    ds_write_b128 v9, v[68:71] offset:5280
    s_waitcnt vmcnt(16)
    ds_write_b128 v9, v[72:75] offset:6336
    s_waitcnt vmcnt(15)
    ds_write_b128 v9, v[76:79] offset:7392
    ds_read_b128 v[48:51], v10 offset:0
    ds_read_b128 v[52:55], v10 offset:64
    ds_read_b128 v[56:59], v10 offset:128
    ds_read_b128 v[60:63], v10 offset:192
    ds_read_b128 v[64:67], v10 offset:256
    ds_read_b128 v[68:71], v10 offset:320
    ds_read_b128 v[72:75], v10 offset:384
    ds_read_b128 v[76:79], v10 offset:448

    v_mul_u32_u24 v8, 240, v14
    v_lshl_add_u32 v8, v13, 4, v8
    v_add_u32 v8, 129024, v8

    s_waitcnt vmcnt(14)
    ds_write_b128 v8, v[80:83] offset:0
    s_waitcnt vmcnt(13)
    ds_write_b128 v8, v[84:87] offset:960
    s_waitcnt vmcnt(12)
    ds_write_b128 v8, v[88:91] offset:1920
    s_waitcnt vmcnt(11)
    ds_write_b128 v8, v[92:95] offset:2880
    s_waitcnt vmcnt(10)
    ds_write_b128 v8, v[96:99] offset:3840
    s_waitcnt vmcnt(9)
    ds_write_b128 v8, v[100:103] offset:4800
    s_waitcnt vmcnt(8)
    ds_write_b128 v8, v[104:107] offset:5760
    s_waitcnt vmcnt(7)
    ds_write_b128 v8, v[108:111] offset:6720

    s_mul_i32 s37, s29, 392
    s_mul_i32 s38, s30, 56
    s_add_u32 s37, s37, s38
    s_add_u32 s37, s37, s32
    s_lshl_b32 s37, s37, 10
    v_lshl_add_u32 v8, v1, 4, s37
    s_mov_b32 s38, 0x3db8aa3b
    s_waitcnt lgkmcnt(0)
    s_barrier

    ds_read_b128 v[144:147], v11 offset:0
    ds_read_b128 v[148:151], v11 offset:64
    ds_read_b128 v[152:155], v11 offset:128
    ds_read_b128 v[156:159], v11 offset:192
    ds_read_b128 v[160:163], v11 offset:256
    ds_read_b128 v[164:167], v11 offset:320
    ds_read_b128 v[168:171], v11 offset:384
    ds_read_b128 v[172:175], v11 offset:448
    s_waitcnt lgkmcnt(7)
    v_mfma_f32_16x16x32_bf16 v[208:211], v[16:19], v[144:147], 0
    v_mfma_f32_16x16x32_bf16 v[212:215], v[48:51], v[144:147], 0
    ds_read_b128 v[176:179], v11 offset:8448
    s_waitcnt lgkmcnt(7)
    v_mfma_f32_16x16x32_bf16 v[208:211], v[20:23], v[148:151], v[208:211]
    v_mfma_f32_16x16x32_bf16 v[212:215], v[52:55], v[148:151], v[212:215]
    ds_read_b128 v[180:183], v11 offset:8512
    s_waitcnt lgkmcnt(7)
    v_mfma_f32_16x16x32_bf16 v[208:211], v[24:27], v[152:155], v[208:211]
    v_mfma_f32_16x16x32_bf16 v[212:215], v[56:59], v[152:155], v[212:215]
    ds_read_b128 v[184:187], v11 offset:8576
    s_waitcnt lgkmcnt(7)
    v_mfma_f32_16x16x32_bf16 v[208:211], v[28:31], v[156:159], v[208:211]
    v_mfma_f32_16x16x32_bf16 v[212:215], v[60:63], v[156:159], v[212:215]
    ds_read_b128 v[188:191], v11 offset:8640
    s_waitcnt lgkmcnt(7)
    v_mfma_f32_16x16x32_bf16 v[208:211], v[32:35], v[160:163], v[208:211]
    v_mfma_f32_16x16x32_bf16 v[212:215], v[64:67], v[160:163], v[212:215]
    ds_read_b128 v[192:195], v11 offset:8704
    s_waitcnt lgkmcnt(7)
    v_mfma_f32_16x16x32_bf16 v[208:211], v[36:39], v[164:167], v[208:211]
    v_mfma_f32_16x16x32_bf16 v[212:215], v[68:71], v[164:167], v[212:215]
    ds_read_b128 v[196:199], v11 offset:8768
    s_waitcnt lgkmcnt(7)
    v_mfma_f32_16x16x32_bf16 v[208:211], v[40:43], v[168:171], v[208:211]
    v_mfma_f32_16x16x32_bf16 v[212:215], v[72:75], v[168:171], v[212:215]
    ds_read_b128 v[200:203], v11 offset:8832
    s_waitcnt lgkmcnt(7)
    v_mfma_f32_16x16x32_bf16 v[208:211], v[44:47], v[172:175], v[208:211]
    v_mfma_f32_16x16x32_bf16 v[212:215], v[76:79], v[172:175], v[212:215]
    ds_read_b128 v[204:207], v11 offset:8896
    s_waitcnt lgkmcnt(7)
    v_mfma_f32_16x16x32_bf16 v[224:227], v[16:19], v[176:179], 0
    v_mfma_f32_16x16x32_bf16 v[228:231], v[48:51], v[176:179], 0
    ds_read_b128 v[144:147], v11 offset:16896
    s_waitcnt lgkmcnt(7)
    v_mfma_f32_16x16x32_bf16 v[224:227], v[20:23], v[180:183], v[224:227]
    v_mfma_f32_16x16x32_bf16 v[228:231], v[52:55], v[180:183], v[228:231]
    ds_read_b128 v[148:151], v11 offset:16960
    s_waitcnt lgkmcnt(7)
    v_mfma_f32_16x16x32_bf16 v[224:227], v[24:27], v[184:187], v[224:227]
    v_mfma_f32_16x16x32_bf16 v[228:231], v[56:59], v[184:187], v[228:231]
    ds_read_b128 v[152:155], v11 offset:17024
    v_mul_f32 v208, s38, v208
    v_mul_f32 v209, s38, v209
    v_mul_f32 v210, s38, v210
    v_mul_f32 v211, s38, v211
    v_mul_f32 v212, s38, v212
    v_mul_f32 v213, s38, v213
    v_mul_f32 v214, s38, v214
    v_mul_f32 v215, s38, v215
    v_cvt_pk_bf16_f32 v240, v208, v209
    v_cvt_pk_bf16_f32 v241, v210, v211
    v_cvt_pk_bf16_f32 v242, v212, v213
    v_cvt_pk_bf16_f32 v243, v214, v215
    global_store_dwordx4 v8, v[240:243], s[4:5] offset:0 sc1
    v_add_u32 v8, 14336, v8
    s_waitcnt lgkmcnt(7)
    v_mfma_f32_16x16x32_bf16 v[224:227], v[28:31], v[188:191], v[224:227]
    v_mfma_f32_16x16x32_bf16 v[228:231], v[60:63], v[188:191], v[228:231]
    ds_read_b128 v[156:159], v11 offset:17088
    s_waitcnt lgkmcnt(7)
    v_mfma_f32_16x16x32_bf16 v[224:227], v[32:35], v[192:195], v[224:227]
    v_mfma_f32_16x16x32_bf16 v[228:231], v[64:67], v[192:195], v[228:231]
    ds_read_b128 v[160:163], v11 offset:17152
    s_waitcnt lgkmcnt(7)
    v_mfma_f32_16x16x32_bf16 v[224:227], v[36:39], v[196:199], v[224:227]
    v_mfma_f32_16x16x32_bf16 v[228:231], v[68:71], v[196:199], v[228:231]
    ds_read_b128 v[164:167], v11 offset:17216
    s_waitcnt lgkmcnt(7)
    v_mfma_f32_16x16x32_bf16 v[224:227], v[40:43], v[200:203], v[224:227]
    v_mfma_f32_16x16x32_bf16 v[228:231], v[72:75], v[200:203], v[228:231]
    ds_read_b128 v[168:171], v11 offset:17280
    s_waitcnt lgkmcnt(7)
    v_mfma_f32_16x16x32_bf16 v[224:227], v[44:47], v[204:207], v[224:227]
    v_mfma_f32_16x16x32_bf16 v[228:231], v[76:79], v[204:207], v[228:231]
    ds_read_b128 v[172:175], v11 offset:17344
    s_waitcnt lgkmcnt(7)
    v_mfma_f32_16x16x32_bf16 v[208:211], v[16:19], v[144:147], 0
    v_mfma_f32_16x16x32_bf16 v[212:215], v[48:51], v[144:147], 0
    ds_read_b128 v[176:179], v11 offset:25344
    s_waitcnt lgkmcnt(7)
    v_mfma_f32_16x16x32_bf16 v[208:211], v[20:23], v[148:151], v[208:211]
    v_mfma_f32_16x16x32_bf16 v[212:215], v[52:55], v[148:151], v[212:215]
    ds_read_b128 v[180:183], v11 offset:25408
    s_waitcnt lgkmcnt(7)
    v_mfma_f32_16x16x32_bf16 v[208:211], v[24:27], v[152:155], v[208:211]
    v_mfma_f32_16x16x32_bf16 v[212:215], v[56:59], v[152:155], v[212:215]
    ds_read_b128 v[184:187], v11 offset:25472
    v_mul_f32 v224, s38, v224
    v_mul_f32 v225, s38, v225
    v_mul_f32 v226, s38, v226
    v_mul_f32 v227, s38, v227
    v_mul_f32 v228, s38, v228
    v_mul_f32 v229, s38, v229
    v_mul_f32 v230, s38, v230
    v_mul_f32 v231, s38, v231
    v_cvt_pk_bf16_f32 v248, v224, v225
    v_cvt_pk_bf16_f32 v249, v226, v227
    v_cvt_pk_bf16_f32 v250, v228, v229
    v_cvt_pk_bf16_f32 v251, v230, v231
    global_store_dwordx4 v8, v[248:251], s[4:5] offset:0 sc1
    v_add_u32 v8, 14336, v8
    s_waitcnt lgkmcnt(7)
    v_mfma_f32_16x16x32_bf16 v[208:211], v[28:31], v[156:159], v[208:211]
    v_mfma_f32_16x16x32_bf16 v[212:215], v[60:63], v[156:159], v[212:215]
    ds_read_b128 v[188:191], v11 offset:25536
    s_waitcnt lgkmcnt(7)
    v_mfma_f32_16x16x32_bf16 v[208:211], v[32:35], v[160:163], v[208:211]
    v_mfma_f32_16x16x32_bf16 v[212:215], v[64:67], v[160:163], v[212:215]
    ds_read_b128 v[192:195], v11 offset:25600
    s_waitcnt lgkmcnt(7)
    v_mfma_f32_16x16x32_bf16 v[208:211], v[36:39], v[164:167], v[208:211]
    v_mfma_f32_16x16x32_bf16 v[212:215], v[68:71], v[164:167], v[212:215]
    ds_read_b128 v[196:199], v11 offset:25664
    s_waitcnt lgkmcnt(7)
    v_mfma_f32_16x16x32_bf16 v[208:211], v[40:43], v[168:171], v[208:211]
    v_mfma_f32_16x16x32_bf16 v[212:215], v[72:75], v[168:171], v[212:215]
    ds_read_b128 v[200:203], v11 offset:25728
    s_waitcnt lgkmcnt(7)
    v_mfma_f32_16x16x32_bf16 v[208:211], v[44:47], v[172:175], v[208:211]
    v_mfma_f32_16x16x32_bf16 v[212:215], v[76:79], v[172:175], v[212:215]
    ds_read_b128 v[204:207], v11 offset:25792
    s_waitcnt lgkmcnt(7)
    v_mfma_f32_16x16x32_bf16 v[224:227], v[16:19], v[176:179], 0
    v_mfma_f32_16x16x32_bf16 v[228:231], v[48:51], v[176:179], 0
    s_waitcnt lgkmcnt(6)
    v_mfma_f32_16x16x32_bf16 v[224:227], v[20:23], v[180:183], v[224:227]
    v_mfma_f32_16x16x32_bf16 v[228:231], v[52:55], v[180:183], v[228:231]
    s_waitcnt lgkmcnt(5)
    v_mfma_f32_16x16x32_bf16 v[224:227], v[24:27], v[184:187], v[224:227]
    v_mfma_f32_16x16x32_bf16 v[228:231], v[56:59], v[184:187], v[228:231]
    v_mul_f32 v208, s38, v208
    v_mul_f32 v209, s38, v209
    v_mul_f32 v210, s38, v210
    v_mul_f32 v211, s38, v211
    v_mul_f32 v212, s38, v212
    v_mul_f32 v213, s38, v213
    v_mul_f32 v214, s38, v214
    v_mul_f32 v215, s38, v215
    v_cvt_pk_bf16_f32 v240, v208, v209
    v_cvt_pk_bf16_f32 v241, v210, v211
    v_cvt_pk_bf16_f32 v242, v212, v213
    v_cvt_pk_bf16_f32 v243, v214, v215
    global_store_dwordx4 v8, v[240:243], s[4:5] offset:0 sc1
    v_add_u32 v8, 14336, v8
    s_waitcnt lgkmcnt(4)
    v_mfma_f32_16x16x32_bf16 v[224:227], v[28:31], v[188:191], v[224:227]
    v_mfma_f32_16x16x32_bf16 v[228:231], v[60:63], v[188:191], v[228:231]
    s_waitcnt lgkmcnt(3)
    v_mfma_f32_16x16x32_bf16 v[224:227], v[32:35], v[192:195], v[224:227]
    v_mfma_f32_16x16x32_bf16 v[228:231], v[64:67], v[192:195], v[228:231]
    s_waitcnt lgkmcnt(2)
    v_mfma_f32_16x16x32_bf16 v[224:227], v[36:39], v[196:199], v[224:227]
    v_mfma_f32_16x16x32_bf16 v[228:231], v[68:71], v[196:199], v[228:231]
    s_waitcnt lgkmcnt(1)
    v_mfma_f32_16x16x32_bf16 v[224:227], v[40:43], v[200:203], v[224:227]
    v_mfma_f32_16x16x32_bf16 v[228:231], v[72:75], v[200:203], v[228:231]
    s_waitcnt lgkmcnt(0)
    v_mfma_f32_16x16x32_bf16 v[224:227], v[44:47], v[204:207], v[224:227]
    v_mfma_f32_16x16x32_bf16 v[228:231], v[76:79], v[204:207], v[228:231]
    s_nop 7
    s_nop 1
    v_mul_f32 v224, s38, v224
    v_mul_f32 v225, s38, v225
    v_mul_f32 v226, s38, v226
    v_mul_f32 v227, s38, v227
    v_mul_f32 v228, s38, v228
    v_mul_f32 v229, s38, v229
    v_mul_f32 v230, s38, v230
    v_mul_f32 v231, s38, v231
    v_cvt_pk_bf16_f32 v248, v224, v225
    v_cvt_pk_bf16_f32 v249, v226, v227
    v_cvt_pk_bf16_f32 v250, v228, v229
    v_cvt_pk_bf16_f32 v251, v230, v231
    global_store_dwordx4 v8, v[248:251], s[4:5] offset:0 sc1
    v_add_u32 v8, 14336, v8
    v_add_u32 v6, 0, v7
    global_load_dwordx4 a[0:3], v6, s[20:21]
    v_add_u32 v6, 16384, v7
    global_load_dwordx4 a[4:7], v6, s[20:21]
    v_add_u32 v6, 65536, v7
    global_load_dwordx4 a[8:11], v6, s[20:21]
    v_add_u32 v6, 81920, v7
    global_load_dwordx4 a[12:15], v6, s[20:21]
    v_add_u32 v6, 131072, v7
    global_load_dwordx4 a[16:19], v6, s[20:21]
    v_add_u32 v6, 147456, v7
    global_load_dwordx4 a[20:23], v6, s[20:21]
    v_add_u32 v6, 196608, v7
    global_load_dwordx4 a[24:27], v6, s[20:21]
    v_add_u32 v6, 212992, v7
    global_load_dwordx4 a[28:31], v6, s[20:21]
    v_add_u32 v6, 32768, v7
    global_load_dwordx4 a[32:35], v6, s[20:21]
    v_add_u32 v6, 49152, v7
    global_load_dwordx4 a[36:39], v6, s[20:21]
    v_add_u32 v6, 98304, v7
    global_load_dwordx4 a[40:43], v6, s[20:21]
    v_add_u32 v6, 114688, v7
    global_load_dwordx4 a[44:47], v6, s[20:21]
    v_add_u32 v6, 163840, v7
    global_load_dwordx4 a[48:51], v6, s[20:21]
    v_add_u32 v6, 180224, v7
    global_load_dwordx4 a[52:55], v6, s[20:21]
    v_add_u32 v6, 229376, v7
    global_load_dwordx4 a[56:59], v6, s[20:21]
    v_add_u32 v6, 245760, v7
    global_load_dwordx4 a[60:63], v6, s[20:21]
    s_waitcnt vmcnt(16)
    s_barrier
    global_load_dwordx4 a[128:131], v2, s[22:23]
    v_add_u32 v2, 7168, v2
    global_load_dwordx4 a[132:135], v2, s[22:23]
    v_add_u32 v2, 7168, v2
    global_load_dwordx4 a[136:139], v2, s[22:23]
    v_add_u32 v2, 7168, v2
    global_load_dwordx4 a[140:143], v2, s[22:23]
    v_add_u32 v2, 7168, v2
    global_load_dwordx4 a[144:147], v2, s[22:23]
    v_add_u32 v2, 7168, v2
    global_load_dwordx4 a[148:151], v2, s[22:23]
    v_add_u32 v2, 7168, v2
    global_load_dwordx4 a[152:155], v2, s[22:23]
    v_add_u32 v2, 7168, v2
    global_load_dwordx4 a[156:159], v2, s[22:23]
    v_add_u32 v2, 7168, v2
    s_waitcnt vmcnt(23)
    ds_write_b128 v9, a[0:3] offset:0
    s_waitcnt vmcnt(22)
    ds_write_b128 v9, a[4:7] offset:1056
    s_waitcnt vmcnt(21)
    ds_write_b128 v9, a[8:11] offset:2112
    s_waitcnt vmcnt(20)
    ds_write_b128 v9, a[12:15] offset:3168
    s_waitcnt vmcnt(19)
    ds_write_b128 v9, a[16:19] offset:4224
    s_waitcnt vmcnt(18)
    ds_write_b128 v9, a[20:23] offset:5280
    s_waitcnt vmcnt(17)
    ds_write_b128 v9, a[24:27] offset:6336
    s_waitcnt vmcnt(16)
    ds_write_b128 v9, a[28:31] offset:7392
    ds_read_b128 v[16:19], v10 offset:0
    ds_read_b128 v[20:23], v10 offset:64
    ds_read_b128 v[24:27], v10 offset:128
    ds_read_b128 v[28:31], v10 offset:192
    ds_read_b128 v[32:35], v10 offset:256
    ds_read_b128 v[36:39], v10 offset:320
    ds_read_b128 v[40:43], v10 offset:384
    ds_read_b128 v[44:47], v10 offset:448
    s_waitcnt vmcnt(15)
    ds_write_b128 v9, a[32:35] offset:0
    s_waitcnt vmcnt(14)
    ds_write_b128 v9, a[36:39] offset:1056
    s_waitcnt vmcnt(13)
    ds_write_b128 v9, a[40:43] offset:2112
    s_waitcnt vmcnt(12)
    ds_write_b128 v9, a[44:47] offset:3168
    s_waitcnt vmcnt(11)
    ds_write_b128 v9, a[48:51] offset:4224
    s_waitcnt vmcnt(10)
    ds_write_b128 v9, a[52:55] offset:5280
    s_waitcnt vmcnt(9)
    ds_write_b128 v9, a[56:59] offset:6336
    s_waitcnt vmcnt(8)
    ds_write_b128 v9, a[60:63] offset:7392
    ds_read_b128 v[48:51], v10 offset:0
    ds_read_b128 v[52:55], v10 offset:64
    ds_read_b128 v[56:59], v10 offset:128
    ds_read_b128 v[60:63], v10 offset:192
    ds_read_b128 v[64:67], v10 offset:256
    ds_read_b128 v[68:71], v10 offset:320
    ds_read_b128 v[72:75], v10 offset:384
    ds_read_b128 v[76:79], v10 offset:448
    s_waitcnt vmcnt(7)
    ds_write_b128 v15, a[128:131] offset:0
    s_waitcnt vmcnt(6)
    ds_write_b128 v15, a[132:135] offset:1920
    s_waitcnt vmcnt(5)
    ds_write_b128 v15, a[136:139] offset:3840
    s_waitcnt vmcnt(4)
    ds_write_b128 v15, a[140:143] offset:5760
    s_waitcnt vmcnt(3)
    ds_write_b128 v15, a[144:147] offset:7680
    s_waitcnt vmcnt(2)
    ds_write_b128 v15, a[148:151] offset:9600
    s_waitcnt vmcnt(1)
    ds_write_b128 v15, a[152:155] offset:11520
    s_waitcnt vmcnt(0)
    ds_write_b128 v15, a[156:159] offset:13440

    v_lshrrev_b32 v12, 2, v3
    v_lshl_add_u32 v12, v4, 3, v12
    v_mul_u32_u24 v12, 240, v12
    v_and_b32 v8, 3, v3
    v_lshl_add_u32 v12, v8, 3, v12
    v_add_u32 v12, 67584, v12
    s_lshl_b32 s37, s30, 6
    s_add_u32 s37, s37, s29
    s_mul_i32 s37, s37, 14
    s_add_u32 s37, s37, s32
    s_lshl_b32 s37, s37, 10
    s_add_u32 s37, s37, 0x640000
    v_lshl_add_u32 v8, v1, 4, s37
    s_waitcnt vmcnt(0) lgkmcnt(0)
    s_barrier

    ds_read_b64_tr_b16 v[144:145], v12 offset:0
    ds_read_b64_tr_b16 v[146:147], v12 offset:960
    ds_read_b64_tr_b16 v[148:149], v12 offset:7680
    ds_read_b64_tr_b16 v[150:151], v12 offset:8640
    ds_read_b64_tr_b16 v[152:153], v12 offset:15360
    ds_read_b64_tr_b16 v[154:155], v12 offset:16320
    ds_read_b64_tr_b16 v[156:157], v12 offset:23040
    ds_read_b64_tr_b16 v[158:159], v12 offset:24000
    ds_read_b64_tr_b16 v[160:161], v12 offset:30720
    ds_read_b64_tr_b16 v[162:163], v12 offset:31680
    ds_read_b64_tr_b16 v[164:165], v12 offset:38400
    ds_read_b64_tr_b16 v[166:167], v12 offset:39360
    ds_read_b64_tr_b16 v[168:169], v12 offset:46080
    ds_read_b64_tr_b16 v[170:171], v12 offset:47040
    ds_read_b64_tr_b16 v[172:173], v12 offset:53760
    ds_read_b64_tr_b16 v[174:175], v12 offset:54720
    s_waitcnt lgkmcnt(14)
    v_mfma_f32_16x16x32_bf16 v[208:211], v[16:19], v[144:147], 0
    v_mfma_f32_16x16x32_bf16 v[212:215], v[48:51], v[144:147], 0
    ds_read_b64_tr_b16 v[176:177], v12 offset:32
    ds_read_b64_tr_b16 v[178:179], v12 offset:992
    s_waitcnt lgkmcnt(14)
    v_mfma_f32_16x16x32_bf16 v[208:211], v[20:23], v[148:151], v[208:211]
    v_mfma_f32_16x16x32_bf16 v[212:215], v[52:55], v[148:151], v[212:215]
    ds_read_b64_tr_b16 v[180:181], v12 offset:7712
    ds_read_b64_tr_b16 v[182:183], v12 offset:8672
    s_waitcnt lgkmcnt(14)
    v_mfma_f32_16x16x32_bf16 v[208:211], v[24:27], v[152:155], v[208:211]
    v_mfma_f32_16x16x32_bf16 v[212:215], v[56:59], v[152:155], v[212:215]
    ds_read_b64_tr_b16 v[184:185], v12 offset:15392
    ds_read_b64_tr_b16 v[186:187], v12 offset:16352
    s_waitcnt lgkmcnt(14)
    v_mfma_f32_16x16x32_bf16 v[208:211], v[28:31], v[156:159], v[208:211]
    v_mfma_f32_16x16x32_bf16 v[212:215], v[60:63], v[156:159], v[212:215]
    ds_read_b64_tr_b16 v[188:189], v12 offset:23072
    ds_read_b64_tr_b16 v[190:191], v12 offset:24032
    s_waitcnt lgkmcnt(14)
    v_mfma_f32_16x16x32_bf16 v[208:211], v[32:35], v[160:163], v[208:211]
    v_mfma_f32_16x16x32_bf16 v[212:215], v[64:67], v[160:163], v[212:215]
    ds_read_b64_tr_b16 v[192:193], v12 offset:30752
    ds_read_b64_tr_b16 v[194:195], v12 offset:31712
    s_waitcnt lgkmcnt(14)
    v_mfma_f32_16x16x32_bf16 v[208:211], v[36:39], v[164:167], v[208:211]
    v_mfma_f32_16x16x32_bf16 v[212:215], v[68:71], v[164:167], v[212:215]
    ds_read_b64_tr_b16 v[196:197], v12 offset:38432
    ds_read_b64_tr_b16 v[198:199], v12 offset:39392
    s_waitcnt lgkmcnt(14)
    v_mfma_f32_16x16x32_bf16 v[208:211], v[40:43], v[168:171], v[208:211]
    v_mfma_f32_16x16x32_bf16 v[212:215], v[72:75], v[168:171], v[212:215]
    ds_read_b64_tr_b16 v[200:201], v12 offset:46112
    ds_read_b64_tr_b16 v[202:203], v12 offset:47072
    s_waitcnt lgkmcnt(14)
    v_mfma_f32_16x16x32_bf16 v[208:211], v[44:47], v[172:175], v[208:211]
    v_mfma_f32_16x16x32_bf16 v[212:215], v[76:79], v[172:175], v[212:215]
    ds_read_b64_tr_b16 v[204:205], v12 offset:53792
    ds_read_b64_tr_b16 v[206:207], v12 offset:54752
    s_waitcnt lgkmcnt(14)
    v_mfma_f32_16x16x32_bf16 v[224:227], v[16:19], v[176:179], 0
    v_mfma_f32_16x16x32_bf16 v[228:231], v[48:51], v[176:179], 0
    ds_read_b64_tr_b16 v[144:145], v12 offset:64
    ds_read_b64_tr_b16 v[146:147], v12 offset:1024
    s_waitcnt lgkmcnt(14)
    v_mfma_f32_16x16x32_bf16 v[224:227], v[20:23], v[180:183], v[224:227]
    v_mfma_f32_16x16x32_bf16 v[228:231], v[52:55], v[180:183], v[228:231]
    ds_read_b64_tr_b16 v[148:149], v12 offset:7744
    ds_read_b64_tr_b16 v[150:151], v12 offset:8704
    s_waitcnt lgkmcnt(14)
    v_mfma_f32_16x16x32_bf16 v[224:227], v[24:27], v[184:187], v[224:227]
    v_mfma_f32_16x16x32_bf16 v[228:231], v[56:59], v[184:187], v[228:231]
    ds_read_b64_tr_b16 v[152:153], v12 offset:15424
    ds_read_b64_tr_b16 v[154:155], v12 offset:16384
    v_cvt_pk_bf16_f32 v240, v208, v209
    v_cvt_pk_bf16_f32 v241, v210, v211
    v_cvt_pk_bf16_f32 v242, v212, v213
    v_cvt_pk_bf16_f32 v243, v214, v215
    global_store_dwordx4 v8, v[240:243], s[4:5] offset:0 sc1
    v_add_u32 v8, 229376, v8
    s_waitcnt lgkmcnt(14)
    v_mfma_f32_16x16x32_bf16 v[224:227], v[28:31], v[188:191], v[224:227]
    v_mfma_f32_16x16x32_bf16 v[228:231], v[60:63], v[188:191], v[228:231]
    ds_read_b64_tr_b16 v[156:157], v12 offset:23104
    ds_read_b64_tr_b16 v[158:159], v12 offset:24064
    s_waitcnt lgkmcnt(14)
    v_mfma_f32_16x16x32_bf16 v[224:227], v[32:35], v[192:195], v[224:227]
    v_mfma_f32_16x16x32_bf16 v[228:231], v[64:67], v[192:195], v[228:231]
    ds_read_b64_tr_b16 v[160:161], v12 offset:30784
    ds_read_b64_tr_b16 v[162:163], v12 offset:31744
    s_waitcnt lgkmcnt(14)
    v_mfma_f32_16x16x32_bf16 v[224:227], v[36:39], v[196:199], v[224:227]
    v_mfma_f32_16x16x32_bf16 v[228:231], v[68:71], v[196:199], v[228:231]
    ds_read_b64_tr_b16 v[164:165], v12 offset:38464
    ds_read_b64_tr_b16 v[166:167], v12 offset:39424
    s_waitcnt lgkmcnt(14)
    v_mfma_f32_16x16x32_bf16 v[224:227], v[40:43], v[200:203], v[224:227]
    v_mfma_f32_16x16x32_bf16 v[228:231], v[72:75], v[200:203], v[228:231]
    ds_read_b64_tr_b16 v[168:169], v12 offset:46144
    ds_read_b64_tr_b16 v[170:171], v12 offset:47104
    s_waitcnt lgkmcnt(14)
    v_mfma_f32_16x16x32_bf16 v[224:227], v[44:47], v[204:207], v[224:227]
    v_mfma_f32_16x16x32_bf16 v[228:231], v[76:79], v[204:207], v[228:231]
    ds_read_b64_tr_b16 v[172:173], v12 offset:53824
    ds_read_b64_tr_b16 v[174:175], v12 offset:54784
    s_waitcnt lgkmcnt(14)
    v_mfma_f32_16x16x32_bf16 v[208:211], v[16:19], v[144:147], 0
    v_mfma_f32_16x16x32_bf16 v[212:215], v[48:51], v[144:147], 0
    ds_read_b64_tr_b16 v[176:177], v12 offset:96
    ds_read_b64_tr_b16 v[178:179], v12 offset:1056
    s_waitcnt lgkmcnt(14)
    v_mfma_f32_16x16x32_bf16 v[208:211], v[20:23], v[148:151], v[208:211]
    v_mfma_f32_16x16x32_bf16 v[212:215], v[52:55], v[148:151], v[212:215]
    ds_read_b64_tr_b16 v[180:181], v12 offset:7776
    ds_read_b64_tr_b16 v[182:183], v12 offset:8736
    s_waitcnt lgkmcnt(14)
    v_mfma_f32_16x16x32_bf16 v[208:211], v[24:27], v[152:155], v[208:211]
    v_mfma_f32_16x16x32_bf16 v[212:215], v[56:59], v[152:155], v[212:215]
    ds_read_b64_tr_b16 v[184:185], v12 offset:15456
    ds_read_b64_tr_b16 v[186:187], v12 offset:16416
    v_cvt_pk_bf16_f32 v248, v224, v225
    v_cvt_pk_bf16_f32 v249, v226, v227
    v_cvt_pk_bf16_f32 v250, v228, v229
    v_cvt_pk_bf16_f32 v251, v230, v231
    global_store_dwordx4 v8, v[248:251], s[4:5] offset:0 sc1
    v_add_u32 v8, 229376, v8
    s_waitcnt lgkmcnt(14)
    v_mfma_f32_16x16x32_bf16 v[208:211], v[28:31], v[156:159], v[208:211]
    v_mfma_f32_16x16x32_bf16 v[212:215], v[60:63], v[156:159], v[212:215]
    ds_read_b64_tr_b16 v[188:189], v12 offset:23136
    ds_read_b64_tr_b16 v[190:191], v12 offset:24096
    s_waitcnt lgkmcnt(14)
    v_mfma_f32_16x16x32_bf16 v[208:211], v[32:35], v[160:163], v[208:211]
    v_mfma_f32_16x16x32_bf16 v[212:215], v[64:67], v[160:163], v[212:215]
    ds_read_b64_tr_b16 v[192:193], v12 offset:30816
    ds_read_b64_tr_b16 v[194:195], v12 offset:31776
    s_waitcnt lgkmcnt(14)
    v_mfma_f32_16x16x32_bf16 v[208:211], v[36:39], v[164:167], v[208:211]
    v_mfma_f32_16x16x32_bf16 v[212:215], v[68:71], v[164:167], v[212:215]
    ds_read_b64_tr_b16 v[196:197], v12 offset:38496
    ds_read_b64_tr_b16 v[198:199], v12 offset:39456
    s_waitcnt lgkmcnt(14)
    v_mfma_f32_16x16x32_bf16 v[208:211], v[40:43], v[168:171], v[208:211]
    v_mfma_f32_16x16x32_bf16 v[212:215], v[72:75], v[168:171], v[212:215]
    ds_read_b64_tr_b16 v[200:201], v12 offset:46176
    ds_read_b64_tr_b16 v[202:203], v12 offset:47136
    s_waitcnt lgkmcnt(14)
    v_mfma_f32_16x16x32_bf16 v[208:211], v[44:47], v[172:175], v[208:211]
    v_mfma_f32_16x16x32_bf16 v[212:215], v[76:79], v[172:175], v[212:215]
    ds_read_b64_tr_b16 v[204:205], v12 offset:53856
    ds_read_b64_tr_b16 v[206:207], v12 offset:54816
    s_waitcnt lgkmcnt(14)
    v_mfma_f32_16x16x32_bf16 v[224:227], v[16:19], v[176:179], 0
    v_mfma_f32_16x16x32_bf16 v[228:231], v[48:51], v[176:179], 0
    s_waitcnt lgkmcnt(12)
    v_mfma_f32_16x16x32_bf16 v[224:227], v[20:23], v[180:183], v[224:227]
    v_mfma_f32_16x16x32_bf16 v[228:231], v[52:55], v[180:183], v[228:231]
    s_waitcnt lgkmcnt(10)
    v_mfma_f32_16x16x32_bf16 v[224:227], v[24:27], v[184:187], v[224:227]
    v_mfma_f32_16x16x32_bf16 v[228:231], v[56:59], v[184:187], v[228:231]
    v_cvt_pk_bf16_f32 v240, v208, v209
    v_cvt_pk_bf16_f32 v241, v210, v211
    v_cvt_pk_bf16_f32 v242, v212, v213
    v_cvt_pk_bf16_f32 v243, v214, v215
    global_store_dwordx4 v8, v[240:243], s[4:5] offset:0 sc1
    v_add_u32 v8, 229376, v8
    s_waitcnt lgkmcnt(8)
    v_mfma_f32_16x16x32_bf16 v[224:227], v[28:31], v[188:191], v[224:227]
    v_mfma_f32_16x16x32_bf16 v[228:231], v[60:63], v[188:191], v[228:231]
    s_waitcnt lgkmcnt(6)
    v_mfma_f32_16x16x32_bf16 v[224:227], v[32:35], v[192:195], v[224:227]
    v_mfma_f32_16x16x32_bf16 v[228:231], v[64:67], v[192:195], v[228:231]
    s_waitcnt lgkmcnt(4)
    v_mfma_f32_16x16x32_bf16 v[224:227], v[36:39], v[196:199], v[224:227]
    v_mfma_f32_16x16x32_bf16 v[228:231], v[68:71], v[196:199], v[228:231]
    s_waitcnt lgkmcnt(2)
    v_mfma_f32_16x16x32_bf16 v[224:227], v[40:43], v[200:203], v[224:227]
    v_mfma_f32_16x16x32_bf16 v[228:231], v[72:75], v[200:203], v[228:231]
    s_waitcnt lgkmcnt(0)
    v_mfma_f32_16x16x32_bf16 v[224:227], v[44:47], v[204:207], v[224:227]
    v_mfma_f32_16x16x32_bf16 v[228:231], v[76:79], v[204:207], v[228:231]
    s_nop 7
    s_nop 1
    v_cvt_pk_bf16_f32 v248, v224, v225
    v_cvt_pk_bf16_f32 v249, v226, v227
    v_cvt_pk_bf16_f32 v250, v228, v229
    v_cvt_pk_bf16_f32 v251, v230, v231
    global_store_dwordx4 v8, v[248:251], s[4:5] offset:0 sc1
    v_add_u32 v8, 229376, v8
    s_branch Q_xa
Q_c0:
    s_cmp_eq_u32 s3, 3
    s_cbranch_scc1 Q_c3

    v_mov_b32 v240, -1
    v_mov_b32 v241, -1
    v_mov_b32 v242, -1
    v_mov_b32 v243, -1
    v_mov_b32 v244, 0
    v_mov_b32 v245, 0
    v_mov_b32 v246, 0
    v_mov_b32 v247, 0
    s_add_u32 s44, s4, 0xe84000
    s_addc_u32 s45, s5, 0
    s_and_b32 s45, s45, 0xffff
    s_mov_b32 s46, 2113536
    s_mov_b32 s47, 0x00020000
    s_add_u32 s48, s4, 0x1100000
    s_addc_u32 s49, s5, 0
    s_and_b32 s49, s49, 0xffff
    s_mov_b32 s50, 147456
    s_mov_b32 s51, 0x00020000
    s_add_u32 s52, s4, 0x1200000
    s_addc_u32 s53, s5, 0
    s_and_b32 s53, s53, 0xffff
    s_mov_b32 s54, 2621440
    s_mov_b32 s55, 0x00020000
    s_lshl_b32 s37, s2, 12
    v_lshl_add_u32 v248, v0, 4, s37
    v_add_u32 v249, 0x100000, v248
    v_add_u32 v250, 0x200000, v248

    buffer_store_dwordx4 v[244:247], v248, s[48:51], 0 offen sc1
    buffer_store_dwordx4 v[240:243], v248, s[44:47], 0 offen sc1
    buffer_store_dwordx4 v[240:243], v249, s[44:47], 0 offen sc1
    buffer_store_dwordx4 v[240:243], v250, s[44:47], 0 offen sc1
    buffer_store_dwordx4 v[240:243], v248, s[52:55], 0 offen sc1
    buffer_store_dwordx4 v[240:243], v249, s[52:55], 0 offen sc1
    buffer_store_dwordx4 v[240:243], v250, s[52:55], 0 offen sc1
    s_waitcnt vmcnt(7)

    s_cmp_lg_u32 s2, 248
    s_cbranch_scc1 Q_nomem0
    v_mov_b32 v208, v0
    v_accvgpr_read_b32 v216, a0
    v_accvgpr_read_b32 v217, a1
    v_accvgpr_read_b32 v218, a2
    v_accvgpr_read_b32 v219, a3
Q_mem0:
    v_mul_u32_u24 v209, 1171, v208
    v_lshrrev_b32 v209, 16, v209
    v_mul_u32_u24 v210, 56, v209
    v_sub_u32 v210, v208, v210
    v_lshrrev_b32 v211, 2, v210
    v_lshlrev_b32 v211, 9, v211
    v_lshl_add_u32 v211, v209, 4, v211
    v_and_b32 v212, 3, v210
    v_lshl_add_u32 v211, v212, 7, v211
    v_add_u32 v211, 0xe82000, v211
    v_lshrrev_b32 v213, 1, v210
    v_lshlrev_b32 v213, 8, v213
    v_lshl_add_u32 v213, v209, 4, v213
    v_and_b32 v212, 1, v210
    v_lshl_add_u32 v213, v212, 3, v213
    v_add_u32 v213, 0xe80000, v213
    global_store_dwordx4 v211, v[216:219], s[4:5] sc1
    global_store_dword v213, v216, s[4:5] sc1
    global_store_dword v213, v217, s[4:5] offset:128 sc1
    global_store_dword v213, v218, s[4:5] offset:4 sc1
    global_store_dword v213, v219, s[4:5] offset:132 sc1
    v_readfirstlane_b32 s37, v208
    v_add_u32 v208, 256, v208
    s_nop 1
    v_accvgpr_read_b32 v216, a4
    v_accvgpr_read_b32 v217, a5
    v_accvgpr_read_b32 v218, a6
    v_accvgpr_read_b32 v219, a7
    s_cmp_lt_u32 s37, 192
    s_cbranch_scc1 Q_mem0
Q_nomem0:

    s_branch Q_done
Q_c3:

    s_lshr_b32 s37, s2, 2
    s_and_b32 s38, s2, 3
    s_mul_i32 s37, s37, 28672
    s_mul_i32 s38, s38, 224
    s_add_u32 s37, s37, s38
    v_mul_u32_u24 v8, 896, v14
    v_lshl_add_u32 v8, v13, 4, v8
    v_add_u32 v8, s37, v8

    global_load_dwordx4 v[80:83], v8, s[8:9] offset:0
    global_load_dwordx4 v[84:87], v8, s[8:9] offset:3584
    v_add_u32 v8, 7168, v8
    global_load_dwordx4 v[88:91], v8, s[8:9] offset:0
    global_load_dwordx4 v[92:95], v8, s[8:9] offset:3584
    v_add_u32 v8, 7168, v8
    global_load_dwordx4 v[96:99], v8, s[8:9] offset:0
    global_load_dwordx4 v[100:103], v8, s[8:9] offset:3584
    v_add_u32 v8, 7168, v8
    global_load_dwordx4 v[104:107], v8, s[8:9] offset:0
    global_load_dwordx4 v[108:111], v8, s[8:9] offset:3584

    v_mov_b32 v240, -1
    v_mov_b32 v241, -1
    v_mov_b32 v242, -1
    v_mov_b32 v243, -1
    v_mov_b32 v244, 0
    v_mov_b32 v245, 0
    v_mov_b32 v246, 0
    v_mov_b32 v247, 0
    s_add_u32 s44, s4, 0xe84000
    s_addc_u32 s45, s5, 0
    s_and_b32 s45, s45, 0xffff
    s_mov_b32 s46, 2113536
    s_mov_b32 s47, 0x00020000
    s_add_u32 s48, s4, 0x1100000
    s_addc_u32 s49, s5, 0
    s_and_b32 s49, s49, 0xffff
    s_mov_b32 s50, 147456
    s_mov_b32 s51, 0x00020000
    s_add_u32 s52, s4, 0x1200000
    s_addc_u32 s53, s5, 0
    s_and_b32 s53, s53, 0xffff
    s_mov_b32 s54, 2621440
    s_mov_b32 s55, 0x00020000
    s_lshl_b32 s37, s2, 12
    v_lshl_add_u32 v248, v0, 4, s37
    v_add_u32 v249, 0x100000, v248
    v_add_u32 v250, 0x200000, v248

    buffer_store_dwordx4 v[244:247], v248, s[48:51], 0 offen sc1
    buffer_store_dwordx4 v[240:243], v248, s[44:47], 0 offen sc1
    buffer_store_dwordx4 v[240:243], v249, s[44:47], 0 offen sc1
    buffer_store_dwordx4 v[240:243], v250, s[44:47], 0 offen sc1
    buffer_store_dwordx4 v[240:243], v248, s[52:55], 0 offen sc1
    buffer_store_dwordx4 v[240:243], v249, s[52:55], 0 offen sc1
    buffer_store_dwordx4 v[240:243], v250, s[52:55], 0 offen sc1

    v_mul_u32_u24 v8, 240, v14
    v_lshl_add_u32 v8, v13, 4, v8
    v_add_u32 v8, 129024, v8

    s_waitcnt vmcnt(14)
    ds_write_b128 v8, v[80:83] offset:0
    s_waitcnt vmcnt(13)
    ds_write_b128 v8, v[84:87] offset:960
    s_waitcnt vmcnt(12)
    ds_write_b128 v8, v[88:91] offset:1920
    s_waitcnt vmcnt(11)
    ds_write_b128 v8, v[92:95] offset:2880
    s_waitcnt vmcnt(10)
    ds_write_b128 v8, v[96:99] offset:3840
    s_waitcnt vmcnt(9)
    ds_write_b128 v8, v[100:103] offset:4800
    s_waitcnt vmcnt(8)
    ds_write_b128 v8, v[104:107] offset:5760
    s_waitcnt vmcnt(7)
    ds_write_b128 v8, v[108:111] offset:6720

    s_cmp_lg_u32 s2, 248
    s_cbranch_scc1 Q_nomem1
    v_mov_b32 v208, v0
    v_accvgpr_read_b32 v216, a0
    v_accvgpr_read_b32 v217, a1
    v_accvgpr_read_b32 v218, a2
    v_accvgpr_read_b32 v219, a3
Q_mem1:
    v_mul_u32_u24 v209, 1171, v208
    v_lshrrev_b32 v209, 16, v209
    v_mul_u32_u24 v210, 56, v209
    v_sub_u32 v210, v208, v210
    v_lshrrev_b32 v211, 2, v210
    v_lshlrev_b32 v211, 9, v211
    v_lshl_add_u32 v211, v209, 4, v211
    v_and_b32 v212, 3, v210
    v_lshl_add_u32 v211, v212, 7, v211
    v_add_u32 v211, 0xe82000, v211
    v_lshrrev_b32 v213, 1, v210
    v_lshlrev_b32 v213, 8, v213
    v_lshl_add_u32 v213, v209, 4, v213
    v_and_b32 v212, 1, v210
    v_lshl_add_u32 v213, v212, 3, v213
    v_add_u32 v213, 0xe80000, v213
    global_store_dwordx4 v211, v[216:219], s[4:5] sc1
    global_store_dword v213, v216, s[4:5] sc1
    global_store_dword v213, v217, s[4:5] offset:128 sc1
    global_store_dword v213, v218, s[4:5] offset:4 sc1
    global_store_dword v213, v219, s[4:5] offset:132 sc1
    v_readfirstlane_b32 s37, v208
    v_add_u32 v208, 256, v208
    s_nop 1
    v_accvgpr_read_b32 v216, a4
    v_accvgpr_read_b32 v217, a5
    v_accvgpr_read_b32 v218, a6
    v_accvgpr_read_b32 v219, a7
    s_cmp_lt_u32 s37, 192
    s_cbranch_scc1 Q_mem1
Q_nomem1:

    s_waitcnt lgkmcnt(0)
Q_xa:

    s_mul_i32 s37, s2, 7168
    s_add_u32 s37, s37, 0x1500000
    v_lshl_add_u32 v8, v1, 4, s37
    v_add_u32 v9, 0x1f00000, v8
    v_mul_u32_u24 v2, 240, v3
    v_add_u32 v2, 129024, v2
    v_lshl_add_u32 v10, v4, 3, v2
    v_lshrrev_b32 v12, 1, v4
    v_and_b32 v13, 1, v4
    v_lshl_add_u32 v11, v12, 5, v2
    v_lshl_add_u32 v11, v13, 2, v11
    v_lshl_add_u32 v14, v13, 4, v2
    v_lshl_add_u32 v14, v12, 2, v14
    v_mul_u32_u24 v15, 3840, v5
    v_add_u32 v15, v15, v2
    v_lshl_add_u32 v15, v13, 4, v15
    s_lshr_b32 s37, s2, 2
    s_and_b32 s38, s2, 3
    s_mul_i32 s37, s37, 28672
    s_mul_i32 s38, s38, 3584
    s_add_u32 s37, s37, s38
    s_add_u32 s37, s37, 0x3600000
    v_mul_u32_u24 v7, 14336, v5
    v_and_b32 v6, 31, v1
    v_lshl_add_u32 v7, v6, 4, v7
    v_add_u32 v7, s37, v7

    ds_read_b64 v[16:17], v10 offset:0
    ds_read_b64 v[18:19], v10 offset:32
    ds_read_b64 v[20:21], v10 offset:64
    ds_read_b64 v[22:23], v10 offset:96
    ds_read_b64 v[24:25], v10 offset:128
    ds_read_b64 v[26:27], v10 offset:160
    ds_read_b64 v[28:29], v10 offset:3840
    ds_read_b64 v[30:31], v10 offset:3872
    ds_read_b64 v[32:33], v10 offset:3904
    ds_read_b64 v[34:35], v10 offset:3936
    ds_read_b64 v[36:37], v10 offset:3968
    ds_read_b64 v[38:39], v10 offset:4000
    ds_read_b64 v[40:41], v10 offset:192
    ds_read_b64 v[42:43], v10 offset:4032
    v_add_u32 v12, 4096, v8
    s_waitcnt lgkmcnt(12)
    global_store_dwordx4 v8, v[16:19], s[4:5] offset:0 sc1
    s_waitcnt lgkmcnt(10)
    global_store_dwordx4 v8, v[20:23], s[4:5] offset:1024 sc1
    s_waitcnt lgkmcnt(8)
    global_store_dwordx4 v8, v[24:27], s[4:5] offset:2048 sc1
    s_waitcnt lgkmcnt(6)
    global_store_dwordx4 v8, v[28:31], s[4:5] offset:3072 sc1
    s_waitcnt lgkmcnt(4)
    global_store_dwordx4 v12, v[32:35], s[4:5] offset:0 sc1
    s_waitcnt lgkmcnt(2)
    global_store_dwordx4 v12, v[36:39], s[4:5] offset:1024 sc1
    s_waitcnt lgkmcnt(0)
    global_store_dwordx4 v12, v[40:43], s[4:5] offset:2048 sc1
    ds_read_b32 v48, v11 offset:0
    ds_read_b32 v49, v11 offset:8
    ds_read_b32 v50, v11 offset:16
    ds_read_b32 v51, v11 offset:24
    ds_read_b32 v52, v11 offset:64
    ds_read_b32 v53, v11 offset:72
    ds_read_b32 v54, v11 offset:80
    ds_read_b32 v55, v11 offset:88
    ds_read_b32 v56, v11 offset:128
    ds_read_b32 v57, v11 offset:136
    ds_read_b32 v58, v11 offset:144
    ds_read_b32 v59, v11 offset:152
    s_waitcnt lgkmcnt(0)
    ds_read_b32 v60, v11 offset:3840
    ds_read_b32 v61, v11 offset:3848
    ds_read_b32 v62, v11 offset:3856
    ds_read_b32 v63, v11 offset:3864
    ds_read_b32 v64, v11 offset:3904
    ds_read_b32 v65, v11 offset:3912
    ds_read_b32 v66, v11 offset:3920
    ds_read_b32 v67, v11 offset:3928
    ds_read_b32 v68, v11 offset:3968
    ds_read_b32 v69, v11 offset:3976
    ds_read_b32 v70, v11 offset:3984
    ds_read_b32 v71, v11 offset:3992
    s_waitcnt lgkmcnt(0)
    ds_read_b32 v72, v14 offset:192
    ds_read_b32 v73, v14 offset:200
    ds_read_b32 v74, v14 offset:4032
    ds_read_b32 v75, v14 offset:4040
    ds_read_b128 v[80:83], v15 offset:0
    ds_read_b128 v[84:87], v15 offset:32
    ds_read_b128 v[88:91], v15 offset:64
    ds_read_b128 v[92:95], v15 offset:96
    ds_read_b128 v[96:99], v15 offset:128
    ds_read_b128 v[100:103], v15 offset:160
    ds_read_b128 v[104:107], v15 offset:192
    v_add_u32 v12, 4096, v9
    s_waitcnt lgkmcnt(7)
    global_store_dwordx4 v9, v[48:51], s[4:5] offset:0 sc1
    global_store_dwordx4 v9, v[52:55], s[4:5] offset:1024 sc1
    global_store_dwordx4 v9, v[56:59], s[4:5] offset:2048 sc1
    global_store_dwordx4 v9, v[60:63], s[4:5] offset:3072 sc1
    global_store_dwordx4 v12, v[64:67], s[4:5] offset:0 sc1
    global_store_dwordx4 v12, v[68:71], s[4:5] offset:1024 sc1
    global_store_dwordx4 v12, v[72:75], s[4:5] offset:2048 sc1
    s_waitcnt lgkmcnt(0)
    global_store_dwordx4 v7, v[80:83], s[4:5] offset:0 sc1
    global_store_dwordx4 v7, v[84:87], s[4:5] offset:512 sc1
    global_store_dwordx4 v7, v[88:91], s[4:5] offset:1024 sc1
    global_store_dwordx4 v7, v[92:95], s[4:5] offset:1536 sc1
    global_store_dwordx4 v7, v[96:99], s[4:5] offset:2048 sc1
    global_store_dwordx4 v7, v[100:103], s[4:5] offset:2560 sc1
    global_store_dwordx4 v7, v[104:107], s[4:5] offset:3072 sc1
Q_done:

    s_waitcnt vmcnt(0)

    s_barrier
    s_cmp_lg_u32 s3, 0
    s_cbranch_scc1 Q_bar
    v_mov_b32 v5, 192
    v_mov_b32 v10, 1
    s_mov_b64 exec, 1
    s_cmp_eq_u32 s26, 0
    s_cbranch_scc1 Q_nf2
    s_lshr_b32 s37, s30, 1
    s_lshl_b32 s37, s37, 2
    s_and_b32 s38, s30, 1
    s_lshl_b32 s38, s38, 4
    s_lshl_b32 s38, 1, s38
    v_mov_b32 v2, s37
    v_mov_b32 v15, s38
    global_atomic_add v2, v15, s[6:7]
Q_nf2:
    global_atomic_add v11, v5, v10, s[6:7] sc0
    s_mov_b64 exec, -1

    s_lshl_b32 s37, s2, 8
    s_add_u32 s37, s37, 0x37C0000
    v_mov_b32 v5, s37
    s_waitcnt vmcnt(0)
    v_readfirstlane_b32 s37, v11
    s_cmp_eq_u32 s37, 255
    s_cbranch_scc0 Q_bw
    v_lshlrev_b32 v5, 8, v1
    v_add_u32 v5, 0x37C0000, v5
    v_add_u32 v6, 16384, v5
    v_add_u32 v7, 32768, v5
    v_add_u32 v8, 49152, v5
    global_store_dword v5, v10, s[4:5] sc1
    global_store_dword v6, v10, s[4:5] sc1
    global_store_dword v7, v10, s[4:5] sc1
    global_store_dword v8, v10, s[4:5] sc1
    s_branch Q_bar
Q_bw:
    s_cmp_eq_u32 s26, 0
    s_cbranch_scc1 Q_bar
    global_load_dword v10, v5, s[4:5] sc1
    s_waitcnt vmcnt(0)
    v_cmp_eq_u32 vcc, 0, v10
    s_cbranch_vccz Q_bar
    s_sleep 2
    s_sub_u32 s15, s15, 1
    s_cbranch_scc0 Q_bw
    s_mov_b32 s15, 0
Q_bar:
    s_cmp_eq_u32 s26, 0
    s_cbranch_scc1 Q_nbar
    s_barrier
Q_nbar:

    s_and_b32 s26, s2, 7
    s_lshr_b32 s27, s2, 3
    s_cmp_lg_u32 s26, 0
    s_cbranch_scc1 M_other
    s_cmp_lt_u32 s27, 16
    s_cbranch_scc1 R_G
    s_cmp_lt_u32 s27, 30
    s_cbranch_scc1 R_U
    s_branch M_end
M_other:
    s_sub_u32 s28, s26, 1
    s_lshl_b32 s26, s28, 3
    s_add_u32 s26, s26, s27
    s_cmp_lt_u32 s27, 8
    s_cbranch_scc1 R_UX
    s_sub_u32 s26, s26, 8
    s_cmp_lt_u32 s27, 16
    s_cbranch_scc1 R_UO
    s_sub_u32 s27, s27, 16
    s_lshl_b32 s26, s28, 2
    s_add_u32 s26, s26, s27
    s_cmp_lt_u32 s27, 4
    s_cbranch_scc1 R_GX
    s_cmp_lt_u32 s28, 2
    s_cbranch_scc0 M_o2
    s_lshl_b32 s26, s28, 1
    s_add_u32 s26, s26, s27
    s_add_u32 s26, s26, 24
    s_cmp_lt_u32 s27, 6
    s_cbranch_scc1 R_GX
    s_mul_i32 s26, s28, 10
    s_add_u32 s26, s26, s27
    s_sub_u32 s26, s26, 6
    s_branch R_A
M_o2:
    s_mul_i32 s26, s28, 12
    s_add_u32 s26, s26, s27
    s_sub_u32 s26, s26, 8
    s_cmp_lt_u32 s26, 64
    s_cbranch_scc1 R_A
M_end:

    s_endpgm
R_G:
    s_mov_b32 s26, s27

    s_getreg_b32 s21, hwreg(HW_REG_XCC_ID)
    s_and_b32 s21, s21, 15
    s_add_u32 s21, s21, 1

    s_lshr_b32 s28, s26, 1
    s_lshl_b32 s28, s28, 2
    s_add_u32 s28, s28, 24
    v_mov_b32 v10, s28
    s_and_b32 s29, s26, 1
    s_lshl_b32 s29, s29, 4
G_cw:
    global_load_dword v11, v10, s[6:7] sc1
    s_waitcnt vmcnt(0)
    v_readfirstlane_b32 s28, v11
    s_lshr_b32 s28, s28, s29
    s_and_b32 s28, s28, 0xffff
    s_cmp_ge_u32 s28, 14
    s_cbranch_scc1 G_cok
    s_sleep 3
    s_sub_u32 s15, s15, 1
    s_cbranch_scc1 M_end
    s_branch G_cw
G_cok:

    s_lshl_b32 s28, s26, 2
    s_add_u32 s28, s28, s3
    s_mul_i32 s28, s28, 100352
    s_add_u32 s30, s4, s28
    s_addc_u32 s31, s5, 0
    s_lshl_b32 s29, s3, 1

    s_add_u32 s28, s29, 0
    s_sub_u32 s32, s28, 7
    s_cmp_ge_u32 s28, 7
    s_cselect_b32 s28, s32, s28
    s_lshl_b32 s28, s28, 11
    v_lshl_add_u32 v2, v1, 4, s28

    global_load_dwordx4 a[0:3], v2, s[30:31]
    global_load_dwordx4 a[4:7], v2, s[30:31] offset:1024
    v_add_u32 v2, 14336, v2
    global_load_dwordx4 a[56:59], v2, s[30:31]
    global_load_dwordx4 a[60:63], v2, s[30:31] offset:1024
    v_add_u32 v2, 14336, v2
    global_load_dwordx4 a[112:115], v2, s[30:31]
    global_load_dwordx4 a[116:119], v2, s[30:31] offset:1024
    v_add_u32 v2, 14336, v2
    global_load_dwordx4 a[168:171], v2, s[30:31]
    global_load_dwordx4 a[172:175], v2, s[30:31] offset:1024
    v_add_u32 v2, 14336, v2
    global_load_dwordx4 a[224:227], v2, s[30:31]
    global_load_dwordx4 a[228:231], v2, s[30:31] offset:1024
    v_add_u32 v2, 14336, v2
    global_load_dwordx4 v[144:147], v2, s[30:31]
    global_load_dwordx4 v[148:151], v2, s[30:31] offset:1024
    v_add_u32 v2, 14336, v2
    global_load_dwordx4 v[200:203], v2, s[30:31]
    global_load_dwordx4 v[204:207], v2, s[30:31] offset:1024

    s_add_u32 s28, s29, 1
    s_sub_u32 s32, s28, 7
    s_cmp_ge_u32 s28, 7
    s_cselect_b32 s28, s32, s28
    s_lshl_b32 s28, s28, 11
    v_lshl_add_u32 v2, v1, 4, s28

    s_lshr_b32 s33, s28, 1
    global_load_dwordx4 a[8:11], v2, s[30:31]
    global_load_dwordx4 a[12:15], v2, s[30:31] offset:1024
    v_add_u32 v2, 14336, v2
    global_load_dwordx4 a[64:67], v2, s[30:31]
    global_load_dwordx4 a[68:71], v2, s[30:31] offset:1024
    v_add_u32 v2, 14336, v2
    global_load_dwordx4 a[120:123], v2, s[30:31]
    global_load_dwordx4 a[124:127], v2, s[30:31] offset:1024
    v_add_u32 v2, 14336, v2
    global_load_dwordx4 a[176:179], v2, s[30:31]
    global_load_dwordx4 a[180:183], v2, s[30:31] offset:1024
    v_add_u32 v2, 14336, v2
    global_load_dwordx4 a[232:235], v2, s[30:31]
    global_load_dwordx4 a[236:239], v2, s[30:31] offset:1024
    v_add_u32 v2, 14336, v2
    global_load_dwordx4 v[152:155], v2, s[30:31]
    global_load_dwordx4 v[156:159], v2, s[30:31] offset:1024
    v_add_u32 v2, 14336, v2
    global_load_dwordx4 v[208:211], v2, s[30:31]
    global_load_dwordx4 v[212:215], v2, s[30:31] offset:1024

    s_add_u32 s28, s29, 2
    s_sub_u32 s32, s28, 7
    s_cmp_ge_u32 s28, 7
    s_cselect_b32 s28, s32, s28
    s_lshl_b32 s28, s28, 11
    v_lshl_add_u32 v2, v1, 4, s28

    s_lshr_b32 s42, s28, 1
    global_load_dwordx4 a[16:19], v2, s[30:31]
    global_load_dwordx4 a[20:23], v2, s[30:31] offset:1024
    v_add_u32 v2, 14336, v2
    global_load_dwordx4 a[72:75], v2, s[30:31]
    global_load_dwordx4 a[76:79], v2, s[30:31] offset:1024
    v_add_u32 v2, 14336, v2
    global_load_dwordx4 a[128:131], v2, s[30:31]
    global_load_dwordx4 a[132:135], v2, s[30:31] offset:1024
    v_add_u32 v2, 14336, v2
    global_load_dwordx4 a[184:187], v2, s[30:31]
    global_load_dwordx4 a[188:191], v2, s[30:31] offset:1024
    v_add_u32 v2, 14336, v2
    global_load_dwordx4 a[240:243], v2, s[30:31]
    global_load_dwordx4 a[244:247], v2, s[30:31] offset:1024
    v_add_u32 v2, 14336, v2
    global_load_dwordx4 v[160:163], v2, s[30:31]
    global_load_dwordx4 v[164:167], v2, s[30:31] offset:1024
    v_add_u32 v2, 14336, v2
    global_load_dwordx4 v[216:219], v2, s[30:31]
    global_load_dwordx4 v[220:223], v2, s[30:31] offset:1024

    s_add_u32 s28, s29, 3
    s_sub_u32 s32, s28, 7
    s_cmp_ge_u32 s28, 7
    s_cselect_b32 s28, s32, s28
    s_lshl_b32 s28, s28, 11
    v_lshl_add_u32 v2, v1, 4, s28

    s_lshr_b32 s43, s28, 1
    global_load_dwordx4 a[24:27], v2, s[30:31]
    global_load_dwordx4 a[28:31], v2, s[30:31] offset:1024
    v_add_u32 v2, 14336, v2
    global_load_dwordx4 a[80:83], v2, s[30:31]
    global_load_dwordx4 a[84:87], v2, s[30:31] offset:1024
    v_add_u32 v2, 14336, v2
    global_load_dwordx4 a[136:139], v2, s[30:31]
    global_load_dwordx4 a[140:143], v2, s[30:31] offset:1024
    v_add_u32 v2, 14336, v2
    global_load_dwordx4 a[192:195], v2, s[30:31]
    global_load_dwordx4 a[196:199], v2, s[30:31] offset:1024
    v_add_u32 v2, 14336, v2
    global_load_dwordx4 a[248:251], v2, s[30:31]
    global_load_dwordx4 a[252:255], v2, s[30:31] offset:1024
    v_add_u32 v2, 14336, v2
    global_load_dwordx4 v[168:171], v2, s[30:31]
    global_load_dwordx4 v[172:175], v2, s[30:31] offset:1024
    v_add_u32 v2, 14336, v2
    global_load_dwordx4 v[224:227], v2, s[30:31]
    global_load_dwordx4 v[228:231], v2, s[30:31] offset:1024

    s_add_u32 s28, s29, 4
    s_sub_u32 s32, s28, 7
    s_cmp_ge_u32 s28, 7
    s_cselect_b32 s28, s32, s28
    s_lshl_b32 s28, s28, 11
    v_lshl_add_u32 v2, v1, 4, s28

    s_lshr_b32 s44, s28, 1
    global_load_dwordx4 a[32:35], v2, s[30:31]
    global_load_dwordx4 a[36:39], v2, s[30:31] offset:1024
    v_add_u32 v2, 14336, v2
    global_load_dwordx4 a[88:91], v2, s[30:31]
    global_load_dwordx4 a[92:95], v2, s[30:31] offset:1024
    v_add_u32 v2, 14336, v2
    global_load_dwordx4 a[144:147], v2, s[30:31]
    global_load_dwordx4 a[148:151], v2, s[30:31] offset:1024
    v_add_u32 v2, 14336, v2
    global_load_dwordx4 a[200:203], v2, s[30:31]
    global_load_dwordx4 a[204:207], v2, s[30:31] offset:1024
    v_add_u32 v2, 14336, v2
    global_load_dwordx4 v[120:123], v2, s[30:31]
    global_load_dwordx4 v[124:127], v2, s[30:31] offset:1024
    v_add_u32 v2, 14336, v2
    global_load_dwordx4 v[176:179], v2, s[30:31]
    global_load_dwordx4 v[180:183], v2, s[30:31] offset:1024
    v_add_u32 v2, 14336, v2
    global_load_dwordx4 v[232:235], v2, s[30:31]
    global_load_dwordx4 v[236:239], v2, s[30:31] offset:1024

    s_add_u32 s28, s29, 5
    s_sub_u32 s32, s28, 7
    s_cmp_ge_u32 s28, 7
    s_cselect_b32 s28, s32, s28
    s_lshl_b32 s28, s28, 11
    v_lshl_add_u32 v2, v1, 4, s28

    s_lshr_b32 s45, s28, 1
    global_load_dwordx4 a[40:43], v2, s[30:31]
    global_load_dwordx4 a[44:47], v2, s[30:31] offset:1024
    v_add_u32 v2, 14336, v2
    global_load_dwordx4 a[96:99], v2, s[30:31]
    global_load_dwordx4 a[100:103], v2, s[30:31] offset:1024
    v_add_u32 v2, 14336, v2
    global_load_dwordx4 a[152:155], v2, s[30:31]
    global_load_dwordx4 a[156:159], v2, s[30:31] offset:1024
    v_add_u32 v2, 14336, v2
    global_load_dwordx4 a[208:211], v2, s[30:31]
    global_load_dwordx4 a[212:215], v2, s[30:31] offset:1024
    v_add_u32 v2, 14336, v2
    global_load_dwordx4 v[128:131], v2, s[30:31]
    global_load_dwordx4 v[132:135], v2, s[30:31] offset:1024
    v_add_u32 v2, 14336, v2
    global_load_dwordx4 v[184:187], v2, s[30:31]
    global_load_dwordx4 v[188:191], v2, s[30:31] offset:1024
    v_add_u32 v2, 14336, v2
    global_load_dwordx4 v[240:243], v2, s[30:31]
    global_load_dwordx4 v[244:247], v2, s[30:31] offset:1024

    s_add_u32 s28, s29, 6
    s_sub_u32 s32, s28, 7
    s_cmp_ge_u32 s28, 7
    s_cselect_b32 s28, s32, s28
    s_lshl_b32 s28, s28, 11
    v_lshl_add_u32 v2, v1, 4, s28

    s_lshr_b32 s46, s28, 1
    global_load_dwordx4 a[48:51], v2, s[30:31]
    global_load_dwordx4 a[52:55], v2, s[30:31] offset:1024
    v_add_u32 v2, 14336, v2
    global_load_dwordx4 a[104:107], v2, s[30:31]
    global_load_dwordx4 a[108:111], v2, s[30:31] offset:1024
    v_add_u32 v2, 14336, v2
    global_load_dwordx4 a[160:163], v2, s[30:31]
    global_load_dwordx4 a[164:167], v2, s[30:31] offset:1024
    v_add_u32 v2, 14336, v2
    global_load_dwordx4 a[216:219], v2, s[30:31]
    global_load_dwordx4 a[220:223], v2, s[30:31] offset:1024
    v_add_u32 v2, 14336, v2
    global_load_dwordx4 v[136:139], v2, s[30:31]
    global_load_dwordx4 v[140:143], v2, s[30:31] offset:1024
    v_add_u32 v2, 14336, v2
    global_load_dwordx4 v[192:195], v2, s[30:31]
    global_load_dwordx4 v[196:199], v2, s[30:31] offset:1024
    v_add_u32 v2, 14336, v2
    global_load_dwordx4 v[248:251], v2, s[30:31]
    global_load_dwordx4 v[252:255], v2, s[30:31] offset:1024

    v_min_u32 v10, 29, v1
    v_lshlrev_b32 v10, 2, v10
    s_lshl_b32 s28, s2, 8
    s_add_u32 s28, s28, 0x37C0000
    v_mov_b32 v13, s28
G_xp:
    global_load_dword v11, v10, s[6:7] offset:64 sc1
    global_load_dword v12, v13, s[4:5] sc1
    s_waitcnt vmcnt(0)
    v_min_u32 v12, v11, v12
    v_cmp_eq_u32 vcc, 0, v12
    s_cbranch_vccz G_xok
    s_sub_u32 s15, s15, 1
    s_cbranch_scc1 M_end
    s_branch G_xp
G_xok:
    v_cmp_ne_u32 vcc, s21, v11
    s_cmp_eq_u64 vcc, 0
    s_cselect_b32 s20, 1, 0

    v_and_b32 v12, 8, v1
    v_cmp_eq_u32 vcc, 0, v12
    v_mov_b32 v6, 0xeeee
    v_mov_b32 v12, 0x4444
    v_cndmask_b32 v6, v6, v12, vcc

    s_lshl_b32 s28, s3, 11
    v_lshl_add_u32 v3, v1, 4, s28
    v_lshl_add_u32 v4, v1, 4, s33
    v_and_b32 v10, 7, v1
    v_lshrrev_b32 v11, 4, v1
    v_lshlrev_b32 v5, 4, v1
    s_mul_i32 s28, s3, 1792
    v_lshlrev_b32 v7, 7, v11
    v_lshl_add_u32 v7, v10, 4, v7
    v_add_u32 v7, s28, v7
    v_lshrrev_b32 v44, 1, v11
    v_and_b32 v45, 1, v11
    v_lshlrev_b32 v8, 7, v44
    v_lshl_add_u32 v8, v10, 4, v8
    v_lshl_add_u32 v8, v45, 3, v8
    v_add_u32 v8, s28, v8
    v_add_u32 v8, 1536, v8
    v_and_b32 v12, 15, v1
    s_mul_i32 s29, s3, 3584
    s_add_u32 s29, s29, 24576
    v_lshlrev_b32 v9, 5, v12
    v_lshl_add_u32 v9, v11, 3, v9
    v_add_u32 v9, s29, v9
    v_lshrrev_b32 v46, 3, v12
    v_lshlrev_b32 v46, 7, v46
    v_bfe_u32 v47, v12, 2, 1
    v_lshl_add_u32 v46, v47, 5, v46
    v_and_b32 v47, 3, v12
    v_lshl_add_u32 v46, v47, 3, v46
    v_add_u32 v46, s29, v46
    v_lshl_add_u32 v0, v44, 9, v46
    v_lshl_add_u32 v0, v45, 6, v0
    v_lshl_add_u32 v112, v45, 8, v46
    v_lshl_add_u32 v112, v44, 6, v112
    v_add_u32 v112, 3072, v112
    v_add_u32 v113, s42, v5
    v_add_u32 v116, s43, v5
    v_add_u32 v117, s44, v5
    v_add_u32 v118, s45, v5
    v_add_u32 v119, s46, v5
    v_mul_u32_u24 v10, 208, v12
    v_lshl_add_u32 v10, v11, 4, v10
    s_mul_i32 s28, s3, 1664
    s_add_u32 s28, s28, 16384
    v_add_u32 v10, s28, v10
    v_bfe_u32 v11, v1, 4, 1
    s_lshl_b32 s28, s3, 1
    v_add_u32 v11, s28, v11
    v_mul_u32_u24 v45, 208, v11
    v_add_u32 v45, 16384, v45
    v_and_b32 v46, 3, v12
    v_lshl_add_u32 v47, v46, 3, v45
    v_add_u32 v47, 128, v47
    v_lshl_add_u32 v45, v12, 3, v45
    s_lshl_b32 s32, s26, 9
    v_lshl_add_u32 v13, v11, 4, s32
    v_bfe_u32 v46, v12, 2, 1
    v_lshl_add_u32 v13, v46, 8, v13
    v_lshrrev_b32 v46, 3, v12
    v_lshl_add_u32 v13, v46, 2, v13
    v_and_b32 v46, 1, v12
    v_lshl_add_u32 v13, v46, 7, v13
    v_bfe_u32 v48, v12, 1, 1
    v_lshl_add_u32 v13, v48, 3, v13
    s_lshr_b32 s32, s26, 1
    s_lshl_b32 s32, s32, 8
    s_and_b32 s33, s26, 1
    s_lshl_b32 s33, s33, 2
    s_add_u32 s32, s32, s33
    s_add_u32 s32, s32, 8192
    v_lshl_add_u32 v14, v11, 4, s32
    v_lshl_add_u32 v14, v46, 7, v14
    v_lshl_add_u32 v14, v48, 3, v14
    v_mov_b32 v11, v45
    v_mov_b32 v12, v47
    s_mul_i32 s29, s3, 7168
    v_add_u32 v1, s29, v5
    s_mov_b32 s36, 0x00ff00ff
    s_mov_b32 s37, 0x00ff00ff
    s_mov_b32 s34, 0x3e800000
    s_mov_b32 s14, 0
    s_add_u32 s16, s4, 0xe80000
    s_addc_u32 s17, s5, 0
    s_add_u32 s18, s4, 0xe84000
    s_addc_u32 s19, s5, 0
    s_add_u32 s24, s4, 0x3400000
    s_addc_u32 s25, s5, 0
    s_add_u32 s52, s24, 4096
    s_addc_u32 s53, s25, 0
    s_add_u32 s50, s18, 32768
    s_addc_u32 s51, s19, 0
    v_mov_b32 v2, -1
    s_cmp_eq_u32 s20, 1
    s_cbranch_scc0 G_nopw
    s_mov_b32 exec_hi, 0
    global_store_dword v13, v2, s[18:19]
    s_mov_b64 exec, 0x000f000f
    global_store_dword v14, v2, s[18:19]
    s_mov_b64 exec, -1
G_nopw:

    global_load_dwordx4 v[72:75], v1, s[24:25] offset:0
    global_load_dwordx4 v[76:79], v1, s[24:25] offset:1024
    global_load_dwordx4 v[80:83], v1, s[24:25] offset:2048
    global_load_dwordx4 v[84:87], v1, s[24:25] offset:3072
    global_load_dwordx4 v[88:91], v1, s[52:53] offset:0
    global_load_dwordx4 v[92:95], v1, s[52:53] offset:1024
    global_load_dwordx4 v[96:99], v1, s[52:53] offset:2048
    s_cmp_eq_u32 s3, 1
    s_cbranch_scc1 G_loop_1
    s_cmp_eq_u32 s3, 2
    s_cbranch_scc1 G_loop_2
    s_cmp_eq_u32 s3, 3
    s_cbranch_scc1 G_loop_3
G_loop_0:

    global_load_dwordx4 v[16:19], v3, s[16:17] sc1
    global_load_dwordx4 v[20:23], v4, s[16:17] sc1
    v_mov_b32 v44, 0
    v_mov_b32 v45, 0
    v_mov_b32 v46, 0
    v_mov_b32 v47, 0
    v_mov_b32 v48, 0
    v_mov_b32 v49, 0
    v_mov_b32 v50, 0
    v_mov_b32 v51, 0
    v_mov_b32 v52, 0
    v_mov_b32 v53, 0
    v_mov_b32 v54, 0
    v_mov_b32 v55, 0
    v_mov_b32 v56, 0
    v_mov_b32 v57, 0
    v_mov_b32 v58, 0
    v_mov_b32 v59, 0
    v_mov_b32 v60, 0
    v_mov_b32 v61, 0
    v_mov_b32 v62, 0
    v_mov_b32 v63, 0
    v_mov_b32 v64, 0
    v_mov_b32 v65, 0
    v_mov_b32 v66, 0
    v_mov_b32 v67, 0
    v_mov_b32 v68, 0
    v_mov_b32 v69, 0
    v_mov_b32 v70, 0
    v_mov_b32 v71, 0
    global_load_dwordx4 v[16:19], v3, s[16:17] sc1
    global_load_dwordx4 v[20:23], v4, s[16:17] sc1
G_pl_0:
    s_waitcnt vmcnt(2)
    v_max3_u32 v15, v16, v17, v18
    v_max3_u32 v15, v15, v19, v20
    v_max3_u32 v15, v15, v21, v22
    v_max_u32 v15, v15, v23
    v_cmp_eq_u32 vcc, -1, v15
    s_cbranch_vccnz G_pr_0

    ds_write_b128 v3, v[16:19]
    ds_write_b128 v4, v[20:23]

    v_smfmac_f32_16x16x64_bf16 v[68:71], v[16:19], v[200:207], v6
    v_smfmac_f32_16x16x64_bf16 v[64:67], v[16:19], v[144:151], v6
    v_smfmac_f32_16x16x64_bf16 v[60:63], v[16:19], a[224:231], v6
    v_smfmac_f32_16x16x64_bf16 v[56:59], v[16:19], a[168:175], v6
    v_smfmac_f32_16x16x64_bf16 v[52:55], v[16:19], a[112:119], v6
    v_smfmac_f32_16x16x64_bf16 v[48:51], v[16:19], a[56:63], v6
    v_smfmac_f32_16x16x64_bf16 v[44:47], v[16:19], a[0:7], v6
    v_smfmac_f32_16x16x64_bf16 v[68:71], v[20:23], v[208:215], v6
    s_waitcnt lgkmcnt(0)
    s_barrier

    ds_read_b128 v[24:27], v113
    v_smfmac_f32_16x16x64_bf16 v[64:67], v[20:23], v[152:159], v6
    ds_read_b128 v[28:31], v116
    v_smfmac_f32_16x16x64_bf16 v[60:63], v[20:23], a[232:239], v6
    ds_read_b128 v[32:35], v117
    v_smfmac_f32_16x16x64_bf16 v[56:59], v[20:23], a[176:183], v6
    ds_read_b128 v[36:39], v118
    v_smfmac_f32_16x16x64_bf16 v[52:55], v[20:23], a[120:127], v6
    ds_read_b128 v[40:43], v119
    v_smfmac_f32_16x16x64_bf16 v[48:51], v[20:23], a[64:71], v6
    ds_read_b64 v[114:115], v8
    v_smfmac_f32_16x16x64_bf16 v[44:47], v[20:23], a[8:15], v6
    s_waitcnt lgkmcnt(5)
    v_smfmac_f32_16x16x64_bf16 v[44:47], v[24:27], a[16:23], v6
    v_smfmac_f32_16x16x64_bf16 v[48:51], v[24:27], a[72:79], v6
    s_waitcnt lgkmcnt(4)
    v_smfmac_f32_16x16x64_bf16 v[44:47], v[28:31], a[24:31], v6
    v_smfmac_f32_16x16x64_bf16 v[48:51], v[28:31], a[80:87], v6
    s_waitcnt lgkmcnt(3)
    v_smfmac_f32_16x16x64_bf16 v[44:47], v[32:35], a[32:39], v6
    v_smfmac_f32_16x16x64_bf16 v[48:51], v[32:35], a[88:95], v6
    s_waitcnt lgkmcnt(2)
    v_smfmac_f32_16x16x64_bf16 v[44:47], v[36:39], a[40:47], v6
    v_smfmac_f32_16x16x64_bf16 v[48:51], v[36:39], a[96:103], v6
    s_waitcnt lgkmcnt(1)
    v_smfmac_f32_16x16x64_bf16 v[44:47], v[40:43], a[48:55], v6
    v_smfmac_f32_16x16x64_bf16 v[48:51], v[40:43], a[104:111], v6
    v_smfmac_f32_16x16x64_bf16 v[52:55], v[24:27], a[128:135], v6
    v_cvt_pk_bf16_f32 v44, v44, v45
    v_smfmac_f32_16x16x64_bf16 v[56:59], v[24:27], a[184:191], v6
    v_cvt_pk_bf16_f32 v45, v46, v47
    ds_write_b64 v9, v[44:45] offset:0
    v_smfmac_f32_16x16x64_bf16 v[52:55], v[28:31], a[136:143], v6
    v_cvt_pk_bf16_f32 v48, v48, v49
    v_smfmac_f32_16x16x64_bf16 v[56:59], v[28:31], a[192:199], v6
    v_cvt_pk_bf16_f32 v49, v50, v51
    ds_write_b64 v9, v[48:49] offset:512
    v_smfmac_f32_16x16x64_bf16 v[52:55], v[32:35], a[144:151], v6
    ds_read_b64_tr_b16 v[44:45], v0 offset:0
    v_smfmac_f32_16x16x64_bf16 v[56:59], v[32:35], a[200:207], v6
    ds_read_b64_tr_b16 v[46:47], v0 offset:256
    v_smfmac_f32_16x16x64_bf16 v[52:55], v[36:39], a[152:159], v6
    ds_read_b128 v[48:51], v7 offset:0
    v_smfmac_f32_16x16x64_bf16 v[56:59], v[36:39], a[208:215], v6
    v_smfmac_f32_16x16x64_bf16 v[52:55], v[40:43], a[160:167], v6
    v_smfmac_f32_16x16x64_bf16 v[56:59], v[40:43], a[216:223], v6
    v_smfmac_f32_16x16x64_bf16 v[60:63], v[24:27], a[240:247], v6
    v_cvt_pk_bf16_f32 v52, v52, v53
    v_smfmac_f32_16x16x64_bf16 v[64:67], v[24:27], v[160:167], v6
    v_cvt_pk_bf16_f32 v53, v54, v55
    ds_write_b64 v9, v[52:53] offset:1024
    v_smfmac_f32_16x16x64_bf16 v[60:63], v[28:31], a[248:255], v6
    v_cvt_pk_bf16_f32 v56, v56, v57
    v_smfmac_f32_16x16x64_bf16 v[64:67], v[28:31], v[168:175], v6
    v_cvt_pk_bf16_f32 v57, v58, v59
    ds_write_b64 v9, v[56:57] offset:1536
    v_smfmac_f32_16x16x64_bf16 v[60:63], v[32:35], v[120:127], v6
    ds_read_b64_tr_b16 v[52:53], v0 offset:1024
    v_smfmac_f32_16x16x64_bf16 v[64:67], v[32:35], v[176:183], v6
    ds_read_b64_tr_b16 v[54:55], v0 offset:1280
    v_smfmac_f32_16x16x64_bf16 v[60:63], v[36:39], v[128:135], v6
    ds_read_b128 v[56:59], v7 offset:512
    v_smfmac_f32_16x16x64_bf16 v[64:67], v[36:39], v[184:191], v6
    v_smfmac_f32_16x16x64_bf16 v[60:63], v[40:43], v[136:143], v6
    v_smfmac_f32_16x16x64_bf16 v[64:67], v[40:43], v[192:199], v6
    v_smfmac_f32_16x16x64_bf16 v[68:71], v[24:27], v[216:223], v6
    v_cvt_pk_bf16_f32 v60, v60, v61
    v_smfmac_f32_16x16x64_bf16 v[68:71], v[28:31], v[224:231], v6
    v_cvt_pk_bf16_f32 v61, v62, v63
    ds_write_b64 v9, v[60:61] offset:2048
    v_smfmac_f32_16x16x64_bf16 v[68:71], v[32:35], v[232:239], v6
    v_cvt_pk_bf16_f32 v64, v64, v65
    v_smfmac_f32_16x16x64_bf16 v[68:71], v[36:39], v[240:247], v6
    v_cvt_pk_bf16_f32 v65, v66, v67
    ds_write_b64 v9, v[64:65] offset:2560
    ds_read_b64_tr_b16 v[60:61], v0 offset:2048
    ds_read_b64_tr_b16 v[62:63], v0 offset:2304
    v_smfmac_f32_16x16x64_bf16 v[68:71], v[40:43], v[248:255], v6
    ds_read_b128 v[64:67], v7 offset:1024

    s_waitcnt lgkmcnt(5)
    v_mfma_f32_16x16x32_bf16 v[100:103], v[72:75], v[44:47], 0
    v_mfma_f32_16x16x32_bf16 v[104:107], v[84:87], v[44:47], 0
    v_cvt_pk_bf16_f32 v68, v68, v69
    v_cvt_pk_bf16_f32 v69, v70, v71
    ds_write_b64 v9, v[68:69] offset:3072
    ds_read_b64_tr_b16 v[70:71], v112
    v_mfma_f32_16x16x32_bf16 v[108:111], v[48:51], v[44:47], 0
    v_mfma_f32_16x16x32_bf16 v[100:103], v[76:79], v[52:55], v[100:103]
    v_mfma_f32_16x16x32_bf16 v[104:107], v[88:91], v[52:55], v[104:107]
    v_mfma_f32_16x16x32_bf16 v[108:111], v[56:59], v[52:55], v[108:111]
    s_waitcnt lgkmcnt(2)
    v_mfma_f32_16x16x32_bf16 v[100:103], v[80:83], v[60:63], v[100:103]
    v_mfma_f32_16x16x32_bf16 v[104:107], v[92:95], v[60:63], v[104:107]
    v_mfma_f32_16x16x32_bf16 v[108:111], v[64:67], v[60:63], v[108:111]
    s_waitcnt lgkmcnt(0)
    v_mfma_f32_16x16x16_bf16 v[100:103], v[96:97], v[70:71], v[100:103]
    v_mfma_f32_16x16x16_bf16 v[104:107], v[98:99], v[70:71], v[104:107]
    v_mfma_f32_16x16x16_bf16 v[108:111], v[114:115], v[70:71], v[108:111]
    v_add_f32_dpp v100, v100, v100 row_ror:8 row_mask:0xf bank_mask:0xf
    v_add_f32_dpp v101, v101, v101 row_ror:8 row_mask:0xf bank_mask:0xf
    v_add_f32_dpp v102, v102, v102 row_ror:8 row_mask:0xf bank_mask:0xf
    v_add_f32_dpp v103, v103, v103 row_ror:8 row_mask:0xf bank_mask:0xf
    v_add_f32_dpp v104, v104, v104 row_ror:8 row_mask:0xf bank_mask:0xf
    v_add_f32_dpp v105, v105, v105 row_ror:8 row_mask:0xf bank_mask:0xf
    v_add_f32_dpp v106, v106, v106 row_ror:8 row_mask:0xf bank_mask:0xf
    v_add_f32_dpp v107, v107, v107 row_ror:8 row_mask:0xf bank_mask:0xf
    v_add_f32_dpp v108, v108, v108 row_ror:8 row_mask:0xf bank_mask:0xf
    v_add_f32_dpp v109, v109, v109 row_ror:8 row_mask:0xf bank_mask:0xf
    v_add_f32_dpp v110, v110, v110 row_ror:8 row_mask:0xf bank_mask:0xf
    v_add_f32_dpp v111, v111, v111 row_ror:8 row_mask:0xf bank_mask:0xf

    s_mov_b64 exec, s[36:37]
    ds_write_b128 v10, v[100:103]
    ds_write_b128 v10, v[104:107] offset:64
    s_mov_b32 exec_hi, 0
    ds_write_b128 v10, v[108:111] offset:128
    s_mov_b64 exec, -1
    s_waitcnt vmcnt(0) lgkmcnt(0)

    s_barrier

    ds_read_b64 v[16:17], v11 offset:0
    ds_read_b64 v[18:19], v11 offset:1664
    ds_read_b64 v[20:21], v11 offset:3328
    ds_read_b64 v[22:23], v11 offset:4992
    ds_read_b64 v[24:25], v12 offset:0
    ds_read_b64 v[26:27], v12 offset:1664
    ds_read_b64 v[28:29], v12 offset:3328
    ds_read_b64 v[30:31], v12 offset:4992

    s_add_u32 s24, s24, 28672
    s_addc_u32 s25, s25, 0
    s_add_u32 s52, s52, 28672
    s_addc_u32 s53, s53, 0
    s_waitcnt lgkmcnt(4)
    v_pk_add_f32 v[16:17], v[16:17], v[18:19]
    v_pk_add_f32 v[20:21], v[20:21], v[22:23]
    s_waitcnt lgkmcnt(0)
    v_pk_add_f32 v[24:25], v[24:25], v[26:27]
    v_pk_add_f32 v[28:29], v[28:29], v[30:31]
    v_pk_add_f32 v[16:17], v[16:17], v[20:21]
    v_pk_add_f32 v[24:25], v[24:25], v[28:29]
    v_max_f32 v32, v16, v17
    v_max3_f32 v32, v32, v24, v25

    s_nop 1
    v_max_f32_dpp v32, v32, v32 quad_perm:[1,0,3,2] row_mask:0xf bank_mask:0xf
    s_nop 1
    v_max_f32_dpp v32, v32, v32 quad_perm:[2,3,0,1] row_mask:0xf bank_mask:0xf
    s_nop 1
    v_max_f32_dpp v32, v32, v32 row_half_mirror row_mask:0xf bank_mask:0xf
    s_nop 1
    v_max_f32_dpp v32, v32, v32 row_mirror row_mask:0xf bank_mask:0xf

    v_sub_f32 v24, v24, v32
    v_sub_f32 v25, v25, v32
    v_sub_f32 v16, v16, v32
    v_sub_f32 v17, v17, v32
    v_exp_f32 v24, v24
    v_exp_f32 v25, v25
    v_exp_f32 v16, v16
    v_exp_f32 v17, v17
    v_add_f32 v33, v24, v25
    v_fma_f32 v33, v33, s34, v16
    v_add_f32 v33, v33, v17

    s_nop 1
    v_add_f32_dpp v33, v33, v33 quad_perm:[1,0,3,2] row_mask:0xf bank_mask:0xf
    s_nop 1
    v_add_f32_dpp v33, v33, v33 quad_perm:[2,3,0,1] row_mask:0xf bank_mask:0xf
    s_nop 1
    v_add_f32_dpp v33, v33, v33 row_half_mirror row_mask:0xf bank_mask:0xf
    s_nop 1
    v_add_f32_dpp v33, v33, v33 row_mirror row_mask:0xf bank_mask:0xf

    v_rcp_f32 v33, v33
    s_mov_b32 exec_hi, 0
    v_mul_f32 v16, v16, v33
    v_mul_f32 v17, v17, v33
    v_mul_f32 v24, v24, v33
    v_mul_f32 v25, v25, v33
    v_cvt_pk_bf16_f32 v36, v16, v17
    v_cvt_pk_bf16_f32 v37, v24, v25
    s_cmp_eq_u32 s20, 1
    s_cbranch_scc0 G_slowst_0
    global_store_dword v13, v36, s[18:19]
    s_mov_b64 exec, 0x000f000f
    global_store_dword v14, v37, s[18:19]
    global_store_dword v14, v2, s[50:51]
    s_mov_b32 exec_lo, -1
    global_store_dword v13, v2, s[50:51]
G_stdone_0:
    s_mov_b64 exec, -1

    s_add_u32 s14, s14, 1
    s_cmp_ge_u32 s14, 63
    s_cbranch_scc1 M_end

    global_load_dwordx4 v[72:75], v1, s[24:25] offset:0
    global_load_dwordx4 v[76:79], v1, s[24:25] offset:1024
    global_load_dwordx4 v[80:83], v1, s[24:25] offset:2048
    global_load_dwordx4 v[84:87], v1, s[24:25] offset:3072
    global_load_dwordx4 v[88:91], v1, s[52:53] offset:0
    global_load_dwordx4 v[92:95], v1, s[52:53] offset:1024
    global_load_dwordx4 v[96:99], v1, s[52:53] offset:2048

    s_add_u32 s16, s16, 32768
    s_addc_u32 s17, s17, 0
    s_add_u32 s18, s18, 32768
    s_addc_u32 s19, s19, 0
    s_add_u32 s50, s50, 32768
    s_addc_u32 s51, s51, 0

    s_sleep 9
    s_branch G_loop_0
G_loop_1:

    global_load_dwordx4 v[16:19], v3, s[16:17] sc1
    global_load_dwordx4 v[20:23], v4, s[16:17] sc1
    v_mov_b32 v44, 0
    v_mov_b32 v45, 0
    v_mov_b32 v46, 0
    v_mov_b32 v47, 0
    v_mov_b32 v48, 0
    v_mov_b32 v49, 0
    v_mov_b32 v50, 0
    v_mov_b32 v51, 0
    v_mov_b32 v52, 0
    v_mov_b32 v53, 0
    v_mov_b32 v54, 0
    v_mov_b32 v55, 0
    v_mov_b32 v56, 0
    v_mov_b32 v57, 0
    v_mov_b32 v58, 0
    v_mov_b32 v59, 0
    v_mov_b32 v60, 0
    v_mov_b32 v61, 0
    v_mov_b32 v62, 0
    v_mov_b32 v63, 0
    v_mov_b32 v64, 0
    v_mov_b32 v65, 0
    v_mov_b32 v66, 0
    v_mov_b32 v67, 0
    v_mov_b32 v68, 0
    v_mov_b32 v69, 0
    v_mov_b32 v70, 0
    v_mov_b32 v71, 0
    global_load_dwordx4 v[16:19], v3, s[16:17] sc1
    global_load_dwordx4 v[20:23], v4, s[16:17] sc1
G_pl_1:
    s_waitcnt vmcnt(2)
    v_max3_u32 v15, v16, v17, v18
    v_max3_u32 v15, v15, v19, v20
    v_max3_u32 v15, v15, v21, v22
    v_max_u32 v15, v15, v23
    v_cmp_eq_u32 vcc, -1, v15
    s_cbranch_vccnz G_pr_1

    ds_write_b128 v3, v[16:19]
    ds_write_b128 v4, v[20:23]

    v_smfmac_f32_16x16x64_bf16 v[68:71], v[16:19], v[200:207], v6
    v_smfmac_f32_16x16x64_bf16 v[64:67], v[16:19], v[144:151], v6
    v_smfmac_f32_16x16x64_bf16 v[60:63], v[16:19], a[224:231], v6
    v_smfmac_f32_16x16x64_bf16 v[56:59], v[16:19], a[168:175], v6
    v_smfmac_f32_16x16x64_bf16 v[52:55], v[16:19], a[112:119], v6
    v_smfmac_f32_16x16x64_bf16 v[48:51], v[16:19], a[56:63], v6
    v_smfmac_f32_16x16x64_bf16 v[44:47], v[16:19], a[0:7], v6
    v_smfmac_f32_16x16x64_bf16 v[68:71], v[20:23], v[208:215], v6
    s_waitcnt lgkmcnt(0)
    s_barrier

    ds_read_b128 v[24:27], v113
    v_smfmac_f32_16x16x64_bf16 v[64:67], v[20:23], v[152:159], v6
    ds_read_b128 v[28:31], v116
    v_smfmac_f32_16x16x64_bf16 v[60:63], v[20:23], a[232:239], v6
    ds_read_b128 v[32:35], v117
    v_smfmac_f32_16x16x64_bf16 v[56:59], v[20:23], a[176:183], v6
    ds_read_b128 v[36:39], v118
    v_smfmac_f32_16x16x64_bf16 v[52:55], v[20:23], a[120:127], v6
    ds_read_b128 v[40:43], v119
    v_smfmac_f32_16x16x64_bf16 v[48:51], v[20:23], a[64:71], v6
    ds_read_b64 v[114:115], v8
    v_smfmac_f32_16x16x64_bf16 v[44:47], v[20:23], a[8:15], v6
    s_waitcnt lgkmcnt(5)
    v_smfmac_f32_16x16x64_bf16 v[44:47], v[24:27], a[16:23], v6
    v_smfmac_f32_16x16x64_bf16 v[48:51], v[24:27], a[72:79], v6
    s_waitcnt lgkmcnt(4)
    v_smfmac_f32_16x16x64_bf16 v[44:47], v[28:31], a[24:31], v6
    v_smfmac_f32_16x16x64_bf16 v[48:51], v[28:31], a[80:87], v6
    s_waitcnt lgkmcnt(3)
    v_smfmac_f32_16x16x64_bf16 v[44:47], v[32:35], a[32:39], v6
    v_smfmac_f32_16x16x64_bf16 v[48:51], v[32:35], a[88:95], v6
    s_waitcnt lgkmcnt(2)
    v_smfmac_f32_16x16x64_bf16 v[44:47], v[36:39], a[40:47], v6
    v_smfmac_f32_16x16x64_bf16 v[48:51], v[36:39], a[96:103], v6
    s_waitcnt lgkmcnt(1)
    v_smfmac_f32_16x16x64_bf16 v[44:47], v[40:43], a[48:55], v6
    v_smfmac_f32_16x16x64_bf16 v[48:51], v[40:43], a[104:111], v6
    v_smfmac_f32_16x16x64_bf16 v[52:55], v[24:27], a[128:135], v6
    v_smfmac_f32_16x16x64_bf16 v[56:59], v[24:27], a[184:191], v6
    v_cvt_pk_bf16_f32 v44, v44, v45
    v_smfmac_f32_16x16x64_bf16 v[52:55], v[28:31], a[136:143], v6
    v_cvt_pk_bf16_f32 v45, v46, v47
    ds_write_b64 v9, v[44:45] offset:0
    v_smfmac_f32_16x16x64_bf16 v[56:59], v[28:31], a[192:199], v6
    v_cvt_pk_bf16_f32 v48, v48, v49
    v_smfmac_f32_16x16x64_bf16 v[52:55], v[32:35], a[144:151], v6
    v_cvt_pk_bf16_f32 v49, v50, v51
    ds_write_b64 v9, v[48:49] offset:512
    v_smfmac_f32_16x16x64_bf16 v[56:59], v[32:35], a[200:207], v6
    ds_read_b64_tr_b16 v[44:45], v0 offset:0
    v_smfmac_f32_16x16x64_bf16 v[52:55], v[36:39], a[152:159], v6
    ds_read_b64_tr_b16 v[46:47], v0 offset:256
    v_smfmac_f32_16x16x64_bf16 v[56:59], v[36:39], a[208:215], v6
    ds_read_b128 v[48:51], v7 offset:0
    v_smfmac_f32_16x16x64_bf16 v[52:55], v[40:43], a[160:167], v6
    v_smfmac_f32_16x16x64_bf16 v[56:59], v[40:43], a[216:223], v6
    v_smfmac_f32_16x16x64_bf16 v[60:63], v[24:27], a[240:247], v6
    v_smfmac_f32_16x16x64_bf16 v[64:67], v[24:27], v[160:167], v6
    v_cvt_pk_bf16_f32 v52, v52, v53
    v_smfmac_f32_16x16x64_bf16 v[60:63], v[28:31], a[248:255], v6
    v_cvt_pk_bf16_f32 v53, v54, v55
    ds_write_b64 v9, v[52:53] offset:1024
    v_smfmac_f32_16x16x64_bf16 v[64:67], v[28:31], v[168:175], v6
    v_cvt_pk_bf16_f32 v56, v56, v57
    v_smfmac_f32_16x16x64_bf16 v[60:63], v[32:35], v[120:127], v6
    v_cvt_pk_bf16_f32 v57, v58, v59
    ds_write_b64 v9, v[56:57] offset:1536
    v_smfmac_f32_16x16x64_bf16 v[64:67], v[32:35], v[176:183], v6
    ds_read_b64_tr_b16 v[52:53], v0 offset:1024
    v_smfmac_f32_16x16x64_bf16 v[60:63], v[36:39], v[128:135], v6
    ds_read_b64_tr_b16 v[54:55], v0 offset:1280
    v_smfmac_f32_16x16x64_bf16 v[64:67], v[36:39], v[184:191], v6
    ds_read_b128 v[56:59], v7 offset:512
    v_smfmac_f32_16x16x64_bf16 v[60:63], v[40:43], v[136:143], v6
    v_smfmac_f32_16x16x64_bf16 v[64:67], v[40:43], v[192:199], v6
    v_smfmac_f32_16x16x64_bf16 v[68:71], v[24:27], v[216:223], v6
    v_smfmac_f32_16x16x64_bf16 v[68:71], v[28:31], v[224:231], v6
    v_cvt_pk_bf16_f32 v60, v60, v61
    v_smfmac_f32_16x16x64_bf16 v[68:71], v[32:35], v[232:239], v6
    v_cvt_pk_bf16_f32 v61, v62, v63
    ds_write_b64 v9, v[60:61] offset:2048
    v_smfmac_f32_16x16x64_bf16 v[68:71], v[36:39], v[240:247], v6
    v_cvt_pk_bf16_f32 v64, v64, v65
    v_smfmac_f32_16x16x64_bf16 v[68:71], v[40:43], v[248:255], v6
    v_cvt_pk_bf16_f32 v65, v66, v67
    ds_write_b64 v9, v[64:65] offset:2560
    ds_read_b64_tr_b16 v[60:61], v0 offset:2048
    ds_read_b64_tr_b16 v[62:63], v0 offset:2304

    s_waitcnt lgkmcnt(4)
    v_mfma_f32_16x16x32_bf16 v[100:103], v[72:75], v[44:47], 0
    ds_read_b128 v[64:67], v7 offset:1024
    v_mfma_f32_16x16x32_bf16 v[104:107], v[84:87], v[44:47], 0
    v_cvt_pk_bf16_f32 v68, v68, v69
    v_cvt_pk_bf16_f32 v69, v70, v71
    ds_write_b64 v9, v[68:69] offset:3072
    ds_read_b64_tr_b16 v[70:71], v112
    v_mfma_f32_16x16x32_bf16 v[108:111], v[48:51], v[44:47], 0
    v_mfma_f32_16x16x32_bf16 v[100:103], v[76:79], v[52:55], v[100:103]
    v_mfma_f32_16x16x32_bf16 v[104:107], v[88:91], v[52:55], v[104:107]
    v_mfma_f32_16x16x32_bf16 v[108:111], v[56:59], v[52:55], v[108:111]
    s_waitcnt lgkmcnt(2)
    v_mfma_f32_16x16x32_bf16 v[100:103], v[80:83], v[60:63], v[100:103]
    v_mfma_f32_16x16x32_bf16 v[104:107], v[92:95], v[60:63], v[104:107]
    v_mfma_f32_16x16x32_bf16 v[108:111], v[64:67], v[60:63], v[108:111]
    s_waitcnt lgkmcnt(0)
    v_mfma_f32_16x16x16_bf16 v[100:103], v[96:97], v[70:71], v[100:103]
    v_mfma_f32_16x16x16_bf16 v[104:107], v[98:99], v[70:71], v[104:107]
    v_mfma_f32_16x16x16_bf16 v[108:111], v[114:115], v[70:71], v[108:111]
    v_add_f32_dpp v100, v100, v100 row_ror:8 row_mask:0xf bank_mask:0xf
    v_add_f32_dpp v101, v101, v101 row_ror:8 row_mask:0xf bank_mask:0xf
    v_add_f32_dpp v102, v102, v102 row_ror:8 row_mask:0xf bank_mask:0xf
    v_add_f32_dpp v103, v103, v103 row_ror:8 row_mask:0xf bank_mask:0xf
    v_add_f32_dpp v104, v104, v104 row_ror:8 row_mask:0xf bank_mask:0xf
    v_add_f32_dpp v105, v105, v105 row_ror:8 row_mask:0xf bank_mask:0xf
    v_add_f32_dpp v106, v106, v106 row_ror:8 row_mask:0xf bank_mask:0xf
    v_add_f32_dpp v107, v107, v107 row_ror:8 row_mask:0xf bank_mask:0xf
    v_add_f32_dpp v108, v108, v108 row_ror:8 row_mask:0xf bank_mask:0xf
    v_add_f32_dpp v109, v109, v109 row_ror:8 row_mask:0xf bank_mask:0xf
    v_add_f32_dpp v110, v110, v110 row_ror:8 row_mask:0xf bank_mask:0xf
    v_add_f32_dpp v111, v111, v111 row_ror:8 row_mask:0xf bank_mask:0xf

    s_mov_b64 exec, s[36:37]
    ds_write_b128 v10, v[100:103]
    ds_write_b128 v10, v[104:107] offset:64
    s_mov_b32 exec_hi, 0
    ds_write_b128 v10, v[108:111] offset:128
    s_mov_b64 exec, -1
    s_waitcnt vmcnt(0) lgkmcnt(0)

    s_barrier

    ds_read_b64 v[16:17], v11 offset:0
    ds_read_b64 v[18:19], v11 offset:1664
    ds_read_b64 v[20:21], v11 offset:3328
    ds_read_b64 v[22:23], v11 offset:4992
    ds_read_b64 v[24:25], v12 offset:0
    ds_read_b64 v[26:27], v12 offset:1664
    ds_read_b64 v[28:29], v12 offset:3328
    ds_read_b64 v[30:31], v12 offset:4992

    s_add_u32 s24, s24, 28672
    s_addc_u32 s25, s25, 0
    s_add_u32 s52, s52, 28672
    s_addc_u32 s53, s53, 0
    s_waitcnt lgkmcnt(4)
    v_pk_add_f32 v[16:17], v[16:17], v[18:19]
    v_pk_add_f32 v[20:21], v[20:21], v[22:23]
    s_waitcnt lgkmcnt(0)
    v_pk_add_f32 v[24:25], v[24:25], v[26:27]
    v_pk_add_f32 v[28:29], v[28:29], v[30:31]
    v_pk_add_f32 v[16:17], v[16:17], v[20:21]
    v_pk_add_f32 v[24:25], v[24:25], v[28:29]
    v_max_f32 v32, v16, v17
    v_max3_f32 v32, v32, v24, v25

    s_nop 1
    v_max_f32_dpp v32, v32, v32 quad_perm:[1,0,3,2] row_mask:0xf bank_mask:0xf
    s_nop 1
    v_max_f32_dpp v32, v32, v32 quad_perm:[2,3,0,1] row_mask:0xf bank_mask:0xf
    s_nop 1
    v_max_f32_dpp v32, v32, v32 row_half_mirror row_mask:0xf bank_mask:0xf
    s_nop 1
    v_max_f32_dpp v32, v32, v32 row_mirror row_mask:0xf bank_mask:0xf

    v_sub_f32 v24, v24, v32
    v_sub_f32 v25, v25, v32
    v_sub_f32 v16, v16, v32
    v_sub_f32 v17, v17, v32
    v_exp_f32 v24, v24
    v_exp_f32 v25, v25
    v_exp_f32 v16, v16
    v_exp_f32 v17, v17
    v_add_f32 v33, v24, v25
    v_fma_f32 v33, v33, s34, v16
    v_add_f32 v33, v33, v17

    s_nop 1
    v_add_f32_dpp v33, v33, v33 quad_perm:[1,0,3,2] row_mask:0xf bank_mask:0xf
    s_nop 1
    v_add_f32_dpp v33, v33, v33 quad_perm:[2,3,0,1] row_mask:0xf bank_mask:0xf
    s_nop 1
    v_add_f32_dpp v33, v33, v33 row_half_mirror row_mask:0xf bank_mask:0xf
    s_nop 1
    v_add_f32_dpp v33, v33, v33 row_mirror row_mask:0xf bank_mask:0xf

    v_rcp_f32 v33, v33
    s_mov_b32 exec_hi, 0
    v_mul_f32 v16, v16, v33
    v_mul_f32 v17, v17, v33
    v_mul_f32 v24, v24, v33
    v_mul_f32 v25, v25, v33
    v_cvt_pk_bf16_f32 v36, v16, v17
    v_cvt_pk_bf16_f32 v37, v24, v25
    s_cmp_eq_u32 s20, 1
    s_cbranch_scc0 G_slowst_1
    global_store_dword v13, v36, s[18:19]
    s_mov_b64 exec, 0x000f000f
    global_store_dword v14, v37, s[18:19]
    global_store_dword v14, v2, s[50:51]
    s_mov_b32 exec_lo, -1
    global_store_dword v13, v2, s[50:51]
G_stdone_1:
    s_mov_b64 exec, -1

    s_add_u32 s14, s14, 1
    s_cmp_ge_u32 s14, 63
    s_cbranch_scc1 M_end

    global_load_dwordx4 v[72:75], v1, s[24:25] offset:0
    global_load_dwordx4 v[76:79], v1, s[24:25] offset:1024
    global_load_dwordx4 v[80:83], v1, s[24:25] offset:2048
    global_load_dwordx4 v[84:87], v1, s[24:25] offset:3072
    global_load_dwordx4 v[88:91], v1, s[52:53] offset:0
    global_load_dwordx4 v[92:95], v1, s[52:53] offset:1024
    global_load_dwordx4 v[96:99], v1, s[52:53] offset:2048

    s_add_u32 s16, s16, 32768
    s_addc_u32 s17, s17, 0
    s_add_u32 s18, s18, 32768
    s_addc_u32 s19, s19, 0
    s_add_u32 s50, s50, 32768
    s_addc_u32 s51, s51, 0

    s_sleep 9
    s_branch G_loop_1
G_loop_2:

    global_load_dwordx4 v[16:19], v3, s[16:17] sc1
    global_load_dwordx4 v[20:23], v4, s[16:17] sc1
    v_mov_b32 v44, 0
    v_mov_b32 v45, 0
    v_mov_b32 v46, 0
    v_mov_b32 v47, 0
    v_mov_b32 v48, 0
    v_mov_b32 v49, 0
    v_mov_b32 v50, 0
    v_mov_b32 v51, 0
    v_mov_b32 v52, 0
    v_mov_b32 v53, 0
    v_mov_b32 v54, 0
    v_mov_b32 v55, 0
    v_mov_b32 v56, 0
    v_mov_b32 v57, 0
    v_mov_b32 v58, 0
    v_mov_b32 v59, 0
    v_mov_b32 v60, 0
    v_mov_b32 v61, 0
    v_mov_b32 v62, 0
    v_mov_b32 v63, 0
    v_mov_b32 v64, 0
    v_mov_b32 v65, 0
    v_mov_b32 v66, 0
    v_mov_b32 v67, 0
    v_mov_b32 v68, 0
    v_mov_b32 v69, 0
    v_mov_b32 v70, 0
    v_mov_b32 v71, 0
    global_load_dwordx4 v[16:19], v3, s[16:17] sc1
    global_load_dwordx4 v[20:23], v4, s[16:17] sc1
G_pl_2:
    s_waitcnt vmcnt(2)
    v_max3_u32 v15, v16, v17, v18
    v_max3_u32 v15, v15, v19, v20
    v_max3_u32 v15, v15, v21, v22
    v_max_u32 v15, v15, v23
    v_cmp_eq_u32 vcc, -1, v15
    s_cbranch_vccnz G_pr_2

    ds_write_b128 v3, v[16:19]
    ds_write_b128 v4, v[20:23]

    v_smfmac_f32_16x16x64_bf16 v[68:71], v[16:19], v[200:207], v6
    v_smfmac_f32_16x16x64_bf16 v[64:67], v[16:19], v[144:151], v6
    v_smfmac_f32_16x16x64_bf16 v[60:63], v[16:19], a[224:231], v6
    v_smfmac_f32_16x16x64_bf16 v[56:59], v[16:19], a[168:175], v6
    v_smfmac_f32_16x16x64_bf16 v[52:55], v[16:19], a[112:119], v6
    v_smfmac_f32_16x16x64_bf16 v[48:51], v[16:19], a[56:63], v6
    v_smfmac_f32_16x16x64_bf16 v[44:47], v[16:19], a[0:7], v6
    v_smfmac_f32_16x16x64_bf16 v[68:71], v[20:23], v[208:215], v6
    s_waitcnt lgkmcnt(0)
    s_barrier

    ds_read_b128 v[24:27], v113
    v_smfmac_f32_16x16x64_bf16 v[64:67], v[20:23], v[152:159], v6
    ds_read_b128 v[28:31], v116
    v_smfmac_f32_16x16x64_bf16 v[60:63], v[20:23], a[232:239], v6
    ds_read_b128 v[32:35], v117
    v_smfmac_f32_16x16x64_bf16 v[56:59], v[20:23], a[176:183], v6
    ds_read_b128 v[36:39], v118
    v_smfmac_f32_16x16x64_bf16 v[52:55], v[20:23], a[120:127], v6
    ds_read_b128 v[40:43], v119
    v_smfmac_f32_16x16x64_bf16 v[48:51], v[20:23], a[64:71], v6
    ds_read_b64 v[114:115], v8
    v_smfmac_f32_16x16x64_bf16 v[44:47], v[20:23], a[8:15], v6
    s_waitcnt lgkmcnt(5)
    v_smfmac_f32_16x16x64_bf16 v[44:47], v[24:27], a[16:23], v6
    v_smfmac_f32_16x16x64_bf16 v[48:51], v[24:27], a[72:79], v6
    s_waitcnt lgkmcnt(4)
    v_smfmac_f32_16x16x64_bf16 v[44:47], v[28:31], a[24:31], v6
    v_smfmac_f32_16x16x64_bf16 v[48:51], v[28:31], a[80:87], v6
    s_waitcnt lgkmcnt(3)
    v_smfmac_f32_16x16x64_bf16 v[44:47], v[32:35], a[32:39], v6
    v_smfmac_f32_16x16x64_bf16 v[48:51], v[32:35], a[88:95], v6
    s_waitcnt lgkmcnt(2)
    v_smfmac_f32_16x16x64_bf16 v[44:47], v[36:39], a[40:47], v6
    v_smfmac_f32_16x16x64_bf16 v[48:51], v[36:39], a[96:103], v6
    s_waitcnt lgkmcnt(1)
    v_smfmac_f32_16x16x64_bf16 v[44:47], v[40:43], a[48:55], v6
    v_smfmac_f32_16x16x64_bf16 v[48:51], v[40:43], a[104:111], v6
    v_smfmac_f32_16x16x64_bf16 v[52:55], v[24:27], a[128:135], v6
    v_smfmac_f32_16x16x64_bf16 v[56:59], v[24:27], a[184:191], v6
    v_smfmac_f32_16x16x64_bf16 v[52:55], v[28:31], a[136:143], v6
    v_cvt_pk_bf16_f32 v44, v44, v45
    v_smfmac_f32_16x16x64_bf16 v[56:59], v[28:31], a[192:199], v6
    v_cvt_pk_bf16_f32 v45, v46, v47
    ds_write_b64 v9, v[44:45] offset:0
    v_smfmac_f32_16x16x64_bf16 v[52:55], v[32:35], a[144:151], v6
    v_cvt_pk_bf16_f32 v48, v48, v49
    v_smfmac_f32_16x16x64_bf16 v[56:59], v[32:35], a[200:207], v6
    v_cvt_pk_bf16_f32 v49, v50, v51
    ds_write_b64 v9, v[48:49] offset:512
    v_smfmac_f32_16x16x64_bf16 v[52:55], v[36:39], a[152:159], v6
    ds_read_b64_tr_b16 v[44:45], v0 offset:0
    v_smfmac_f32_16x16x64_bf16 v[56:59], v[36:39], a[208:215], v6
    ds_read_b64_tr_b16 v[46:47], v0 offset:256
    v_smfmac_f32_16x16x64_bf16 v[52:55], v[40:43], a[160:167], v6
    ds_read_b128 v[48:51], v7 offset:0
    v_smfmac_f32_16x16x64_bf16 v[56:59], v[40:43], a[216:223], v6
    v_smfmac_f32_16x16x64_bf16 v[60:63], v[24:27], a[240:247], v6
    v_smfmac_f32_16x16x64_bf16 v[64:67], v[24:27], v[160:167], v6
    v_smfmac_f32_16x16x64_bf16 v[60:63], v[28:31], a[248:255], v6
    v_cvt_pk_bf16_f32 v52, v52, v53
    v_smfmac_f32_16x16x64_bf16 v[64:67], v[28:31], v[168:175], v6
    v_cvt_pk_bf16_f32 v53, v54, v55
    ds_write_b64 v9, v[52:53] offset:1024
    v_smfmac_f32_16x16x64_bf16 v[60:63], v[32:35], v[120:127], v6
    v_cvt_pk_bf16_f32 v56, v56, v57
    v_smfmac_f32_16x16x64_bf16 v[64:67], v[32:35], v[176:183], v6
    v_cvt_pk_bf16_f32 v57, v58, v59
    ds_write_b64 v9, v[56:57] offset:1536
    v_smfmac_f32_16x16x64_bf16 v[60:63], v[36:39], v[128:135], v6
    ds_read_b64_tr_b16 v[52:53], v0 offset:1024
    v_smfmac_f32_16x16x64_bf16 v[64:67], v[36:39], v[184:191], v6
    ds_read_b64_tr_b16 v[54:55], v0 offset:1280
    v_smfmac_f32_16x16x64_bf16 v[60:63], v[40:43], v[136:143], v6
    ds_read_b128 v[56:59], v7 offset:512
    v_smfmac_f32_16x16x64_bf16 v[64:67], v[40:43], v[192:199], v6
    v_smfmac_f32_16x16x64_bf16 v[68:71], v[24:27], v[216:223], v6
    v_smfmac_f32_16x16x64_bf16 v[68:71], v[28:31], v[224:231], v6
    v_smfmac_f32_16x16x64_bf16 v[68:71], v[32:35], v[232:239], v6
    v_cvt_pk_bf16_f32 v60, v60, v61
    v_smfmac_f32_16x16x64_bf16 v[68:71], v[36:39], v[240:247], v6
    v_cvt_pk_bf16_f32 v61, v62, v63
    ds_write_b64 v9, v[60:61] offset:2048
    v_smfmac_f32_16x16x64_bf16 v[68:71], v[40:43], v[248:255], v6
    v_cvt_pk_bf16_f32 v64, v64, v65

    s_waitcnt lgkmcnt(1)
    v_mfma_f32_16x16x32_bf16 v[100:103], v[72:75], v[44:47], 0
    v_cvt_pk_bf16_f32 v65, v66, v67
    ds_write_b64 v9, v[64:65] offset:2560
    ds_read_b64_tr_b16 v[60:61], v0 offset:2048
    ds_read_b64_tr_b16 v[62:63], v0 offset:2304
    v_mfma_f32_16x16x32_bf16 v[104:107], v[84:87], v[44:47], 0
    ds_read_b128 v[64:67], v7 offset:1024
    v_cvt_pk_bf16_f32 v68, v68, v69
    v_cvt_pk_bf16_f32 v69, v70, v71
    ds_write_b64 v9, v[68:69] offset:3072
    ds_read_b64_tr_b16 v[70:71], v112
    v_mfma_f32_16x16x32_bf16 v[108:111], v[48:51], v[44:47], 0
    v_mfma_f32_16x16x32_bf16 v[100:103], v[76:79], v[52:55], v[100:103]
    v_mfma_f32_16x16x32_bf16 v[104:107], v[88:91], v[52:55], v[104:107]
    v_mfma_f32_16x16x32_bf16 v[108:111], v[56:59], v[52:55], v[108:111]
    s_waitcnt lgkmcnt(2)
    v_mfma_f32_16x16x32_bf16 v[100:103], v[80:83], v[60:63], v[100:103]
    v_mfma_f32_16x16x32_bf16 v[104:107], v[92:95], v[60:63], v[104:107]
    v_mfma_f32_16x16x32_bf16 v[108:111], v[64:67], v[60:63], v[108:111]
    s_waitcnt lgkmcnt(0)
    v_mfma_f32_16x16x16_bf16 v[100:103], v[96:97], v[70:71], v[100:103]
    v_mfma_f32_16x16x16_bf16 v[104:107], v[98:99], v[70:71], v[104:107]
    v_mfma_f32_16x16x16_bf16 v[108:111], v[114:115], v[70:71], v[108:111]
    v_add_f32_dpp v100, v100, v100 row_ror:8 row_mask:0xf bank_mask:0xf
    v_add_f32_dpp v101, v101, v101 row_ror:8 row_mask:0xf bank_mask:0xf
    v_add_f32_dpp v102, v102, v102 row_ror:8 row_mask:0xf bank_mask:0xf
    v_add_f32_dpp v103, v103, v103 row_ror:8 row_mask:0xf bank_mask:0xf
    v_add_f32_dpp v104, v104, v104 row_ror:8 row_mask:0xf bank_mask:0xf
    v_add_f32_dpp v105, v105, v105 row_ror:8 row_mask:0xf bank_mask:0xf
    v_add_f32_dpp v106, v106, v106 row_ror:8 row_mask:0xf bank_mask:0xf
    v_add_f32_dpp v107, v107, v107 row_ror:8 row_mask:0xf bank_mask:0xf
    v_add_f32_dpp v108, v108, v108 row_ror:8 row_mask:0xf bank_mask:0xf
    v_add_f32_dpp v109, v109, v109 row_ror:8 row_mask:0xf bank_mask:0xf
    v_add_f32_dpp v110, v110, v110 row_ror:8 row_mask:0xf bank_mask:0xf
    v_add_f32_dpp v111, v111, v111 row_ror:8 row_mask:0xf bank_mask:0xf

    s_mov_b64 exec, s[36:37]
    ds_write_b128 v10, v[100:103]
    ds_write_b128 v10, v[104:107] offset:64
    s_mov_b32 exec_hi, 0
    ds_write_b128 v10, v[108:111] offset:128
    s_mov_b64 exec, -1
    s_waitcnt vmcnt(0) lgkmcnt(0)

    s_barrier

    ds_read_b64 v[16:17], v11 offset:0
    ds_read_b64 v[18:19], v11 offset:1664
    ds_read_b64 v[20:21], v11 offset:3328
    ds_read_b64 v[22:23], v11 offset:4992
    ds_read_b64 v[24:25], v12 offset:0
    ds_read_b64 v[26:27], v12 offset:1664
    ds_read_b64 v[28:29], v12 offset:3328
    ds_read_b64 v[30:31], v12 offset:4992

    s_add_u32 s24, s24, 28672
    s_addc_u32 s25, s25, 0
    s_add_u32 s52, s52, 28672
    s_addc_u32 s53, s53, 0
    s_waitcnt lgkmcnt(4)
    v_pk_add_f32 v[16:17], v[16:17], v[18:19]
    v_pk_add_f32 v[20:21], v[20:21], v[22:23]
    s_waitcnt lgkmcnt(0)
    v_pk_add_f32 v[24:25], v[24:25], v[26:27]
    v_pk_add_f32 v[28:29], v[28:29], v[30:31]
    v_pk_add_f32 v[16:17], v[16:17], v[20:21]
    v_pk_add_f32 v[24:25], v[24:25], v[28:29]
    v_max_f32 v32, v16, v17
    v_max3_f32 v32, v32, v24, v25

    s_nop 1
    v_max_f32_dpp v32, v32, v32 quad_perm:[1,0,3,2] row_mask:0xf bank_mask:0xf
    s_nop 1
    v_max_f32_dpp v32, v32, v32 quad_perm:[2,3,0,1] row_mask:0xf bank_mask:0xf
    s_nop 1
    v_max_f32_dpp v32, v32, v32 row_half_mirror row_mask:0xf bank_mask:0xf
    s_nop 1
    v_max_f32_dpp v32, v32, v32 row_mirror row_mask:0xf bank_mask:0xf

    v_sub_f32 v24, v24, v32
    v_sub_f32 v25, v25, v32
    v_sub_f32 v16, v16, v32
    v_sub_f32 v17, v17, v32
    v_exp_f32 v24, v24
    v_exp_f32 v25, v25
    v_exp_f32 v16, v16
    v_exp_f32 v17, v17
    v_add_f32 v33, v24, v25
    v_fma_f32 v33, v33, s34, v16
    v_add_f32 v33, v33, v17

    s_nop 1
    v_add_f32_dpp v33, v33, v33 quad_perm:[1,0,3,2] row_mask:0xf bank_mask:0xf
    s_nop 1
    v_add_f32_dpp v33, v33, v33 quad_perm:[2,3,0,1] row_mask:0xf bank_mask:0xf
    s_nop 1
    v_add_f32_dpp v33, v33, v33 row_half_mirror row_mask:0xf bank_mask:0xf
    s_nop 1
    v_add_f32_dpp v33, v33, v33 row_mirror row_mask:0xf bank_mask:0xf

    v_rcp_f32 v33, v33
    s_mov_b32 exec_hi, 0
    v_mul_f32 v16, v16, v33
    v_mul_f32 v17, v17, v33
    v_mul_f32 v24, v24, v33
    v_mul_f32 v25, v25, v33
    v_cvt_pk_bf16_f32 v36, v16, v17
    v_cvt_pk_bf16_f32 v37, v24, v25
    s_cmp_eq_u32 s20, 1
    s_cbranch_scc0 G_slowst_2
    global_store_dword v13, v36, s[18:19]
    s_mov_b64 exec, 0x000f000f
    global_store_dword v14, v37, s[18:19]
    global_store_dword v14, v2, s[50:51]
    s_mov_b32 exec_lo, -1
    global_store_dword v13, v2, s[50:51]
G_stdone_2:
    s_mov_b64 exec, -1

    s_add_u32 s14, s14, 1
    s_cmp_ge_u32 s14, 63
    s_cbranch_scc1 M_end

    global_load_dwordx4 v[72:75], v1, s[24:25] offset:0
    global_load_dwordx4 v[76:79], v1, s[24:25] offset:1024
    global_load_dwordx4 v[80:83], v1, s[24:25] offset:2048
    global_load_dwordx4 v[84:87], v1, s[24:25] offset:3072
    global_load_dwordx4 v[88:91], v1, s[52:53] offset:0
    global_load_dwordx4 v[92:95], v1, s[52:53] offset:1024
    global_load_dwordx4 v[96:99], v1, s[52:53] offset:2048

    s_add_u32 s16, s16, 32768
    s_addc_u32 s17, s17, 0
    s_add_u32 s18, s18, 32768
    s_addc_u32 s19, s19, 0
    s_add_u32 s50, s50, 32768
    s_addc_u32 s51, s51, 0

    s_sleep 9
    s_branch G_loop_2
G_loop_3:

    global_load_dwordx4 v[16:19], v3, s[16:17] sc1
    global_load_dwordx4 v[20:23], v4, s[16:17] sc1
    v_mov_b32 v44, 0
    v_mov_b32 v45, 0
    v_mov_b32 v46, 0
    v_mov_b32 v47, 0
    v_mov_b32 v48, 0
    v_mov_b32 v49, 0
    v_mov_b32 v50, 0
    v_mov_b32 v51, 0
    v_mov_b32 v52, 0
    v_mov_b32 v53, 0
    v_mov_b32 v54, 0
    v_mov_b32 v55, 0
    v_mov_b32 v56, 0
    v_mov_b32 v57, 0
    v_mov_b32 v58, 0
    v_mov_b32 v59, 0
    v_mov_b32 v60, 0
    v_mov_b32 v61, 0
    v_mov_b32 v62, 0
    v_mov_b32 v63, 0
    v_mov_b32 v64, 0
    v_mov_b32 v65, 0
    v_mov_b32 v66, 0
    v_mov_b32 v67, 0
    v_mov_b32 v68, 0
    v_mov_b32 v69, 0
    v_mov_b32 v70, 0
    v_mov_b32 v71, 0
    global_load_dwordx4 v[16:19], v3, s[16:17] sc1
    global_load_dwordx4 v[20:23], v4, s[16:17] sc1
G_pl_3:
    s_waitcnt vmcnt(2)
    v_max3_u32 v15, v16, v17, v18
    v_max3_u32 v15, v15, v19, v20
    v_max3_u32 v15, v15, v21, v22
    v_max_u32 v15, v15, v23
    v_cmp_eq_u32 vcc, -1, v15
    s_cbranch_vccnz G_pr_3

    ds_write_b128 v3, v[16:19]
    ds_write_b128 v4, v[20:23]

    v_smfmac_f32_16x16x64_bf16 v[68:71], v[16:19], v[200:207], v6
    v_smfmac_f32_16x16x64_bf16 v[64:67], v[16:19], v[144:151], v6
    v_smfmac_f32_16x16x64_bf16 v[60:63], v[16:19], a[224:231], v6
    v_smfmac_f32_16x16x64_bf16 v[56:59], v[16:19], a[168:175], v6
    v_smfmac_f32_16x16x64_bf16 v[52:55], v[16:19], a[112:119], v6
    v_smfmac_f32_16x16x64_bf16 v[48:51], v[16:19], a[56:63], v6
    v_smfmac_f32_16x16x64_bf16 v[44:47], v[16:19], a[0:7], v6
    v_smfmac_f32_16x16x64_bf16 v[68:71], v[20:23], v[208:215], v6
    s_waitcnt lgkmcnt(0)
    s_barrier

    ds_read_b128 v[24:27], v113
    v_smfmac_f32_16x16x64_bf16 v[64:67], v[20:23], v[152:159], v6
    ds_read_b128 v[28:31], v116
    v_smfmac_f32_16x16x64_bf16 v[60:63], v[20:23], a[232:239], v6
    ds_read_b128 v[32:35], v117
    v_smfmac_f32_16x16x64_bf16 v[56:59], v[20:23], a[176:183], v6
    ds_read_b128 v[36:39], v118
    v_smfmac_f32_16x16x64_bf16 v[52:55], v[20:23], a[120:127], v6
    ds_read_b128 v[40:43], v119
    v_smfmac_f32_16x16x64_bf16 v[48:51], v[20:23], a[64:71], v6
    ds_read_b64 v[114:115], v8
    v_smfmac_f32_16x16x64_bf16 v[44:47], v[20:23], a[8:15], v6
    s_waitcnt lgkmcnt(5)
    v_smfmac_f32_16x16x64_bf16 v[44:47], v[24:27], a[16:23], v6
    v_smfmac_f32_16x16x64_bf16 v[48:51], v[24:27], a[72:79], v6
    s_waitcnt lgkmcnt(4)
    v_smfmac_f32_16x16x64_bf16 v[44:47], v[28:31], a[24:31], v6
    v_smfmac_f32_16x16x64_bf16 v[48:51], v[28:31], a[80:87], v6
    s_waitcnt lgkmcnt(3)
    v_smfmac_f32_16x16x64_bf16 v[44:47], v[32:35], a[32:39], v6
    v_smfmac_f32_16x16x64_bf16 v[48:51], v[32:35], a[88:95], v6
    s_waitcnt lgkmcnt(2)
    v_smfmac_f32_16x16x64_bf16 v[44:47], v[36:39], a[40:47], v6
    v_smfmac_f32_16x16x64_bf16 v[48:51], v[36:39], a[96:103], v6
    s_waitcnt lgkmcnt(1)
    v_smfmac_f32_16x16x64_bf16 v[44:47], v[40:43], a[48:55], v6
    v_smfmac_f32_16x16x64_bf16 v[48:51], v[40:43], a[104:111], v6
    v_smfmac_f32_16x16x64_bf16 v[52:55], v[24:27], a[128:135], v6
    v_smfmac_f32_16x16x64_bf16 v[56:59], v[24:27], a[184:191], v6
    v_smfmac_f32_16x16x64_bf16 v[52:55], v[28:31], a[136:143], v6
    v_smfmac_f32_16x16x64_bf16 v[56:59], v[28:31], a[192:199], v6
    v_cvt_pk_bf16_f32 v44, v44, v45
    v_smfmac_f32_16x16x64_bf16 v[52:55], v[32:35], a[144:151], v6
    v_cvt_pk_bf16_f32 v45, v46, v47
    ds_write_b64 v9, v[44:45] offset:0
    v_smfmac_f32_16x16x64_bf16 v[56:59], v[32:35], a[200:207], v6
    v_cvt_pk_bf16_f32 v48, v48, v49
    v_smfmac_f32_16x16x64_bf16 v[52:55], v[36:39], a[152:159], v6
    v_cvt_pk_bf16_f32 v49, v50, v51
    ds_write_b64 v9, v[48:49] offset:512
    v_smfmac_f32_16x16x64_bf16 v[56:59], v[36:39], a[208:215], v6
    ds_read_b64_tr_b16 v[44:45], v0 offset:0
    v_smfmac_f32_16x16x64_bf16 v[52:55], v[40:43], a[160:167], v6
    ds_read_b64_tr_b16 v[46:47], v0 offset:256
    v_smfmac_f32_16x16x64_bf16 v[56:59], v[40:43], a[216:223], v6
    ds_read_b128 v[48:51], v7 offset:0
    v_smfmac_f32_16x16x64_bf16 v[60:63], v[24:27], a[240:247], v6
    v_smfmac_f32_16x16x64_bf16 v[64:67], v[24:27], v[160:167], v6
    v_smfmac_f32_16x16x64_bf16 v[60:63], v[28:31], a[248:255], v6
    v_smfmac_f32_16x16x64_bf16 v[64:67], v[28:31], v[168:175], v6
    v_cvt_pk_bf16_f32 v52, v52, v53
    v_smfmac_f32_16x16x64_bf16 v[60:63], v[32:35], v[120:127], v6
    v_cvt_pk_bf16_f32 v53, v54, v55
    ds_write_b64 v9, v[52:53] offset:1024
    v_smfmac_f32_16x16x64_bf16 v[64:67], v[32:35], v[176:183], v6
    v_cvt_pk_bf16_f32 v56, v56, v57
    v_smfmac_f32_16x16x64_bf16 v[60:63], v[36:39], v[128:135], v6
    v_cvt_pk_bf16_f32 v57, v58, v59
    ds_write_b64 v9, v[56:57] offset:1536
    v_smfmac_f32_16x16x64_bf16 v[64:67], v[36:39], v[184:191], v6
    ds_read_b64_tr_b16 v[52:53], v0 offset:1024
    v_smfmac_f32_16x16x64_bf16 v[60:63], v[40:43], v[136:143], v6
    ds_read_b64_tr_b16 v[54:55], v0 offset:1280
    v_smfmac_f32_16x16x64_bf16 v[64:67], v[40:43], v[192:199], v6
    ds_read_b128 v[56:59], v7 offset:512
    v_smfmac_f32_16x16x64_bf16 v[68:71], v[24:27], v[216:223], v6
    v_smfmac_f32_16x16x64_bf16 v[68:71], v[28:31], v[224:231], v6
    v_smfmac_f32_16x16x64_bf16 v[68:71], v[32:35], v[232:239], v6
    v_cvt_pk_bf16_f32 v60, v60, v61
    v_smfmac_f32_16x16x64_bf16 v[68:71], v[36:39], v[240:247], v6
    v_cvt_pk_bf16_f32 v61, v62, v63
    ds_write_b64 v9, v[60:61] offset:2048
    v_smfmac_f32_16x16x64_bf16 v[68:71], v[40:43], v[248:255], v6
    v_cvt_pk_bf16_f32 v64, v64, v65

    s_waitcnt lgkmcnt(1)
    v_mfma_f32_16x16x32_bf16 v[100:103], v[72:75], v[44:47], 0
    v_cvt_pk_bf16_f32 v65, v66, v67
    ds_write_b64 v9, v[64:65] offset:2560
    ds_read_b64_tr_b16 v[60:61], v0 offset:2048
    ds_read_b64_tr_b16 v[62:63], v0 offset:2304
    v_mfma_f32_16x16x32_bf16 v[104:107], v[84:87], v[44:47], 0
    ds_read_b128 v[64:67], v7 offset:1024
    v_cvt_pk_bf16_f32 v68, v68, v69
    v_cvt_pk_bf16_f32 v69, v70, v71
    ds_write_b64 v9, v[68:69] offset:3072
    ds_read_b64_tr_b16 v[70:71], v112
    v_mfma_f32_16x16x32_bf16 v[108:111], v[48:51], v[44:47], 0
    v_mfma_f32_16x16x32_bf16 v[100:103], v[76:79], v[52:55], v[100:103]
    v_mfma_f32_16x16x32_bf16 v[104:107], v[88:91], v[52:55], v[104:107]
    v_mfma_f32_16x16x32_bf16 v[108:111], v[56:59], v[52:55], v[108:111]
    s_waitcnt lgkmcnt(2)
    v_mfma_f32_16x16x32_bf16 v[100:103], v[80:83], v[60:63], v[100:103]
    v_mfma_f32_16x16x32_bf16 v[104:107], v[92:95], v[60:63], v[104:107]
    v_mfma_f32_16x16x32_bf16 v[108:111], v[64:67], v[60:63], v[108:111]
    s_waitcnt lgkmcnt(0)
    v_mfma_f32_16x16x16_bf16 v[100:103], v[96:97], v[70:71], v[100:103]
    v_mfma_f32_16x16x16_bf16 v[104:107], v[98:99], v[70:71], v[104:107]
    v_mfma_f32_16x16x16_bf16 v[108:111], v[114:115], v[70:71], v[108:111]
    v_add_f32_dpp v100, v100, v100 row_ror:8 row_mask:0xf bank_mask:0xf
    v_add_f32_dpp v101, v101, v101 row_ror:8 row_mask:0xf bank_mask:0xf
    v_add_f32_dpp v102, v102, v102 row_ror:8 row_mask:0xf bank_mask:0xf
    v_add_f32_dpp v103, v103, v103 row_ror:8 row_mask:0xf bank_mask:0xf
    v_add_f32_dpp v104, v104, v104 row_ror:8 row_mask:0xf bank_mask:0xf
    v_add_f32_dpp v105, v105, v105 row_ror:8 row_mask:0xf bank_mask:0xf
    v_add_f32_dpp v106, v106, v106 row_ror:8 row_mask:0xf bank_mask:0xf
    v_add_f32_dpp v107, v107, v107 row_ror:8 row_mask:0xf bank_mask:0xf
    v_add_f32_dpp v108, v108, v108 row_ror:8 row_mask:0xf bank_mask:0xf
    v_add_f32_dpp v109, v109, v109 row_ror:8 row_mask:0xf bank_mask:0xf
    v_add_f32_dpp v110, v110, v110 row_ror:8 row_mask:0xf bank_mask:0xf
    v_add_f32_dpp v111, v111, v111 row_ror:8 row_mask:0xf bank_mask:0xf

    s_mov_b64 exec, s[36:37]
    ds_write_b128 v10, v[100:103]
    ds_write_b128 v10, v[104:107] offset:64
    s_mov_b32 exec_hi, 0
    ds_write_b128 v10, v[108:111] offset:128
    s_mov_b64 exec, -1
    s_waitcnt vmcnt(0) lgkmcnt(0)

    s_barrier

    ds_read_b64 v[16:17], v11 offset:0
    ds_read_b64 v[18:19], v11 offset:1664
    ds_read_b64 v[20:21], v11 offset:3328
    ds_read_b64 v[22:23], v11 offset:4992
    ds_read_b64 v[24:25], v12 offset:0
    ds_read_b64 v[26:27], v12 offset:1664
    ds_read_b64 v[28:29], v12 offset:3328
    ds_read_b64 v[30:31], v12 offset:4992

    s_add_u32 s24, s24, 28672
    s_addc_u32 s25, s25, 0
    s_add_u32 s52, s52, 28672
    s_addc_u32 s53, s53, 0
    s_waitcnt lgkmcnt(4)
    v_pk_add_f32 v[16:17], v[16:17], v[18:19]
    v_pk_add_f32 v[20:21], v[20:21], v[22:23]
    s_waitcnt lgkmcnt(0)
    v_pk_add_f32 v[24:25], v[24:25], v[26:27]
    v_pk_add_f32 v[28:29], v[28:29], v[30:31]
    v_pk_add_f32 v[16:17], v[16:17], v[20:21]
    v_pk_add_f32 v[24:25], v[24:25], v[28:29]
    v_max_f32 v32, v16, v17
    v_max3_f32 v32, v32, v24, v25

    s_nop 1
    v_max_f32_dpp v32, v32, v32 quad_perm:[1,0,3,2] row_mask:0xf bank_mask:0xf
    s_nop 1
    v_max_f32_dpp v32, v32, v32 quad_perm:[2,3,0,1] row_mask:0xf bank_mask:0xf
    s_nop 1
    v_max_f32_dpp v32, v32, v32 row_half_mirror row_mask:0xf bank_mask:0xf
    s_nop 1
    v_max_f32_dpp v32, v32, v32 row_mirror row_mask:0xf bank_mask:0xf

    v_sub_f32 v24, v24, v32
    v_sub_f32 v25, v25, v32
    v_sub_f32 v16, v16, v32
    v_sub_f32 v17, v17, v32
    v_exp_f32 v24, v24
    v_exp_f32 v25, v25
    v_exp_f32 v16, v16
    v_exp_f32 v17, v17
    v_add_f32 v33, v24, v25
    v_fma_f32 v33, v33, s34, v16
    v_add_f32 v33, v33, v17

    s_nop 1
    v_add_f32_dpp v33, v33, v33 quad_perm:[1,0,3,2] row_mask:0xf bank_mask:0xf
    s_nop 1
    v_add_f32_dpp v33, v33, v33 quad_perm:[2,3,0,1] row_mask:0xf bank_mask:0xf
    s_nop 1
    v_add_f32_dpp v33, v33, v33 row_half_mirror row_mask:0xf bank_mask:0xf
    s_nop 1
    v_add_f32_dpp v33, v33, v33 row_mirror row_mask:0xf bank_mask:0xf

    v_rcp_f32 v33, v33
    s_mov_b32 exec_hi, 0
    v_mul_f32 v16, v16, v33
    v_mul_f32 v17, v17, v33
    v_mul_f32 v24, v24, v33
    v_mul_f32 v25, v25, v33
    v_cvt_pk_bf16_f32 v36, v16, v17
    v_cvt_pk_bf16_f32 v37, v24, v25
    s_cmp_eq_u32 s20, 1
    s_cbranch_scc0 G_slowst_3
    global_store_dword v13, v36, s[18:19]
    s_mov_b64 exec, 0x000f000f
    global_store_dword v14, v37, s[18:19]
    global_store_dword v14, v2, s[50:51]
    s_mov_b32 exec_lo, -1
    global_store_dword v13, v2, s[50:51]
G_stdone_3:
    s_mov_b64 exec, -1

    s_add_u32 s14, s14, 1
    s_cmp_ge_u32 s14, 63
    s_cbranch_scc1 M_end

    global_load_dwordx4 v[72:75], v1, s[24:25] offset:0
    global_load_dwordx4 v[76:79], v1, s[24:25] offset:1024
    global_load_dwordx4 v[80:83], v1, s[24:25] offset:2048
    global_load_dwordx4 v[84:87], v1, s[24:25] offset:3072
    global_load_dwordx4 v[88:91], v1, s[52:53] offset:0
    global_load_dwordx4 v[92:95], v1, s[52:53] offset:1024
    global_load_dwordx4 v[96:99], v1, s[52:53] offset:2048

    s_add_u32 s16, s16, 32768
    s_addc_u32 s17, s17, 0
    s_add_u32 s18, s18, 32768
    s_addc_u32 s19, s19, 0
    s_add_u32 s50, s50, 32768
    s_addc_u32 s51, s51, 0

    s_sleep 9
    s_branch G_loop_3
R_U:
    s_sub_u32 s26, s27, 16
    s_mov_b32 s90, 0
    s_mov_b32 s91, 0

    s_getreg_b32 s21, hwreg(HW_REG_XCC_ID)
    s_and_b32 s21, s21, 15
    s_add_u32 s21, s21, 1

    s_lshr_b32 s30, s26, 1

    s_lshr_b32 s28, s30, 1
    s_lshl_b32 s28, s28, 2
    s_add_u32 s28, s28, 0
    v_mov_b32 v10, s28
    s_and_b32 s29, s30, 1
    s_lshl_b32 s29, s29, 4
U_cw:
    global_load_dword v11, v10, s[6:7] sc1
    s_waitcnt vmcnt(0)
    v_readfirstlane_b32 s28, v11
    s_lshr_b32 s28, s28, s29
    s_and_b32 s28, s28, 0xffff
    s_cmp_ge_u32 s28, 32
    s_cbranch_scc1 U_cok
    s_sleep 3
    s_sub_u32 s15, s15, 1
    s_cbranch_scc1 M_end
    s_branch U_cw
U_cok:

    s_lshl_b32 s28, s26, 5
    s_lshl_b32 s29, s3, 2
    s_add_u32 s28, s28, s29
    s_mul_i32 s28, s28, 14336
    s_add_u32 s28, s28, 0x640000
    s_add_u32 s30, s4, s28
    s_addc_u32 s31, s5, 0
    v_lshlrev_b32 v2, 4, v1
    s_lshl_b32 s28, s3, 11
    s_add_u32 s28, s28, 8192
    v_add_u32 v7, s28, v2
    s_mov_b32 s14, 0
    s_add_u32 s16, s4, 0xe80000
    s_addc_u32 s17, s5, 0
    s_lshl_b32 s28, s3, 11
    v_add_u32 v3, s28, v2
    s_add_u32 s28, s28, 1024
    s_min_u32 s28, s28, 6144
    v_add_u32 v4, s28, v2
    s_cmp_ge_u32 s3, 2
    s_cbranch_scc1 R_UP

    v_add_u32 v5, 43008, v2
    global_load_dwordx4 v[16:19], v5, s[30:31] offset:0
    global_load_dwordx4 v[24:27], v5, s[30:31] offset:1024
    global_load_dwordx4 v[32:35], v5, s[30:31] offset:2048
    global_load_dwordx4 v[40:43], v5, s[30:31] offset:3072
    v_add_u32 v5, 4096, v5
    global_load_dwordx4 v[48:51], v5, s[30:31] offset:0
    global_load_dwordx4 v[56:59], v5, s[30:31] offset:1024
    global_load_dwordx4 v[64:67], v5, s[30:31] offset:2048
    global_load_dwordx4 v[72:75], v5, s[30:31] offset:3072
    v_add_u32 v5, 4096, v5
    global_load_dwordx4 v[80:83], v5, s[30:31] offset:0
    global_load_dwordx4 v[88:91], v5, s[30:31] offset:1024
    global_load_dwordx4 v[96:99], v5, s[30:31] offset:2048
    global_load_dwordx4 v[104:107], v5, s[30:31] offset:3072
    v_add_u32 v5, 4096, v5
    global_load_dwordx4 v[112:115], v5, s[30:31] offset:0
    global_load_dwordx4 v[120:123], v5, s[30:31] offset:1024
    v_add_u32 v5, 272384, v2
    global_load_dwordx4 v[20:23], v5, s[30:31] offset:0
    global_load_dwordx4 v[28:31], v5, s[30:31] offset:1024
    global_load_dwordx4 v[36:39], v5, s[30:31] offset:2048
    global_load_dwordx4 v[44:47], v5, s[30:31] offset:3072
    v_add_u32 v5, 4096, v5
    global_load_dwordx4 v[52:55], v5, s[30:31] offset:0
    global_load_dwordx4 v[60:63], v5, s[30:31] offset:1024
    global_load_dwordx4 v[68:71], v5, s[30:31] offset:2048
    global_load_dwordx4 v[76:79], v5, s[30:31] offset:3072
    v_add_u32 v5, 4096, v5
    global_load_dwordx4 v[84:87], v5, s[30:31] offset:0
    global_load_dwordx4 v[92:95], v5, s[30:31] offset:1024
    global_load_dwordx4 v[100:103], v5, s[30:31] offset:2048
    global_load_dwordx4 v[108:111], v5, s[30:31] offset:3072
    v_add_u32 v5, 4096, v5
    global_load_dwordx4 v[116:119], v5, s[30:31] offset:0
    global_load_dwordx4 v[124:127], v5, s[30:31] offset:1024
    v_add_u32 v5, 0, v2
    global_load_dwordx4 a[0:3], v5, s[30:31] offset:0
    global_load_dwordx4 a[4:7], v5, s[30:31] offset:1024
    global_load_dwordx4 a[8:11], v5, s[30:31] offset:2048
    global_load_dwordx4 a[12:15], v5, s[30:31] offset:3072
    v_add_u32 v5, 4096, v5
    global_load_dwordx4 a[16:19], v5, s[30:31] offset:0
    global_load_dwordx4 a[20:23], v5, s[30:31] offset:1024
    global_load_dwordx4 a[24:27], v5, s[30:31] offset:2048
    global_load_dwordx4 a[28:31], v5, s[30:31] offset:3072
    v_add_u32 v5, 4096, v5
    global_load_dwordx4 a[32:35], v5, s[30:31] offset:0
    global_load_dwordx4 a[36:39], v5, s[30:31] offset:1024
    global_load_dwordx4 a[40:43], v5, s[30:31] offset:2048
    global_load_dwordx4 a[44:47], v5, s[30:31] offset:3072
    v_add_u32 v5, 4096, v5
    global_load_dwordx4 a[48:51], v5, s[30:31] offset:0
    global_load_dwordx4 a[52:55], v5, s[30:31] offset:1024
    v_add_u32 v5, 229376, v2
    global_load_dwordx4 a[56:59], v5, s[30:31] offset:0
    global_load_dwordx4 a[60:63], v5, s[30:31] offset:1024
    global_load_dwordx4 a[64:67], v5, s[30:31] offset:2048
    global_load_dwordx4 a[68:71], v5, s[30:31] offset:3072
    v_add_u32 v5, 4096, v5
    global_load_dwordx4 a[72:75], v5, s[30:31] offset:0
    global_load_dwordx4 a[76:79], v5, s[30:31] offset:1024
    global_load_dwordx4 a[80:83], v5, s[30:31] offset:2048
    global_load_dwordx4 a[84:87], v5, s[30:31] offset:3072
    v_add_u32 v5, 4096, v5
    global_load_dwordx4 a[88:91], v5, s[30:31] offset:0
    global_load_dwordx4 a[92:95], v5, s[30:31] offset:1024
    global_load_dwordx4 a[96:99], v5, s[30:31] offset:2048
    global_load_dwordx4 a[100:103], v5, s[30:31] offset:3072
    v_add_u32 v5, 4096, v5
    global_load_dwordx4 a[104:107], v5, s[30:31] offset:0
    global_load_dwordx4 a[108:111], v5, s[30:31] offset:1024
    v_add_u32 v5, 14336, v2
    global_load_dwordx4 a[112:115], v5, s[30:31] offset:0
    global_load_dwordx4 a[116:119], v5, s[30:31] offset:1024
    global_load_dwordx4 a[120:123], v5, s[30:31] offset:2048
    global_load_dwordx4 a[124:127], v5, s[30:31] offset:3072
    v_add_u32 v5, 4096, v5
    global_load_dwordx4 a[128:131], v5, s[30:31] offset:0
    global_load_dwordx4 a[132:135], v5, s[30:31] offset:1024
    global_load_dwordx4 a[136:139], v5, s[30:31] offset:2048
    global_load_dwordx4 a[140:143], v5, s[30:31] offset:3072
    v_add_u32 v5, 4096, v5
    global_load_dwordx4 a[144:147], v5, s[30:31] offset:0
    global_load_dwordx4 a[148:151], v5, s[30:31] offset:1024
    global_load_dwordx4 a[152:155], v5, s[30:31] offset:2048
    global_load_dwordx4 a[156:159], v5, s[30:31] offset:3072
    v_add_u32 v5, 4096, v5
    global_load_dwordx4 a[160:163], v5, s[30:31] offset:0
    global_load_dwordx4 a[164:167], v5, s[30:31] offset:1024
    v_add_u32 v5, 243712, v2
    global_load_dwordx4 a[168:171], v5, s[30:31] offset:0
    global_load_dwordx4 a[172:175], v5, s[30:31] offset:1024
    global_load_dwordx4 a[176:179], v5, s[30:31] offset:2048
    global_load_dwordx4 a[180:183], v5, s[30:31] offset:3072
    v_add_u32 v5, 4096, v5
    global_load_dwordx4 a[184:187], v5, s[30:31] offset:0
    global_load_dwordx4 a[188:191], v5, s[30:31] offset:1024
    global_load_dwordx4 a[192:195], v5, s[30:31] offset:2048
    global_load_dwordx4 a[196:199], v5, s[30:31] offset:3072
    v_add_u32 v5, 4096, v5
    global_load_dwordx4 a[200:203], v5, s[30:31] offset:0
    global_load_dwordx4 a[204:207], v5, s[30:31] offset:1024
    global_load_dwordx4 a[208:211], v5, s[30:31] offset:2048
    global_load_dwordx4 a[212:215], v5, s[30:31] offset:3072
    v_add_u32 v5, 4096, v5
    global_load_dwordx4 a[216:219], v5, s[30:31] offset:0
    global_load_dwordx4 a[220:223], v5, s[30:31] offset:1024
    v_add_u32 v5, 28672, v2
    global_load_dwordx4 a[224:227], v5, s[30:31] offset:0
    global_load_dwordx4 a[228:231], v5, s[30:31] offset:1024
    global_load_dwordx4 a[232:235], v5, s[30:31] offset:2048
    global_load_dwordx4 a[236:239], v5, s[30:31] offset:3072
    v_add_u32 v5, 4096, v5
    global_load_dwordx4 a[240:243], v5, s[30:31] offset:0
    global_load_dwordx4 a[244:247], v5, s[30:31] offset:1024
    global_load_dwordx4 a[248:251], v5, s[30:31] offset:2048
    global_load_dwordx4 a[252:255], v5, s[30:31] offset:3072
    v_add_u32 v5, 4096, v5
    global_load_dwordx4 v[176:179], v5, s[30:31] offset:0
    global_load_dwordx4 v[180:183], v5, s[30:31] offset:1024
    global_load_dwordx4 v[184:187], v5, s[30:31] offset:2048
    global_load_dwordx4 v[188:191], v5, s[30:31] offset:3072
    v_add_u32 v5, 4096, v5
    global_load_dwordx4 v[192:195], v5, s[30:31] offset:0
    global_load_dwordx4 v[196:199], v5, s[30:31] offset:1024
    v_add_u32 v5, 258048, v2
    global_load_dwordx4 v[200:203], v5, s[30:31] offset:0
    global_load_dwordx4 v[204:207], v5, s[30:31] offset:1024
    global_load_dwordx4 v[208:211], v5, s[30:31] offset:2048
    global_load_dwordx4 v[212:215], v5, s[30:31] offset:3072
    v_add_u32 v5, 4096, v5
    global_load_dwordx4 v[216:219], v5, s[30:31] offset:0
    global_load_dwordx4 v[220:223], v5, s[30:31] offset:1024
    global_load_dwordx4 v[224:227], v5, s[30:31] offset:2048
    global_load_dwordx4 v[228:231], v5, s[30:31] offset:3072
    v_add_u32 v5, 4096, v5
    global_load_dwordx4 v[232:235], v5, s[30:31] offset:0
    global_load_dwordx4 v[236:239], v5, s[30:31] offset:1024
    global_load_dwordx4 v[240:243], v5, s[30:31] offset:2048
    global_load_dwordx4 v[244:247], v5, s[30:31] offset:3072
    v_add_u32 v5, 4096, v5
    global_load_dwordx4 v[248:251], v5, s[30:31] offset:0
    global_load_dwordx4 v[252:255], v5, s[30:31] offset:1024

    s_mul_i32 s28, s3, 28672
    s_add_u32 s28, s28, 24576
    v_lshl_add_u32 v8, v1, 4, s28
    s_waitcnt vmcnt(63)

    ds_write_b128 v8, v[16:19] offset:0
    ds_write_b128 v8, v[20:23] offset:1024
    ds_write_b128 v8, v[24:27] offset:2048
    ds_write_b128 v8, v[28:31] offset:3072
    ds_write_b128 v8, v[32:35] offset:4096
    ds_write_b128 v8, v[36:39] offset:5120
    ds_write_b128 v8, v[40:43] offset:6144
    ds_write_b128 v8, v[44:47] offset:7168
    ds_write_b128 v8, v[48:51] offset:8192
    ds_write_b128 v8, v[52:55] offset:9216
    ds_write_b128 v8, v[56:59] offset:10240
    ds_write_b128 v8, v[60:63] offset:11264
    ds_write_b128 v8, v[64:67] offset:12288
    ds_write_b128 v8, v[68:71] offset:13312
    ds_write_b128 v8, v[72:75] offset:14336
    ds_write_b128 v8, v[76:79] offset:15360
    ds_write_b128 v8, v[80:83] offset:16384
    ds_write_b128 v8, v[84:87] offset:17408
    ds_write_b128 v8, v[88:91] offset:18432
    ds_write_b128 v8, v[92:95] offset:19456
    ds_write_b128 v8, v[96:99] offset:20480
    ds_write_b128 v8, v[100:103] offset:21504
    ds_write_b128 v8, v[104:107] offset:22528
    ds_write_b128 v8, v[108:111] offset:23552
    ds_write_b128 v8, v[112:115] offset:24576
    ds_write_b128 v8, v[116:119] offset:25600
    ds_write_b128 v8, v[120:123] offset:26624
    ds_write_b128 v8, v[124:127] offset:27648

    v_min_u32 v10, 29, v1
    v_lshlrev_b32 v10, 2, v10
    s_lshl_b32 s28, s2, 8
    s_add_u32 s28, s28, 0x37C0000
    v_mov_b32 v13, s28
U_xp:
    global_load_dword v11, v10, s[6:7] offset:64 sc1
    global_load_dword v12, v13, s[4:5] sc1
    s_waitcnt vmcnt(0)
    v_min_u32 v12, v11, v12
    v_cmp_eq_u32 vcc, 0, v12
    s_cbranch_vccz U_xok
    s_sub_u32 s15, s15, 1
    s_cbranch_scc1 M_end
    s_branch U_xp
U_xok:
    v_cmp_ne_u32 vcc, s21, v11
    s_cmp_eq_u64 vcc, 0
    s_cselect_b32 s20, 1, 0

    v_and_b32 v12, 8, v1
    v_cmp_eq_u32 vcc, 0, v12
    v_mov_b32 v6, 0xeeee
    v_mov_b32 v12, 0x4444
    v_cndmask_b32 v6, v6, v12, vcc

    v_lshlrev_b32 v5, 4, v1
    v_add_u32 v60, 4096, v5
    v_add_u32 v62, 12288, v5
    s_lshl_b32 s28, s3, 13
    s_add_u32 s28, s28, 8192
    v_lshrrev_b32 v11, 5, v1
    v_lshlrev_b32 v11, 10, v11
    v_and_b32 v13, 31, v1
    v_lshl_add_u32 v11, v13, 4, v11
    v_add_u32 v11, s28, v11
    v_bfe_u32 v12, v1, 4, 1
    v_lshlrev_b32 v12, 2, v12
    v_lshrrev_b32 v13, 5, v1
    v_lshl_add_u32 v12, v13, 1, v12
    v_and_b32 v13, 1, v1
    v_add_u32 v12, v12, v13
    v_lshlrev_b32 v12, 4, v12
    s_lshl_b32 s28, s26, 1
    s_add_u32 s28, s28, s3
    s_lshl_b32 s29, s28, 8
    v_add_u32 v12, s29, v12
    v_bfe_u32 v13, v1, 3, 1
    v_lshl_add_u32 v61, v13, 7, v12
    v_bfe_u32 v13, v1, 1, 2
    v_lshl_add_u32 v61, v13, 2, v61
    v_and_b32 v63, 255, v61
    s_lshl_b32 s29, s3, 8
    s_add_u32 s29, s29, 7168
    v_add_u32 v63, s29, v63
    v_bfe_u32 v13, v1, 1, 1
    v_lshl_add_u32 v12, v13, 7, v12
    v_bfe_u32 v13, v1, 2, 2
    v_lshl_add_u32 v12, v13, 2, v12
    v_mov_b32 v13, -1
    v_and_b32 v14, 3, v1
    v_lshlrev_b32 v14, 3, v14
    s_lshl_b32 s29, s28, 5
    s_add_u32 s29, s29, 0x1100000
    v_add_u32 v14, s29, v14
    s_mov_b32 s34, 0x55555555
    s_mov_b32 s35, 0x55555555
    s_mov_b32 s22, 0
    s_mov_b32 s23, 0
    s_add_u32 s18, s4, 0xe84000
    s_addc_u32 s19, s5, 0
    s_add_u32 s38, s4, 0xe88000
    s_addc_u32 s39, s5, 0
    s_add_u32 s40, s4, 0xe8a000
    s_addc_u32 s41, s5, 0
    s_lshl_b32 s28, s28, 14
    s_add_u32 s28, s28, 0x1800000
    s_add_u32 s24, s4, s28
    s_addc_u32 s25, s5, 0
    s_add_u32 s50, s38, 32768
    s_addc_u32 s51, s39, 0
    s_cmp_eq_u32 s20, 1
    s_cbranch_scc0 U_nopw
    global_store_dword v12, v13, s[38:39]
U_nopw:
    s_waitcnt vmcnt(0) lgkmcnt(0)

U_loop:

    s_cmp_gt_u32 s22, s14
    s_cbranch_scc0 U_fl
U_flok:

    global_load_dwordx4 v[44:47], v3, s[16:17] sc1
    global_load_dwordx4 v[48:51], v4, s[16:17] sc1
    v_mov_b32 v72, 0
    v_mov_b32 v73, 0
    v_mov_b32 v74, 0
    v_mov_b32 v75, 0
    v_mov_b32 v76, 0
    v_mov_b32 v77, 0
    v_mov_b32 v78, 0
    v_mov_b32 v79, 0
    v_mov_b32 v80, 0
    v_mov_b32 v81, 0
    v_mov_b32 v82, 0
    v_mov_b32 v83, 0
    v_mov_b32 v84, 0
    v_mov_b32 v85, 0
    v_mov_b32 v86, 0
    v_mov_b32 v87, 0
    v_mov_b32 v88, 0
    v_mov_b32 v89, 0
    v_mov_b32 v90, 0
    v_mov_b32 v91, 0
    v_mov_b32 v92, 0
    v_mov_b32 v93, 0
    v_mov_b32 v94, 0
    v_mov_b32 v95, 0
    v_mov_b32 v96, 0
    v_mov_b32 v97, 0
    v_mov_b32 v98, 0
    v_mov_b32 v99, 0
    v_mov_b32 v100, 0
    v_mov_b32 v101, 0
    v_mov_b32 v102, 0
    v_mov_b32 v103, 0
UF_pl:
    s_waitcnt vmcnt(0)
    v_max3_u32 v15, v44, v45, v46
    v_max3_u32 v15, v15, v47, v48
    v_max3_u32 v15, v15, v49, v50
    v_max_u32 v15, v15, v51
    v_cmp_eq_u32 vcc, -1, v15
    s_cbranch_vccnz UF_pr

    ds_write_b128 v3, v[44:47]
    ds_write_b128 v4, v[48:51]
    ds_read_b128 v[104:107], v8 offset:0
    ds_read_b128 v[108:111], v8 offset:2048
    ds_read_b128 v[112:115], v8 offset:1024
    ds_read_b128 v[116:119], v8 offset:3072
    ds_read_b128 v[120:123], v8 offset:4096
    ds_read_b128 v[124:127], v8 offset:6144
    s_waitcnt lgkmcnt(6)
    s_barrier

    ds_read_b128 v[16:19], v5 offset:0
    ds_read_b128 v[20:23], v5 offset:1024
    ds_read_b128 v[24:27], v5 offset:2048
    ds_read_b128 v[28:31], v5 offset:3072
    ds_read_b128 v[32:35], v5 offset:4096
    ds_read_b128 v[36:39], v5 offset:5120
    ds_read_b128 v[40:43], v5 offset:6144
    s_waitcnt lgkmcnt(6)
    v_smfmac_f32_16x16x64_bf16 v[72:75], v[16:19], a[0:7], v6
    global_load_dwordx4 v[128:131], v60, s[24:25] offset:-4096 sc1
    v_smfmac_f32_16x16x64_bf16 v[80:83], v[16:19], a[112:119], v6
    global_load_dwordx4 v[132:135], v60, s[24:25] offset:-3072 sc1
    v_smfmac_f32_16x16x64_bf16 v[76:79], v[16:19], a[56:63], v6
    global_load_dwordx4 v[136:139], v60, s[24:25] offset:-2048 sc1
    v_smfmac_f32_16x16x64_bf16 v[96:99], v[16:19], v[104:111], v6
    global_load_dwordx4 v[140:143], v60, s[24:25] offset:-1024 sc1
    ds_read_b128 v[104:107], v8 offset:5120
    ds_read_b128 v[108:111], v8 offset:7168
    v_smfmac_f32_16x16x64_bf16 v[84:87], v[16:19], a[168:175], v6
    global_load_dwordx4 v[144:147], v60, s[24:25] offset:0 sc1
    s_waitcnt lgkmcnt(7)
    v_smfmac_f32_16x16x64_bf16 v[72:75], v[20:23], a[8:15], v6
    global_load_dwordx4 v[148:151], v60, s[24:25] offset:1024 sc1
    v_smfmac_f32_16x16x64_bf16 v[80:83], v[20:23], a[120:127], v6
    global_load_dwordx4 v[152:155], v60, s[24:25] offset:2048 sc1
    v_smfmac_f32_16x16x64_bf16 v[100:103], v[16:19], v[112:119], v6
    global_load_dwordx4 v[156:159], v60, s[24:25] offset:3072 sc1
    ds_read_b128 v[112:115], v8 offset:8192
    ds_read_b128 v[116:119], v8 offset:10240
    v_smfmac_f32_16x16x64_bf16 v[76:79], v[20:23], a[64:71], v6
    global_load_dwordx4 v[160:163], v62, s[24:25] offset:-4096 sc1
    v_smfmac_f32_16x16x64_bf16 v[84:87], v[20:23], a[176:183], v6
    global_load_dwordx4 v[164:167], v62, s[24:25] offset:-3072 sc1
    s_waitcnt lgkmcnt(8)
    v_smfmac_f32_16x16x64_bf16 v[72:75], v[24:27], a[16:23], v6
    global_load_dwordx4 v[168:171], v62, s[24:25] offset:-2048 sc1
    v_smfmac_f32_16x16x64_bf16 v[96:99], v[20:23], v[120:127], v6
    global_load_dwordx4 v[172:175], v62, s[24:25] offset:-1024 sc1
    ds_read_b128 v[120:123], v8 offset:9216
    ds_read_b128 v[124:127], v8 offset:11264
    v_smfmac_f32_16x16x64_bf16 v[80:83], v[24:27], a[128:135], v6
    global_load_dwordx4 v[44:47], v62, s[24:25] offset:0 sc1
    v_smfmac_f32_16x16x64_bf16 v[76:79], v[24:27], a[72:79], v6
    global_load_dwordx4 v[48:51], v62, s[24:25] offset:1024 sc1
    v_smfmac_f32_16x16x64_bf16 v[84:87], v[24:27], a[184:191], v6
    global_load_dwordx4 v[52:55], v62, s[24:25] offset:2048 sc1
    s_waitcnt lgkmcnt(4)
    v_smfmac_f32_16x16x64_bf16 v[100:103], v[20:23], v[104:111], v6
    global_load_dwordx4 v[56:59], v62, s[24:25] offset:3072 sc1
    ds_read_b128 v[104:107], v8 offset:12288
    ds_read_b128 v[108:111], v8 offset:14336
    v_smfmac_f32_16x16x64_bf16 v[72:75], v[28:31], a[24:31], v6
    v_smfmac_f32_16x16x64_bf16 v[80:83], v[28:31], a[136:143], v6
    v_smfmac_f32_16x16x64_bf16 v[76:79], v[28:31], a[80:87], v6
    s_waitcnt lgkmcnt(4)
    v_smfmac_f32_16x16x64_bf16 v[96:99], v[24:27], v[112:119], v6
    ds_read_b128 v[112:115], v8 offset:13312
    ds_read_b128 v[116:119], v8 offset:15360
    v_smfmac_f32_16x16x64_bf16 v[84:87], v[28:31], a[192:199], v6
    v_smfmac_f32_16x16x64_bf16 v[72:75], v[32:35], a[32:39], v6
    v_smfmac_f32_16x16x64_bf16 v[80:83], v[32:35], a[144:151], v6
    s_waitcnt lgkmcnt(4)
    v_smfmac_f32_16x16x64_bf16 v[100:103], v[24:27], v[120:127], v6
    ds_read_b128 v[120:123], v8 offset:16384
    ds_read_b128 v[124:127], v8 offset:18432
    v_smfmac_f32_16x16x64_bf16 v[76:79], v[32:35], a[88:95], v6
    v_smfmac_f32_16x16x64_bf16 v[84:87], v[32:35], a[200:207], v6
    v_smfmac_f32_16x16x64_bf16 v[72:75], v[36:39], a[40:47], v6
    s_waitcnt lgkmcnt(4)
    v_smfmac_f32_16x16x64_bf16 v[96:99], v[28:31], v[104:111], v6
    ds_read_b128 v[104:107], v8 offset:17408
    ds_read_b128 v[108:111], v8 offset:19456
    v_smfmac_f32_16x16x64_bf16 v[80:83], v[36:39], a[152:159], v6
    v_smfmac_f32_16x16x64_bf16 v[76:79], v[36:39], a[96:103], v6
    v_smfmac_f32_16x16x64_bf16 v[84:87], v[36:39], a[208:215], v6
    s_waitcnt lgkmcnt(4)
    v_smfmac_f32_16x16x64_bf16 v[100:103], v[28:31], v[112:119], v6
    ds_read_b128 v[112:115], v8 offset:20480
    ds_read_b128 v[116:119], v8 offset:22528
    v_smfmac_f32_16x16x64_bf16 v[72:75], v[40:43], a[48:55], v6
    v_smfmac_f32_16x16x64_bf16 v[80:83], v[40:43], a[160:167], v6
    v_smfmac_f32_16x16x64_bf16 v[76:79], v[40:43], a[104:111], v6
    s_waitcnt lgkmcnt(4)
    v_smfmac_f32_16x16x64_bf16 v[96:99], v[32:35], v[120:127], v6
    ds_read_b128 v[120:123], v8 offset:21504
    ds_read_b128 v[124:127], v8 offset:23552
    v_smfmac_f32_16x16x64_bf16 v[84:87], v[40:43], a[216:223], v6
    v_smfmac_f32_16x16x64_bf16 v[88:91], v[16:19], a[224:231], v6
    v_smfmac_f32_16x16x64_bf16 v[92:95], v[16:19], v[200:207], v6
    s_waitcnt lgkmcnt(4)
    v_smfmac_f32_16x16x64_bf16 v[100:103], v[32:35], v[104:111], v6
    ds_read_b128 v[104:107], v8 offset:24576
    ds_read_b128 v[108:111], v8 offset:26624
    s_add_u32 s28, s14, 2
    s_cmp_gt_u32 s22, s28
    s_cbranch_scc0 U_fa
U_fab:
    v_smfmac_f32_16x16x64_bf16 v[88:91], v[20:23], a[232:239], v6
    v_cvt_pk_bf16_f32 v72, v72, v73
    v_smfmac_f32_16x16x64_bf16 v[92:95], v[20:23], v[208:215], v6
    v_cvt_pk_bf16_f32 v73, v74, v75
    v_smfmac_f32_16x16x64_bf16 v[88:91], v[24:27], a[240:247], v6
    v_cvt_pk_bf16_f32 v74, v80, v81
    s_waitcnt lgkmcnt(4)
    v_smfmac_f32_16x16x64_bf16 v[96:99], v[36:39], v[112:119], v6
    v_cvt_pk_bf16_f32 v75, v82, v83
    ds_write_b128 v7, v[72:75] offset:0
    ds_read_b128 v[112:115], v8 offset:25600
    ds_read_b128 v[116:119], v8 offset:27648
    v_smfmac_f32_16x16x64_bf16 v[92:95], v[24:27], v[216:223], v6
    v_cvt_pk_bf16_f32 v76, v76, v77
    v_smfmac_f32_16x16x64_bf16 v[88:91], v[28:31], a[248:255], v6
    v_cvt_pk_bf16_f32 v77, v78, v79
    v_smfmac_f32_16x16x64_bf16 v[92:95], v[28:31], v[224:231], v6
    v_cvt_pk_bf16_f32 v78, v84, v85
    s_waitcnt lgkmcnt(5)
    v_smfmac_f32_16x16x64_bf16 v[100:103], v[36:39], v[120:127], v6
    v_cvt_pk_bf16_f32 v79, v86, v87
    ds_write_b128 v7, v[76:79] offset:8192
    v_smfmac_f32_16x16x64_bf16 v[88:91], v[32:35], v[176:183], v6
    v_smfmac_f32_16x16x64_bf16 v[92:95], v[32:35], v[232:239], v6
    v_smfmac_f32_16x16x64_bf16 v[88:91], v[36:39], v[184:191], v6
    s_waitcnt lgkmcnt(4)
    v_smfmac_f32_16x16x64_bf16 v[96:99], v[40:43], v[104:111], v6
    v_smfmac_f32_16x16x64_bf16 v[92:95], v[36:39], v[240:247], v6
    v_smfmac_f32_16x16x64_bf16 v[88:91], v[40:43], v[192:199], v6
    v_smfmac_f32_16x16x64_bf16 v[92:95], v[40:43], v[248:255], v6
    s_waitcnt lgkmcnt(1)
    v_smfmac_f32_16x16x64_bf16 v[100:103], v[40:43], v[112:119], v6

    v_mov_b32 v124, 0
    v_mov_b32 v125, 0
    v_mov_b32 v126, 0
    v_mov_b32 v127, 0

    v_cvt_pk_bf16_f32 v88, v88, v89
    v_cvt_pk_bf16_f32 v89, v90, v91
    v_cvt_pk_bf16_f32 v90, v96, v97
    v_cvt_pk_bf16_f32 v91, v98, v99
    ds_write_b128 v7, v[88:91] offset:1024
    v_cvt_pk_bf16_f32 v92, v92, v93
    v_cvt_pk_bf16_f32 v93, v94, v95
    v_cvt_pk_bf16_f32 v94, v100, v101
    v_cvt_pk_bf16_f32 v95, v102, v103
    ds_write_b128 v7, v[92:95] offset:9216
    s_waitcnt lgkmcnt(0)
    s_barrier
    ds_read_b128 v[72:75], v11 offset:0
    ds_read_b128 v[76:79], v11 offset:2048
    ds_read_b128 v[80:83], v11 offset:512
    ds_read_b128 v[84:87], v11 offset:2560
    ds_read_b128 v[88:91], v11 offset:4096
    ds_read_b128 v[92:95], v11 offset:6144
    ds_read_b128 v[96:99], v11 offset:4608
    ds_read_b128 v[100:103], v11 offset:6656

    s_add_u32 s90, s90, s91
    s_mov_b32 s91, 0
    s_cmp_lt_u32 s14, 4
    s_cselect_b32 s90, 0, s90
    s_cmp_lt_u32 s90, 4
    s_cbranch_scc0 Up_ad
    s_sleep 8
Up_adr:

    global_load_dwordx4 v[16:19], v60, s[18:19] offset:-4096 sc1
    global_load_dwordx4 v[20:23], v60, s[18:19] offset:-3072 sc1
    global_load_dwordx4 v[24:27], v60, s[18:19] offset:-2048 sc1
    global_load_dwordx4 v[28:31], v60, s[18:19] offset:-1024 sc1
    global_load_dwordx4 v[32:35], v60, s[18:19] offset:0 sc1
    global_load_dwordx4 v[36:39], v60, s[18:19] offset:1024 sc1
    global_load_dwordx4 v[40:43], v60, s[18:19] offset:2048 sc1
    global_load_dwordx4 v[104:107], v60, s[18:19] offset:3072 sc1
    global_load_dwordx4 v[108:111], v62, s[18:19] offset:-4096 sc1
    global_load_dwordx4 v[112:115], v62, s[18:19] offset:-3072 sc1
Up_C0:
    s_waitcnt vmcnt(7)
    v_max3_u32 v15, v16, v20, v24
    v_cmp_eq_u32 vcc, -1, v15
    s_cbranch_vccnz Up_R0
Up_S0:

    v_smfmac_f32_16x16x64_bf16 v[124:127], v[16:19], v[128:135], v6
    v_smfmac_f32_16x16x64_bf16 v[124:127], v[20:23], v[136:143], v6
    s_waitcnt vmcnt(4)
    v_max3_u32 v15, v28, v32, v36
    v_cmp_eq_u32 vcc, -1, v15
    v_smfmac_f32_16x16x64_bf16 v[124:127], v[24:27], v[144:151], v6
    s_cbranch_vccnz Up_R1
Up_S1:
    v_smfmac_f32_16x16x64_bf16 v[124:127], v[28:31], v[152:159], v6
    v_smfmac_f32_16x16x64_bf16 v[124:127], v[32:35], v[160:167], v6
    s_waitcnt vmcnt(2)
    v_max_u32 v15, v40, v104
    v_cmp_eq_u32 vcc, -1, v15
    v_smfmac_f32_16x16x64_bf16 v[124:127], v[36:39], v[168:175], v6
    s_cbranch_vccnz Up_R2
Up_S2:
    v_smfmac_f32_16x16x64_bf16 v[124:127], v[40:43], v[44:51], v6
    s_waitcnt vmcnt(1)
    v_max_u32 v15, v108, v109
    v_cmp_eq_u32 vcc, -1, v15
    v_smfmac_f32_16x16x64_bf16 v[124:127], v[104:107], v[52:59], v6
    s_cbranch_vccnz Up_R3
Up_S3:
    s_waitcnt lgkmcnt(0)
    v_smfmac_f32_16x16x64_bf16 v[124:127], v[108:111], v[72:79], v6
    s_waitcnt vmcnt(0)
    v_max_u32 v15, v112, v113
    v_cmp_eq_u32 vcc, -1, v15
    v_smfmac_f32_16x16x64_bf16 v[124:127], v[108:111], v[80:87], v6
    s_cbranch_vccnz Up_R4
Up_S4:
    v_smfmac_f32_16x16x64_bf16 v[124:127], v[112:115], v[88:95], v6
    v_smfmac_f32_16x16x64_bf16 v[124:127], v[112:115], v[96:103], v6
U_tail:

    s_mov_b64 vcc, s[34:35]
    s_nop 6
    v_permlane32_swap_b32 v124, v126
    v_permlane32_swap_b32 v125, v127
    v_add_f32 v124, v124, v126
    v_add_f32 v125, v125, v127
    s_nop 1
    v_cndmask_b32_dpp v126, v125, v124, vcc quad_perm:[1,0,3,2] row_mask:0xf bank_mask:0xf
    s_not_b64 vcc, vcc
    v_cndmask_b32_dpp v127, v124, v125, vcc quad_perm:[1,0,3,2] row_mask:0xf bank_mask:0xf
    s_cmp_eq_u32 s20, 1
    v_cmp_u_f32 vcc, v126, v127
    v_cvt_pk_bf16_f32 v126, v126, v127
    v_min_u32 v9, -2, v126
    s_cbranch_vccnz Up_redo
    s_cbranch_scc0 U_slowst
    global_store_dword v12, v9, s[38:39]
    global_store_dword v12, v13, s[50:51]

U_stdone:
    ds_write_b32 v63, v9

    s_cmp_eq_u32 s23, 0
    s_cbranch_scc0 U_fu
U_fub:

    s_add_u32 s14, s14, 1
    s_cmp_ge_u32 s14, 63
    s_cbranch_scc1 U_last
    s_add_u32 s16, s16, 32768
    s_addc_u32 s17, s17, 0
    s_add_u32 s18, s18, 32768
    s_addc_u32 s19, s19, 0
    s_add_u32 s38, s38, 32768
    s_addc_u32 s39, s39, 0
    s_add_u32 s40, s40, 32768
    s_addc_u32 s41, s41, 0
    s_add_u32 s50, s50, 32768
    s_addc_u32 s51, s51, 0
    s_add_u32 s24, s24, 458752
    s_addc_u32 s25, s25, 0

    s_branch U_loop
R_UP:
    v_add_u32 v5, 0, v2
    global_load_dwordx4 a[0:3], v5, s[30:31] offset:0
    global_load_dwordx4 a[4:7], v5, s[30:31] offset:1024
    global_load_dwordx4 a[8:11], v5, s[30:31] offset:2048
    global_load_dwordx4 a[12:15], v5, s[30:31] offset:3072
    v_add_u32 v5, 4096, v5
    global_load_dwordx4 a[16:19], v5, s[30:31] offset:0
    global_load_dwordx4 a[20:23], v5, s[30:31] offset:1024
    global_load_dwordx4 a[24:27], v5, s[30:31] offset:2048
    global_load_dwordx4 a[28:31], v5, s[30:31] offset:3072
    v_add_u32 v5, 4096, v5
    global_load_dwordx4 a[32:35], v5, s[30:31] offset:0
    global_load_dwordx4 a[36:39], v5, s[30:31] offset:1024
    global_load_dwordx4 a[40:43], v5, s[30:31] offset:2048
    global_load_dwordx4 a[44:47], v5, s[30:31] offset:3072
    v_add_u32 v5, 4096, v5
    global_load_dwordx4 a[48:51], v5, s[30:31] offset:0
    global_load_dwordx4 a[52:55], v5, s[30:31] offset:1024
    v_add_u32 v5, 229376, v2
    global_load_dwordx4 a[56:59], v5, s[30:31] offset:0
    global_load_dwordx4 a[60:63], v5, s[30:31] offset:1024
    global_load_dwordx4 a[64:67], v5, s[30:31] offset:2048
    global_load_dwordx4 a[68:71], v5, s[30:31] offset:3072
    v_add_u32 v5, 4096, v5
    global_load_dwordx4 a[72:75], v5, s[30:31] offset:0
    global_load_dwordx4 a[76:79], v5, s[30:31] offset:1024
    global_load_dwordx4 a[80:83], v5, s[30:31] offset:2048
    global_load_dwordx4 a[84:87], v5, s[30:31] offset:3072
    v_add_u32 v5, 4096, v5
    global_load_dwordx4 a[88:91], v5, s[30:31] offset:0
    global_load_dwordx4 a[92:95], v5, s[30:31] offset:1024
    global_load_dwordx4 a[96:99], v5, s[30:31] offset:2048
    global_load_dwordx4 a[100:103], v5, s[30:31] offset:3072
    v_add_u32 v5, 4096, v5
    global_load_dwordx4 a[104:107], v5, s[30:31] offset:0
    global_load_dwordx4 a[108:111], v5, s[30:31] offset:1024
    v_add_u32 v5, 14336, v2
    global_load_dwordx4 a[112:115], v5, s[30:31] offset:0
    global_load_dwordx4 a[116:119], v5, s[30:31] offset:1024
    global_load_dwordx4 a[120:123], v5, s[30:31] offset:2048
    global_load_dwordx4 a[124:127], v5, s[30:31] offset:3072
    v_add_u32 v5, 4096, v5
    global_load_dwordx4 a[128:131], v5, s[30:31] offset:0
    global_load_dwordx4 a[132:135], v5, s[30:31] offset:1024
    global_load_dwordx4 a[136:139], v5, s[30:31] offset:2048
    global_load_dwordx4 a[140:143], v5, s[30:31] offset:3072
    v_add_u32 v5, 4096, v5
    global_load_dwordx4 a[144:147], v5, s[30:31] offset:0
    global_load_dwordx4 a[148:151], v5, s[30:31] offset:1024
    global_load_dwordx4 a[152:155], v5, s[30:31] offset:2048
    global_load_dwordx4 a[156:159], v5, s[30:31] offset:3072
    v_add_u32 v5, 4096, v5
    global_load_dwordx4 a[160:163], v5, s[30:31] offset:0
    global_load_dwordx4 a[164:167], v5, s[30:31] offset:1024
    v_add_u32 v5, 243712, v2
    global_load_dwordx4 a[168:171], v5, s[30:31] offset:0
    global_load_dwordx4 a[172:175], v5, s[30:31] offset:1024
    global_load_dwordx4 a[176:179], v5, s[30:31] offset:2048
    global_load_dwordx4 a[180:183], v5, s[30:31] offset:3072
    v_add_u32 v5, 4096, v5
    global_load_dwordx4 a[184:187], v5, s[30:31] offset:0
    global_load_dwordx4 a[188:191], v5, s[30:31] offset:1024
    global_load_dwordx4 a[192:195], v5, s[30:31] offset:2048
    global_load_dwordx4 a[196:199], v5, s[30:31] offset:3072
    v_add_u32 v5, 4096, v5
    global_load_dwordx4 a[200:203], v5, s[30:31] offset:0
    global_load_dwordx4 a[204:207], v5, s[30:31] offset:1024
    global_load_dwordx4 a[208:211], v5, s[30:31] offset:2048
    global_load_dwordx4 a[212:215], v5, s[30:31] offset:3072
    v_add_u32 v5, 4096, v5
    global_load_dwordx4 a[216:219], v5, s[30:31] offset:0
    global_load_dwordx4 a[220:223], v5, s[30:31] offset:1024
    v_add_u32 v5, 28672, v2
    global_load_dwordx4 a[224:227], v5, s[30:31] offset:0
    global_load_dwordx4 a[228:231], v5, s[30:31] offset:1024
    global_load_dwordx4 a[232:235], v5, s[30:31] offset:2048
    global_load_dwordx4 a[236:239], v5, s[30:31] offset:3072
    v_add_u32 v5, 4096, v5
    global_load_dwordx4 a[240:243], v5, s[30:31] offset:0
    global_load_dwordx4 a[244:247], v5, s[30:31] offset:1024
    global_load_dwordx4 a[248:251], v5, s[30:31] offset:2048
    global_load_dwordx4 a[252:255], v5, s[30:31] offset:3072
    v_add_u32 v5, 4096, v5
    global_load_dwordx4 v[64:67], v5, s[30:31] offset:0
    global_load_dwordx4 v[68:71], v5, s[30:31] offset:1024
    global_load_dwordx4 v[72:75], v5, s[30:31] offset:2048
    global_load_dwordx4 v[76:79], v5, s[30:31] offset:3072
    v_add_u32 v5, 4096, v5
    global_load_dwordx4 v[80:83], v5, s[30:31] offset:0
    global_load_dwordx4 v[84:87], v5, s[30:31] offset:1024
    v_add_u32 v5, 258048, v2
    global_load_dwordx4 v[88:91], v5, s[30:31] offset:0
    global_load_dwordx4 v[92:95], v5, s[30:31] offset:1024
    global_load_dwordx4 v[96:99], v5, s[30:31] offset:2048
    global_load_dwordx4 v[100:103], v5, s[30:31] offset:3072
    v_add_u32 v5, 4096, v5
    global_load_dwordx4 v[104:107], v5, s[30:31] offset:0
    global_load_dwordx4 v[108:111], v5, s[30:31] offset:1024
    global_load_dwordx4 v[112:115], v5, s[30:31] offset:2048
    global_load_dwordx4 v[116:119], v5, s[30:31] offset:3072
    v_add_u32 v5, 4096, v5
    global_load_dwordx4 v[120:123], v5, s[30:31] offset:0
    global_load_dwordx4 v[124:127], v5, s[30:31] offset:1024
    global_load_dwordx4 v[128:131], v5, s[30:31] offset:2048
    global_load_dwordx4 v[132:135], v5, s[30:31] offset:3072
    v_add_u32 v5, 4096, v5
    global_load_dwordx4 v[136:139], v5, s[30:31] offset:0
    global_load_dwordx4 v[140:143], v5, s[30:31] offset:1024
    v_add_u32 v5, 43008, v2
    global_load_dwordx4 v[144:147], v5, s[30:31] offset:0
    global_load_dwordx4 v[148:151], v5, s[30:31] offset:1024
    global_load_dwordx4 v[152:155], v5, s[30:31] offset:2048
    global_load_dwordx4 v[156:159], v5, s[30:31] offset:3072
    v_add_u32 v5, 4096, v5
    global_load_dwordx4 v[160:163], v5, s[30:31] offset:0
    global_load_dwordx4 v[164:167], v5, s[30:31] offset:1024
    global_load_dwordx4 v[168:171], v5, s[30:31] offset:2048
    global_load_dwordx4 v[172:175], v5, s[30:31] offset:3072
    v_add_u32 v5, 4096, v5
    global_load_dwordx4 v[176:179], v5, s[30:31] offset:0
    global_load_dwordx4 v[180:183], v5, s[30:31] offset:1024
    global_load_dwordx4 v[184:187], v5, s[30:31] offset:2048
    global_load_dwordx4 v[188:191], v5, s[30:31] offset:3072
    v_add_u32 v5, 4096, v5
    global_load_dwordx4 v[192:195], v5, s[30:31] offset:0
    global_load_dwordx4 v[196:199], v5, s[30:31] offset:1024
    v_add_u32 v5, 272384, v2
    global_load_dwordx4 v[200:203], v5, s[30:31] offset:0
    global_load_dwordx4 v[204:207], v5, s[30:31] offset:1024
    global_load_dwordx4 v[208:211], v5, s[30:31] offset:2048
    global_load_dwordx4 v[212:215], v5, s[30:31] offset:3072
    v_add_u32 v5, 4096, v5
    global_load_dwordx4 v[216:219], v5, s[30:31] offset:0
    global_load_dwordx4 v[220:223], v5, s[30:31] offset:1024
    global_load_dwordx4 v[224:227], v5, s[30:31] offset:2048
    global_load_dwordx4 v[228:231], v5, s[30:31] offset:3072
    v_add_u32 v5, 4096, v5
    global_load_dwordx4 v[232:235], v5, s[30:31] offset:0
    global_load_dwordx4 v[236:239], v5, s[30:31] offset:1024
    global_load_dwordx4 v[240:243], v5, s[30:31] offset:2048
    global_load_dwordx4 v[244:247], v5, s[30:31] offset:3072
    v_add_u32 v5, 4096, v5
    global_load_dwordx4 v[248:251], v5, s[30:31] offset:0
    global_load_dwordx4 v[252:255], v5, s[30:31] offset:1024

    v_min_u32 v10, 29, v1
    v_lshlrev_b32 v10, 2, v10
    s_lshl_b32 s28, s2, 8
    s_add_u32 s28, s28, 0x37C0000
    v_mov_b32 v13, s28
UP_xp:
    global_load_dword v11, v10, s[6:7] offset:64 sc1
    global_load_dword v12, v13, s[4:5] sc1
    s_waitcnt vmcnt(0)
    v_min_u32 v12, v11, v12
    v_cmp_eq_u32 vcc, 0, v12
    s_cbranch_vccz UP_xok
    s_sub_u32 s15, s15, 1
    s_cbranch_scc1 M_end
    s_branch UP_xp
UP_xok:
    v_cmp_ne_u32 vcc, s21, v11
    s_cmp_eq_u64 vcc, 0
    s_cselect_b32 s20, 1, 0

    v_and_b32 v12, 8, v1
    v_cmp_eq_u32 vcc, 0, v12
    v_mov_b32 v6, 0xeeee
    v_mov_b32 v12, 0x4444
    v_cndmask_b32 v6, v6, v12, vcc

    v_lshlrev_b32 v5, 4, v1
    s_sub_u32 s28, s3, 2
    s_lshl_b32 s29, s28, 8
    s_add_u32 s29, s29, 7168
    v_lshl_add_u32 v1, v1, 2, s29
    s_lshl_b32 s29, s26, 9
    s_add_u32 s29, s29, 1024
    s_add_u32 s40, s16, s29
    s_addc_u32 s41, s17, 0
    s_lshl_b32 s29, s26, 11
    s_lshl_b32 s28, s28, 10
    s_add_u32 s28, s28, s29
    v_add_u32 v2, s28, v5
    s_add_u32 s48, s4, 0x3407000
    s_addc_u32 s49, s5, 0
    global_load_dwordx4 v[8:11], v2, s[48:49]
    s_add_u32 s48, s48, 28672
    s_addc_u32 s49, s49, 0
    s_lshl_b32 s28, s26, 1
    s_add_u32 s28, s28, s3
    s_sub_u32 s28, s28, 2
    s_lshl_b32 s28, s28, 14
    s_add_u32 s28, s28, 0x1800000
    s_add_u32 s24, s4, s28
    s_addc_u32 s25, s5, 0

    s_branch UP_go
UP_loop:
    s_sleep 14
UP_go:

    global_load_dwordx4 v[8:11], v3, s[16:17] sc1
    global_load_dwordx4 v[12:15], v4, s[16:17] sc1
    v_mov_b32 v32, 0
    v_mov_b32 v33, 0
    v_mov_b32 v34, 0
    v_mov_b32 v35, 0
    v_mov_b32 v36, 0
    v_mov_b32 v37, 0
    v_mov_b32 v38, 0
    v_mov_b32 v39, 0
    v_mov_b32 v40, 0
    v_mov_b32 v41, 0
    v_mov_b32 v42, 0
    v_mov_b32 v43, 0
    v_mov_b32 v44, 0
    v_mov_b32 v45, 0
    v_mov_b32 v46, 0
    v_mov_b32 v47, 0
    v_mov_b32 v48, 0
    v_mov_b32 v49, 0
    v_mov_b32 v50, 0
    v_mov_b32 v51, 0
    v_mov_b32 v52, 0
    v_mov_b32 v53, 0
    v_mov_b32 v54, 0
    v_mov_b32 v55, 0
    v_mov_b32 v56, 0
    v_mov_b32 v57, 0
    v_mov_b32 v58, 0
    v_mov_b32 v59, 0
    v_mov_b32 v60, 0
    v_mov_b32 v61, 0
    v_mov_b32 v62, 0
    v_mov_b32 v63, 0
UP_poll:
    s_waitcnt vmcnt(0)
    v_max3_u32 v0, v8, v9, v10
    v_max3_u32 v0, v0, v11, v12
    v_max3_u32 v0, v0, v13, v14
    v_max_u32 v0, v0, v15
    v_cmp_eq_u32 vcc, -1, v0
    s_cbranch_vccnz UP_pr

    ds_write_b128 v3, v[8:11]
    ds_write_b128 v4, v[12:15]
    s_waitcnt lgkmcnt(0)
    s_barrier

    ds_read_b128 v[16:19], v5 offset:0
    ds_read_b128 v[20:23], v5 offset:1024
    ds_read_b128 v[24:27], v5 offset:2048
    ds_read_b128 v[28:31], v5 offset:3072
    ds_read_b32 v0, v1
    global_load_dwordx4 v[8:11], v2, s[48:49]
    s_waitcnt lgkmcnt(4)
    v_smfmac_f32_16x16x64_bf16 v[32:35], v[16:19], a[0:7], v6
    v_smfmac_f32_16x16x64_bf16 v[40:43], v[16:19], a[112:119], v6
    v_smfmac_f32_16x16x64_bf16 v[36:39], v[16:19], a[56:63], v6
    v_smfmac_f32_16x16x64_bf16 v[44:47], v[16:19], a[168:175], v6
    ds_read_b128 v[16:19], v5 offset:4096
    s_waitcnt lgkmcnt(4)
    v_smfmac_f32_16x16x64_bf16 v[32:35], v[20:23], a[8:15], v6
    v_smfmac_f32_16x16x64_bf16 v[40:43], v[20:23], a[120:127], v6
    v_smfmac_f32_16x16x64_bf16 v[36:39], v[20:23], a[64:71], v6
    v_smfmac_f32_16x16x64_bf16 v[44:47], v[20:23], a[176:183], v6
    ds_read_b128 v[20:23], v5 offset:5120
    s_waitcnt lgkmcnt(4)
    v_smfmac_f32_16x16x64_bf16 v[32:35], v[24:27], a[16:23], v6
    v_smfmac_f32_16x16x64_bf16 v[40:43], v[24:27], a[128:135], v6
    v_smfmac_f32_16x16x64_bf16 v[36:39], v[24:27], a[72:79], v6
    v_smfmac_f32_16x16x64_bf16 v[44:47], v[24:27], a[184:191], v6
    ds_read_b128 v[24:27], v5 offset:6144
    s_waitcnt lgkmcnt(4)
    v_smfmac_f32_16x16x64_bf16 v[32:35], v[28:31], a[24:31], v6
    v_smfmac_f32_16x16x64_bf16 v[40:43], v[28:31], a[136:143], v6
    v_smfmac_f32_16x16x64_bf16 v[36:39], v[28:31], a[80:87], v6
    v_smfmac_f32_16x16x64_bf16 v[44:47], v[28:31], a[192:199], v6
    ds_read_b128 v[28:31], v5 offset:0
    s_waitcnt lgkmcnt(3)
    v_smfmac_f32_16x16x64_bf16 v[32:35], v[16:19], a[32:39], v6
    v_smfmac_f32_16x16x64_bf16 v[40:43], v[16:19], a[144:151], v6
    v_smfmac_f32_16x16x64_bf16 v[36:39], v[16:19], a[88:95], v6
    v_smfmac_f32_16x16x64_bf16 v[44:47], v[16:19], a[200:207], v6
    ds_read_b128 v[16:19], v5 offset:1024
    s_cmp_eq_u32 s14, 0
    s_cbranch_scc1 UP_nomg
    global_store_dword v1, v0, s[40:41] sc1
UP_nomg:
    s_waitcnt lgkmcnt(3)
    v_smfmac_f32_16x16x64_bf16 v[32:35], v[20:23], a[40:47], v6
    v_smfmac_f32_16x16x64_bf16 v[40:43], v[20:23], a[152:159], v6
    v_smfmac_f32_16x16x64_bf16 v[36:39], v[20:23], a[96:103], v6
    v_smfmac_f32_16x16x64_bf16 v[44:47], v[20:23], a[208:215], v6
    ds_read_b128 v[20:23], v5 offset:2048
    s_waitcnt lgkmcnt(3)
    v_smfmac_f32_16x16x64_bf16 v[32:35], v[24:27], a[48:55], v6
    v_smfmac_f32_16x16x64_bf16 v[40:43], v[24:27], a[160:167], v6
    v_smfmac_f32_16x16x64_bf16 v[36:39], v[24:27], a[104:111], v6
    v_smfmac_f32_16x16x64_bf16 v[44:47], v[24:27], a[216:223], v6
    ds_read_b128 v[24:27], v5 offset:3072
    s_waitcnt lgkmcnt(3)
    v_smfmac_f32_16x16x64_bf16 v[48:51], v[28:31], a[224:231], v6
    v_smfmac_f32_16x16x64_bf16 v[56:59], v[28:31], v[144:151], v6
    v_smfmac_f32_16x16x64_bf16 v[52:55], v[28:31], v[88:95], v6
    v_smfmac_f32_16x16x64_bf16 v[60:63], v[28:31], v[200:207], v6
    ds_read_b128 v[28:31], v5 offset:4096
    s_waitcnt lgkmcnt(3)
    v_smfmac_f32_16x16x64_bf16 v[48:51], v[16:19], a[232:239], v6
    v_cvt_pk_bf16_f32 v32, v32, v33
    v_smfmac_f32_16x16x64_bf16 v[56:59], v[16:19], v[152:159], v6
    v_cvt_pk_bf16_f32 v33, v34, v35
    v_smfmac_f32_16x16x64_bf16 v[52:55], v[16:19], v[96:103], v6
    v_cvt_pk_bf16_f32 v34, v40, v41
    v_smfmac_f32_16x16x64_bf16 v[60:63], v[16:19], v[208:215], v6
    v_cvt_pk_bf16_f32 v35, v42, v43
    ds_write_b128 v7, v[32:35] offset:0
    ds_read_b128 v[16:19], v5 offset:5120
    s_waitcnt lgkmcnt(4)
    v_smfmac_f32_16x16x64_bf16 v[48:51], v[20:23], a[240:247], v6
    v_cvt_pk_bf16_f32 v36, v36, v37
    v_smfmac_f32_16x16x64_bf16 v[56:59], v[20:23], v[160:167], v6
    v_cvt_pk_bf16_f32 v37, v38, v39
    v_smfmac_f32_16x16x64_bf16 v[52:55], v[20:23], v[104:111], v6
    v_cvt_pk_bf16_f32 v38, v44, v45
    v_smfmac_f32_16x16x64_bf16 v[60:63], v[20:23], v[216:223], v6
    v_cvt_pk_bf16_f32 v39, v46, v47
    ds_write_b128 v7, v[36:39] offset:8192
    ds_read_b128 v[20:23], v5 offset:6144
    s_waitcnt lgkmcnt(5)
    v_smfmac_f32_16x16x64_bf16 v[48:51], v[24:27], a[248:255], v6
    v_smfmac_f32_16x16x64_bf16 v[56:59], v[24:27], v[168:175], v6
    v_smfmac_f32_16x16x64_bf16 v[52:55], v[24:27], v[112:119], v6
    v_smfmac_f32_16x16x64_bf16 v[60:63], v[24:27], v[224:231], v6
    s_waitcnt lgkmcnt(4)
    v_smfmac_f32_16x16x64_bf16 v[48:51], v[28:31], v[64:71], v6
    v_smfmac_f32_16x16x64_bf16 v[56:59], v[28:31], v[176:183], v6
    v_smfmac_f32_16x16x64_bf16 v[52:55], v[28:31], v[120:127], v6
    v_smfmac_f32_16x16x64_bf16 v[60:63], v[28:31], v[232:239], v6
    s_waitcnt lgkmcnt(2)
    v_smfmac_f32_16x16x64_bf16 v[48:51], v[16:19], v[72:79], v6
    v_smfmac_f32_16x16x64_bf16 v[56:59], v[16:19], v[184:191], v6
    v_smfmac_f32_16x16x64_bf16 v[52:55], v[16:19], v[128:135], v6
    v_smfmac_f32_16x16x64_bf16 v[60:63], v[16:19], v[240:247], v6
    s_waitcnt lgkmcnt(0)
    v_smfmac_f32_16x16x64_bf16 v[48:51], v[20:23], v[80:87], v6
    v_smfmac_f32_16x16x64_bf16 v[56:59], v[20:23], v[192:199], v6
    v_smfmac_f32_16x16x64_bf16 v[52:55], v[20:23], v[136:143], v6
    v_smfmac_f32_16x16x64_bf16 v[60:63], v[20:23], v[248:255], v6

    s_nop 1
    v_cvt_pk_bf16_f32 v48, v48, v49
    v_cvt_pk_bf16_f32 v49, v50, v51
    v_cvt_pk_bf16_f32 v50, v56, v57
    v_cvt_pk_bf16_f32 v51, v58, v59
    ds_write_b128 v7, v[48:51] offset:1024
    v_cvt_pk_bf16_f32 v52, v52, v53
    v_cvt_pk_bf16_f32 v53, v54, v55
    v_cvt_pk_bf16_f32 v54, v60, v61
    v_cvt_pk_bf16_f32 v55, v62, v63
    ds_write_b128 v7, v[52:55] offset:9216
    s_waitcnt lgkmcnt(0)
    s_barrier

    s_add_u32 s14, s14, 1
    s_cmp_ge_u32 s14, 63
    s_cbranch_scc1 M_end
    s_add_u32 s16, s16, 32768
    s_addc_u32 s17, s17, 0
    s_add_u32 s40, s40, 32768
    s_addc_u32 s41, s41, 0
    s_add_u32 s24, s24, 458752
    s_addc_u32 s25, s25, 0
    s_cmp_ge_u32 s14, 62
    s_cbranch_scc1 UP_loop
    s_add_u32 s48, s48, 28672
    s_addc_u32 s49, s49, 0
    s_branch UP_loop

R_PF:

    s_sub_u32 s26, s27, 30
    s_lshl_b32 s26, s26, 2
    s_add_u32 s26, s26, s3
    s_lshl_b32 s28, s2, 8
    s_add_u32 s28, s28, 0x37C0000
    v_mov_b32 v13, s28
PF_gb:
    global_load_dword v12, v13, s[4:5] sc1
    s_waitcnt vmcnt(0)
    v_cmp_eq_u32 vcc, 0, v12
    s_cbranch_vccz PF_go
    s_sleep 8
    s_sub_u32 s15, s15, 1
    s_cbranch_scc1 M_end
    s_branch PF_gb
PF_go:
    s_mul_i32 s28, s26, 57344
    v_mul_u32_u24 v2, 128, v1
    v_add_u32 v2, s28, v2
    s_mul_i32 s28, s26, 3584
    v_min_u32 v3, 27, v1
    v_mul_u32_u24 v3, 128, v3
    v_add_u32 v3, s28, v3
    v_min_u32 v4, 55, v1
    v_lshlrev_b32 v4, 4, v4
    v_add_u32 v4, 0x1100000, v4
    v_mov_b32 v5, 0
    v_and_b32 v6, 1, v1
    s_mov_b32 s14, 1
    s_add_u32 s24, s4, 0x1870000
    s_addc_u32 s25, s5, 0
    s_add_u32 s48, s4, 0x3407000
    s_addc_u32 s49, s5, 0
PF_loop:
    s_sub_u32 s28, s14, 3
    s_cselect_b32 s28, 0, s28
    s_sub_u32 s29, s14, s28
    s_lshl_b32 s28, s28, 15
    s_lshl_b32 s29, s29, 15
    s_add_u32 s28, s28, 0xe82000
    v_mul_u32_u24 v7, s29, v6
    v_add_u32 v7, s28, v7
PF_pc:
    global_load_dword v8, v7, s[4:5] sc1
    s_waitcnt vmcnt(0)
    v_readlane_b32 s28, v8, 0
    v_readlane_b32 s29, v8, 1
    s_cmp_lg_u32 s28, -1
    s_cbranch_scc1 PF_pok
    s_sleep 6
    s_sub_u32 s15, s15, 1
    s_cbranch_scc1 M_end
    s_branch PF_pc
PF_pok:
    s_cmp_lg_u32 s29, -1
    s_cbranch_scc1 PF_next
PF_fc:
    v_cmp_ge_u32 vcc, s14, v5
    s_cbranch_vccz PF_fok
    global_load_dwordx4 v[8:11], v4, s[4:5] sc1
    s_waitcnt vmcnt(0)
    v_lshlrev_b32 v8, 1, v8
    v_lshl_add_u32 v9, v9, 1, 1
    v_lshlrev_b32 v10, 1, v10
    v_lshl_add_u32 v11, v11, 1, 1
    v_min3_u32 v5, v8, v9, v10
    v_min_u32 v5, v5, v11
    v_cmp_ge_u32 vcc, s14, v5
    s_cbranch_vccz PF_fok
    s_sleep 4
    s_sub_u32 s15, s15, 1
    s_cbranch_scc1 M_end
    s_branch PF_pc
PF_fok:

    global_load_dword v14, v3, s[48:49]
    v_mov_b32 v9, v2
    global_load_dword v16, v9, s[24:25]
    v_add_u32 v9, 8192, v9
    global_load_dword v17, v9, s[24:25]
    v_add_u32 v9, 8192, v9
    global_load_dword v18, v9, s[24:25]
    v_add_u32 v9, 8192, v9
    global_load_dword v19, v9, s[24:25]
    v_add_u32 v9, 8192, v9
    global_load_dword v20, v9, s[24:25]
    v_add_u32 v9, 8192, v9
    global_load_dword v21, v9, s[24:25]
    v_add_u32 v9, 8192, v9
    global_load_dword v22, v9, s[24:25]

PF_next:
    s_add_u32 s14, s14, 1
    s_add_u32 s24, s24, 458752
    s_addc_u32 s25, s25, 0
    s_add_u32 s48, s48, 28672
    s_addc_u32 s49, s49, 0
    s_cmp_lt_u32 s14, 63
    s_cbranch_scc1 PF_loop
    s_waitcnt vmcnt(0)
    s_branch M_end

R_UX:
    s_and_b32 s23, s26, 1
    s_lshr_b32 s26, s26, 1

    s_lshl_b32 s28, s26, 4
    s_lshl_b32 s29, s3, 2
    s_add_u32 s28, s28, s29
    s_mul_i32 s28, s28, 14336
    s_add_u32 s28, s28, 0x640000
    s_add_u32 s30, s4, s28
    s_addc_u32 s31, s5, 0
    v_lshlrev_b32 v2, 4, v1

    global_load_dwordx4 a[0:3], v2, s[30:31] offset:0
    global_load_dwordx4 a[4:7], v2, s[30:31] offset:1024
    global_load_dwordx4 a[8:11], v2, s[30:31] offset:2048
    global_load_dwordx4 a[12:15], v2, s[30:31] offset:3072
    v_add_u32 v2, 4096, v2
    global_load_dwordx4 a[16:19], v2, s[30:31] offset:0
    global_load_dwordx4 a[20:23], v2, s[30:31] offset:1024
    global_load_dwordx4 a[24:27], v2, s[30:31] offset:2048
    global_load_dwordx4 a[28:31], v2, s[30:31] offset:3072
    v_add_u32 v2, 4096, v2
    global_load_dwordx4 a[32:35], v2, s[30:31] offset:0
    global_load_dwordx4 a[36:39], v2, s[30:31] offset:1024
    global_load_dwordx4 a[40:43], v2, s[30:31] offset:2048
    global_load_dwordx4 a[44:47], v2, s[30:31] offset:3072
    v_add_u32 v2, 4096, v2
    global_load_dwordx4 a[48:51], v2, s[30:31] offset:0
    global_load_dwordx4 a[52:55], v2, s[30:31] offset:1024
    global_load_dwordx4 a[56:59], v2, s[30:31] offset:2048
    global_load_dwordx4 a[60:63], v2, s[30:31] offset:3072
    v_add_u32 v2, 4096, v2
    global_load_dwordx4 a[64:67], v2, s[30:31] offset:0
    global_load_dwordx4 a[68:71], v2, s[30:31] offset:1024
    global_load_dwordx4 a[72:75], v2, s[30:31] offset:2048
    global_load_dwordx4 a[76:79], v2, s[30:31] offset:3072
    v_add_u32 v2, 4096, v2
    global_load_dwordx4 a[80:83], v2, s[30:31] offset:0
    global_load_dwordx4 a[84:87], v2, s[30:31] offset:1024
    global_load_dwordx4 a[88:91], v2, s[30:31] offset:2048
    global_load_dwordx4 a[92:95], v2, s[30:31] offset:3072
    v_add_u32 v2, 4096, v2
    global_load_dwordx4 a[96:99], v2, s[30:31] offset:0
    global_load_dwordx4 a[100:103], v2, s[30:31] offset:1024
    global_load_dwordx4 a[104:107], v2, s[30:31] offset:2048
    global_load_dwordx4 a[108:111], v2, s[30:31] offset:3072
    v_add_u32 v2, 4096, v2
    global_load_dwordx4 a[112:115], v2, s[30:31] offset:0
    global_load_dwordx4 a[116:119], v2, s[30:31] offset:1024
    global_load_dwordx4 a[120:123], v2, s[30:31] offset:2048
    global_load_dwordx4 a[124:127], v2, s[30:31] offset:3072
    v_add_u32 v2, 4096, v2
    global_load_dwordx4 a[128:131], v2, s[30:31] offset:0
    global_load_dwordx4 a[132:135], v2, s[30:31] offset:1024
    global_load_dwordx4 a[136:139], v2, s[30:31] offset:2048
    global_load_dwordx4 a[140:143], v2, s[30:31] offset:3072
    v_add_u32 v2, 4096, v2
    global_load_dwordx4 a[144:147], v2, s[30:31] offset:0
    global_load_dwordx4 a[148:151], v2, s[30:31] offset:1024
    global_load_dwordx4 a[152:155], v2, s[30:31] offset:2048
    global_load_dwordx4 a[156:159], v2, s[30:31] offset:3072
    v_add_u32 v2, 4096, v2
    global_load_dwordx4 a[160:163], v2, s[30:31] offset:0
    global_load_dwordx4 a[164:167], v2, s[30:31] offset:1024
    global_load_dwordx4 a[168:171], v2, s[30:31] offset:2048
    global_load_dwordx4 a[172:175], v2, s[30:31] offset:3072
    v_add_u32 v2, 4096, v2
    global_load_dwordx4 a[176:179], v2, s[30:31] offset:0
    global_load_dwordx4 a[180:183], v2, s[30:31] offset:1024
    global_load_dwordx4 a[184:187], v2, s[30:31] offset:2048
    global_load_dwordx4 a[188:191], v2, s[30:31] offset:3072
    v_add_u32 v2, 4096, v2
    global_load_dwordx4 a[192:195], v2, s[30:31] offset:0
    global_load_dwordx4 a[196:199], v2, s[30:31] offset:1024
    global_load_dwordx4 a[200:203], v2, s[30:31] offset:2048
    global_load_dwordx4 a[204:207], v2, s[30:31] offset:3072
    v_add_u32 v2, 4096, v2
    global_load_dwordx4 a[208:211], v2, s[30:31] offset:0
    global_load_dwordx4 a[212:215], v2, s[30:31] offset:1024
    global_load_dwordx4 a[216:219], v2, s[30:31] offset:2048
    global_load_dwordx4 a[220:223], v2, s[30:31] offset:3072
    v_add_u32 v2, 4096, v2

    v_lshlrev_b32 v8, 4, v1
    v_add_u32 v8, 4096, v8
    v_add_u32 v9, 8192, v8
    v_add_u32 v10, 16384, v8
    v_add_u32 v11, 24576, v8
    s_mul_i32 s28, s23, 28672
    s_add_u32 s28, s28, 0x3600000
    s_add_u32 s24, s4, s28
    s_addc_u32 s25, s5, 0

    global_load_dwordx4 v[16:19], v8, s[24:25] offset:-4096
    global_load_dwordx4 v[20:23], v9, s[24:25] offset:2048
    global_load_dwordx4 v[24:27], v8, s[24:25] offset:-3072
    global_load_dwordx4 v[28:31], v9, s[24:25] offset:3072
    global_load_dwordx4 v[32:35], v8, s[24:25] offset:-2048
    global_load_dwordx4 v[36:39], v10, s[24:25] offset:-4096
    global_load_dwordx4 v[40:43], v8, s[24:25] offset:-1024
    global_load_dwordx4 v[44:47], v10, s[24:25] offset:-3072
    global_load_dwordx4 v[48:51], v8, s[24:25] offset:0
    global_load_dwordx4 v[52:55], v10, s[24:25] offset:-2048
    global_load_dwordx4 v[56:59], v8, s[24:25] offset:1024
    global_load_dwordx4 v[60:63], v10, s[24:25] offset:-1024
    global_load_dwordx4 v[64:67], v8, s[24:25] offset:2048
    global_load_dwordx4 v[68:71], v10, s[24:25] offset:0
    global_load_dwordx4 v[72:75], v8, s[24:25] offset:3072
    global_load_dwordx4 v[76:79], v10, s[24:25] offset:1024
    global_load_dwordx4 v[80:83], v9, s[24:25] offset:-4096
    global_load_dwordx4 v[84:87], v10, s[24:25] offset:2048
    global_load_dwordx4 v[88:91], v9, s[24:25] offset:-3072
    global_load_dwordx4 v[92:95], v10, s[24:25] offset:3072
    global_load_dwordx4 v[96:99], v9, s[24:25] offset:-2048
    global_load_dwordx4 v[100:103], v11, s[24:25] offset:-4096
    global_load_dwordx4 v[104:107], v9, s[24:25] offset:-1024
    global_load_dwordx4 v[108:111], v11, s[24:25] offset:-3072
    global_load_dwordx4 v[112:115], v9, s[24:25] offset:0
    global_load_dwordx4 v[116:119], v11, s[24:25] offset:-2048
    global_load_dwordx4 v[120:123], v9, s[24:25] offset:1024
    global_load_dwordx4 v[124:127], v11, s[24:25] offset:-1024

    v_lshlrev_b32 v5, 4, v1
    s_lshl_b32 s28, s26, 14
    s_lshl_b32 s29, s3, 12
    s_add_u32 s28, s28, s29
    s_mul_i32 s29, s23, 458752
    s_add_u32 s28, s28, s29
    s_add_u32 s28, s28, 0x1800000
    s_add_u32 s18, s4, s28
    s_addc_u32 s19, s5, 0
    s_lshl_b32 s28, s26, 5
    s_lshl_b32 s29, s3, 3
    s_add_u32 s28, s28, s29
    s_lshl_b32 s29, s23, 2
    s_add_u32 s28, s28, s29
    s_add_u32 s28, s28, 0x1100000
    v_mov_b32 v6, s28
    s_mov_b32 s14, 0
    s_add_u32 s24, s24, 57344
    s_addc_u32 s25, s25, 0
    s_waitcnt vmcnt(0)

X1_loop:
    s_waitcnt vmcnt(31)
    v_mfma_f32_16x16x32_bf16 v[128:131], v[16:19], a[0:3], 0
    v_mfma_f32_16x16x32_bf16 v[136:139], v[16:19], a[56:59], 0
    v_mfma_f32_16x16x32_bf16 v[144:147], v[16:19], a[112:115], 0
    v_mfma_f32_16x16x32_bf16 v[152:155], v[16:19], a[168:171], 0
    v_mfma_f32_16x16x32_bf16 v[132:135], v[20:23], a[0:3], 0
    v_mfma_f32_16x16x32_bf16 v[140:143], v[20:23], a[56:59], 0
    v_mfma_f32_16x16x32_bf16 v[148:151], v[20:23], a[112:115], 0
    v_mfma_f32_16x16x32_bf16 v[156:159], v[20:23], a[168:171], 0
    global_load_dwordx4 v[16:19], v8, s[24:25] offset:-4096
    global_load_dwordx4 v[20:23], v9, s[24:25] offset:2048
    s_waitcnt vmcnt(31)
    v_mfma_f32_16x16x32_bf16 v[128:131], v[24:27], a[4:7], v[128:131]
    v_mfma_f32_16x16x32_bf16 v[136:139], v[24:27], a[60:63], v[136:139]
    v_mfma_f32_16x16x32_bf16 v[144:147], v[24:27], a[116:119], v[144:147]
    v_mfma_f32_16x16x32_bf16 v[152:155], v[24:27], a[172:175], v[152:155]
    v_mfma_f32_16x16x32_bf16 v[132:135], v[28:31], a[4:7], v[132:135]
    v_mfma_f32_16x16x32_bf16 v[140:143], v[28:31], a[60:63], v[140:143]
    v_mfma_f32_16x16x32_bf16 v[148:151], v[28:31], a[116:119], v[148:151]
    v_mfma_f32_16x16x32_bf16 v[156:159], v[28:31], a[172:175], v[156:159]
    global_load_dwordx4 v[24:27], v8, s[24:25] offset:-3072
    global_load_dwordx4 v[28:31], v9, s[24:25] offset:3072
    s_waitcnt vmcnt(31)
    v_mfma_f32_16x16x32_bf16 v[128:131], v[32:35], a[8:11], v[128:131]
    v_mfma_f32_16x16x32_bf16 v[136:139], v[32:35], a[64:67], v[136:139]
    v_mfma_f32_16x16x32_bf16 v[144:147], v[32:35], a[120:123], v[144:147]
    v_mfma_f32_16x16x32_bf16 v[152:155], v[32:35], a[176:179], v[152:155]
    v_mfma_f32_16x16x32_bf16 v[132:135], v[36:39], a[8:11], v[132:135]
    v_mfma_f32_16x16x32_bf16 v[140:143], v[36:39], a[64:67], v[140:143]
    v_mfma_f32_16x16x32_bf16 v[148:151], v[36:39], a[120:123], v[148:151]
    v_mfma_f32_16x16x32_bf16 v[156:159], v[36:39], a[176:179], v[156:159]
    global_load_dwordx4 v[32:35], v8, s[24:25] offset:-2048
    global_load_dwordx4 v[36:39], v10, s[24:25] offset:-4096
    s_waitcnt vmcnt(31)
    v_mfma_f32_16x16x32_bf16 v[128:131], v[40:43], a[12:15], v[128:131]
    v_mfma_f32_16x16x32_bf16 v[136:139], v[40:43], a[68:71], v[136:139]
    v_mfma_f32_16x16x32_bf16 v[144:147], v[40:43], a[124:127], v[144:147]
    v_mfma_f32_16x16x32_bf16 v[152:155], v[40:43], a[180:183], v[152:155]
    v_mfma_f32_16x16x32_bf16 v[132:135], v[44:47], a[12:15], v[132:135]
    v_mfma_f32_16x16x32_bf16 v[140:143], v[44:47], a[68:71], v[140:143]
    v_mfma_f32_16x16x32_bf16 v[148:151], v[44:47], a[124:127], v[148:151]
    v_mfma_f32_16x16x32_bf16 v[156:159], v[44:47], a[180:183], v[156:159]
    global_load_dwordx4 v[40:43], v8, s[24:25] offset:-1024
    global_load_dwordx4 v[44:47], v10, s[24:25] offset:-3072
    s_waitcnt vmcnt(31)
    v_mfma_f32_16x16x32_bf16 v[128:131], v[48:51], a[16:19], v[128:131]
    v_mfma_f32_16x16x32_bf16 v[136:139], v[48:51], a[72:75], v[136:139]
    v_mfma_f32_16x16x32_bf16 v[144:147], v[48:51], a[128:131], v[144:147]
    v_mfma_f32_16x16x32_bf16 v[152:155], v[48:51], a[184:187], v[152:155]
    v_mfma_f32_16x16x32_bf16 v[132:135], v[52:55], a[16:19], v[132:135]
    v_mfma_f32_16x16x32_bf16 v[140:143], v[52:55], a[72:75], v[140:143]
    v_mfma_f32_16x16x32_bf16 v[148:151], v[52:55], a[128:131], v[148:151]
    v_mfma_f32_16x16x32_bf16 v[156:159], v[52:55], a[184:187], v[156:159]
    global_load_dwordx4 v[48:51], v8, s[24:25] offset:0
    global_load_dwordx4 v[52:55], v10, s[24:25] offset:-2048
    s_waitcnt vmcnt(31)
    v_mfma_f32_16x16x32_bf16 v[128:131], v[56:59], a[20:23], v[128:131]
    v_mfma_f32_16x16x32_bf16 v[136:139], v[56:59], a[76:79], v[136:139]
    v_mfma_f32_16x16x32_bf16 v[144:147], v[56:59], a[132:135], v[144:147]
    v_mfma_f32_16x16x32_bf16 v[152:155], v[56:59], a[188:191], v[152:155]
    v_mfma_f32_16x16x32_bf16 v[132:135], v[60:63], a[20:23], v[132:135]
    v_mfma_f32_16x16x32_bf16 v[140:143], v[60:63], a[76:79], v[140:143]
    v_mfma_f32_16x16x32_bf16 v[148:151], v[60:63], a[132:135], v[148:151]
    v_mfma_f32_16x16x32_bf16 v[156:159], v[60:63], a[188:191], v[156:159]
    global_load_dwordx4 v[56:59], v8, s[24:25] offset:1024
    global_load_dwordx4 v[60:63], v10, s[24:25] offset:-1024
    s_waitcnt vmcnt(31)
    v_mfma_f32_16x16x32_bf16 v[128:131], v[64:67], a[24:27], v[128:131]
    v_mfma_f32_16x16x32_bf16 v[136:139], v[64:67], a[80:83], v[136:139]
    v_mfma_f32_16x16x32_bf16 v[144:147], v[64:67], a[136:139], v[144:147]
    v_mfma_f32_16x16x32_bf16 v[152:155], v[64:67], a[192:195], v[152:155]
    v_mfma_f32_16x16x32_bf16 v[132:135], v[68:71], a[24:27], v[132:135]
    v_mfma_f32_16x16x32_bf16 v[140:143], v[68:71], a[80:83], v[140:143]
    v_mfma_f32_16x16x32_bf16 v[148:151], v[68:71], a[136:139], v[148:151]
    v_mfma_f32_16x16x32_bf16 v[156:159], v[68:71], a[192:195], v[156:159]
    global_load_dwordx4 v[64:67], v8, s[24:25] offset:2048
    global_load_dwordx4 v[68:71], v10, s[24:25] offset:0
    s_waitcnt vmcnt(31)
    v_mfma_f32_16x16x32_bf16 v[128:131], v[72:75], a[28:31], v[128:131]
    v_mfma_f32_16x16x32_bf16 v[136:139], v[72:75], a[84:87], v[136:139]
    v_mfma_f32_16x16x32_bf16 v[144:147], v[72:75], a[140:143], v[144:147]
    v_mfma_f32_16x16x32_bf16 v[152:155], v[72:75], a[196:199], v[152:155]
    v_mfma_f32_16x16x32_bf16 v[132:135], v[76:79], a[28:31], v[132:135]
    v_mfma_f32_16x16x32_bf16 v[140:143], v[76:79], a[84:87], v[140:143]
    v_mfma_f32_16x16x32_bf16 v[148:151], v[76:79], a[140:143], v[148:151]
    v_mfma_f32_16x16x32_bf16 v[156:159], v[76:79], a[196:199], v[156:159]
    global_load_dwordx4 v[72:75], v8, s[24:25] offset:3072
    global_load_dwordx4 v[76:79], v10, s[24:25] offset:1024
    s_waitcnt vmcnt(31)
    v_mfma_f32_16x16x32_bf16 v[128:131], v[80:83], a[32:35], v[128:131]
    v_mfma_f32_16x16x32_bf16 v[136:139], v[80:83], a[88:91], v[136:139]
    v_mfma_f32_16x16x32_bf16 v[144:147], v[80:83], a[144:147], v[144:147]
    v_mfma_f32_16x16x32_bf16 v[152:155], v[80:83], a[200:203], v[152:155]
    v_mfma_f32_16x16x32_bf16 v[132:135], v[84:87], a[32:35], v[132:135]
    v_mfma_f32_16x16x32_bf16 v[140:143], v[84:87], a[88:91], v[140:143]
    v_mfma_f32_16x16x32_bf16 v[148:151], v[84:87], a[144:147], v[148:151]
    v_mfma_f32_16x16x32_bf16 v[156:159], v[84:87], a[200:203], v[156:159]
    global_load_dwordx4 v[80:83], v9, s[24:25] offset:-4096
    global_load_dwordx4 v[84:87], v10, s[24:25] offset:2048
    s_waitcnt vmcnt(31)
    v_mfma_f32_16x16x32_bf16 v[128:131], v[88:91], a[36:39], v[128:131]
    v_mfma_f32_16x16x32_bf16 v[136:139], v[88:91], a[92:95], v[136:139]
    v_mfma_f32_16x16x32_bf16 v[144:147], v[88:91], a[148:151], v[144:147]
    v_mfma_f32_16x16x32_bf16 v[152:155], v[88:91], a[204:207], v[152:155]
    v_mfma_f32_16x16x32_bf16 v[132:135], v[92:95], a[36:39], v[132:135]
    v_mfma_f32_16x16x32_bf16 v[140:143], v[92:95], a[92:95], v[140:143]
    v_mfma_f32_16x16x32_bf16 v[148:151], v[92:95], a[148:151], v[148:151]
    v_mfma_f32_16x16x32_bf16 v[156:159], v[92:95], a[204:207], v[156:159]
    global_load_dwordx4 v[88:91], v9, s[24:25] offset:-3072
    global_load_dwordx4 v[92:95], v10, s[24:25] offset:3072
    s_waitcnt vmcnt(31)
    v_mfma_f32_16x16x32_bf16 v[128:131], v[96:99], a[40:43], v[128:131]
    v_mfma_f32_16x16x32_bf16 v[136:139], v[96:99], a[96:99], v[136:139]
    v_mfma_f32_16x16x32_bf16 v[144:147], v[96:99], a[152:155], v[144:147]
    v_mfma_f32_16x16x32_bf16 v[152:155], v[96:99], a[208:211], v[152:155]
    v_mfma_f32_16x16x32_bf16 v[132:135], v[100:103], a[40:43], v[132:135]
    v_mfma_f32_16x16x32_bf16 v[140:143], v[100:103], a[96:99], v[140:143]
    v_mfma_f32_16x16x32_bf16 v[148:151], v[100:103], a[152:155], v[148:151]
    v_mfma_f32_16x16x32_bf16 v[156:159], v[100:103], a[208:211], v[156:159]
    global_load_dwordx4 v[96:99], v9, s[24:25] offset:-2048
    global_load_dwordx4 v[100:103], v11, s[24:25] offset:-4096
    s_waitcnt vmcnt(31)
    v_mfma_f32_16x16x32_bf16 v[128:131], v[104:107], a[44:47], v[128:131]
    v_mfma_f32_16x16x32_bf16 v[136:139], v[104:107], a[100:103], v[136:139]
    v_mfma_f32_16x16x32_bf16 v[144:147], v[104:107], a[156:159], v[144:147]
    v_mfma_f32_16x16x32_bf16 v[152:155], v[104:107], a[212:215], v[152:155]
    v_mfma_f32_16x16x32_bf16 v[132:135], v[108:111], a[44:47], v[132:135]
    v_mfma_f32_16x16x32_bf16 v[140:143], v[108:111], a[100:103], v[140:143]
    v_mfma_f32_16x16x32_bf16 v[148:151], v[108:111], a[156:159], v[148:151]
    v_mfma_f32_16x16x32_bf16 v[156:159], v[108:111], a[212:215], v[156:159]
    global_load_dwordx4 v[104:107], v9, s[24:25] offset:-1024
    global_load_dwordx4 v[108:111], v11, s[24:25] offset:-3072
    s_waitcnt vmcnt(31)
    v_mfma_f32_16x16x32_bf16 v[128:131], v[112:115], a[48:51], v[128:131]
    v_mfma_f32_16x16x32_bf16 v[136:139], v[112:115], a[104:107], v[136:139]
    v_mfma_f32_16x16x32_bf16 v[144:147], v[112:115], a[160:163], v[144:147]
    v_mfma_f32_16x16x32_bf16 v[152:155], v[112:115], a[216:219], v[152:155]
    v_mfma_f32_16x16x32_bf16 v[132:135], v[116:119], a[48:51], v[132:135]
    v_mfma_f32_16x16x32_bf16 v[140:143], v[116:119], a[104:107], v[140:143]
    v_mfma_f32_16x16x32_bf16 v[148:151], v[116:119], a[160:163], v[148:151]
    v_mfma_f32_16x16x32_bf16 v[156:159], v[116:119], a[216:219], v[156:159]
    global_load_dwordx4 v[112:115], v9, s[24:25] offset:0
    global_load_dwordx4 v[116:119], v11, s[24:25] offset:-2048
    s_waitcnt vmcnt(31)
    v_mfma_f32_16x16x32_bf16 v[128:131], v[120:123], a[52:55], v[128:131]
    v_mfma_f32_16x16x32_bf16 v[136:139], v[120:123], a[108:111], v[136:139]
    v_mfma_f32_16x16x32_bf16 v[144:147], v[120:123], a[164:167], v[144:147]
    v_mfma_f32_16x16x32_bf16 v[152:155], v[120:123], a[220:223], v[152:155]
    v_mfma_f32_16x16x32_bf16 v[132:135], v[124:127], a[52:55], v[132:135]
    v_mfma_f32_16x16x32_bf16 v[140:143], v[124:127], a[108:111], v[140:143]
    v_mfma_f32_16x16x32_bf16 v[148:151], v[124:127], a[164:167], v[148:151]
    v_mfma_f32_16x16x32_bf16 v[156:159], v[124:127], a[220:223], v[156:159]
    global_load_dwordx4 v[120:123], v9, s[24:25] offset:1024
    global_load_dwordx4 v[124:127], v11, s[24:25] offset:-1024
    s_nop 4
    v_cvt_pk_bf16_f32 v160, v128, v129
    v_cvt_pk_bf16_f32 v161, v130, v131
    v_cvt_pk_bf16_f32 v162, v132, v133
    v_cvt_pk_bf16_f32 v163, v134, v135
    v_cvt_pk_bf16_f32 v164, v136, v137
    v_cvt_pk_bf16_f32 v165, v138, v139
    v_cvt_pk_bf16_f32 v166, v140, v141
    v_cvt_pk_bf16_f32 v167, v142, v143
    v_cvt_pk_bf16_f32 v168, v144, v145
    v_cvt_pk_bf16_f32 v169, v146, v147
    v_cvt_pk_bf16_f32 v170, v148, v149
    v_cvt_pk_bf16_f32 v171, v150, v151
    v_cvt_pk_bf16_f32 v172, v152, v153
    v_cvt_pk_bf16_f32 v173, v154, v155
    v_cvt_pk_bf16_f32 v174, v156, v157
    v_cvt_pk_bf16_f32 v175, v158, v159
    global_store_dwordx4 v5, v[160:163], s[18:19] offset:0 sc1
    global_store_dwordx4 v5, v[164:167], s[18:19] offset:1024 sc1
    global_store_dwordx4 v5, v[168:171], s[18:19] offset:2048 sc1
    global_store_dwordx4 v5, v[172:175], s[18:19] offset:3072 sc1

    v_mov_b32 v7, s14
    s_waitcnt vmcnt(33)
    s_cmp_lg_u32 s14, 0
    s_cbranch_scc1 X1_nf
    v_mov_b32 v7, 1
    s_waitcnt vmcnt(0)
X1_nf:
    s_mov_b64 exec, 1
    global_store_dword v6, v7, s[4:5] sc1
    s_mov_b64 exec, -1

    s_add_u32 s14, s14, 1
    s_add_u32 s18, s18, 917504
    s_addc_u32 s19, s19, 0
    s_cmp_ge_u32 s14, 31
    s_cbranch_scc1 X1_noinc
    s_add_u32 s24, s24, 57344
    s_addc_u32 s25, s25, 0
X1_noinc:
    s_cmp_lt_u32 s14, 32
    s_cbranch_scc1 X1_loop
    v_mov_b32 v7, 32
    s_waitcnt vmcnt(0)
    s_mov_b64 exec, 1
    global_store_dword v6, v7, s[4:5] sc1
    s_mov_b64 exec, -1
    s_branch M_end

R_GX:
    s_sleep 127
    s_sleep 127
    s_sleep 127
    s_sleep 127
    s_and_b32 s14, s26, 1
    s_lshr_b32 s26, s26, 1

    s_lshl_b32 s28, s26, 2
    s_add_u32 s28, s28, s3
    s_mul_i32 s28, s28, 100352
    s_add_u32 s30, s4, s28
    s_addc_u32 s31, s5, 0
    v_lshlrev_b32 v2, 4, v1
    v_add_u32 v5, 86016, v2

    global_load_dwordx4 v[16:19], v5, s[30:31] offset:0
    global_load_dwordx4 v[20:23], v5, s[30:31] offset:1024
    global_load_dwordx4 v[24:27], v5, s[30:31] offset:2048
    global_load_dwordx4 v[28:31], v5, s[30:31] offset:3072
    v_add_u32 v5, 4096, v5
    global_load_dwordx4 v[32:35], v5, s[30:31] offset:0
    global_load_dwordx4 v[36:39], v5, s[30:31] offset:1024
    global_load_dwordx4 v[40:43], v5, s[30:31] offset:2048
    global_load_dwordx4 v[44:47], v5, s[30:31] offset:3072
    v_add_u32 v5, 4096, v5
    global_load_dwordx4 v[48:51], v5, s[30:31] offset:0
    global_load_dwordx4 v[52:55], v5, s[30:31] offset:1024
    global_load_dwordx4 v[56:59], v5, s[30:31] offset:2048
    global_load_dwordx4 v[60:63], v5, s[30:31] offset:3072
    v_add_u32 v5, 4096, v5
    global_load_dwordx4 v[64:67], v5, s[30:31] offset:0
    global_load_dwordx4 v[68:71], v5, s[30:31] offset:1024
    global_load_dwordx4 a[0:3], v2, s[30:31] offset:0
    global_load_dwordx4 a[4:7], v2, s[30:31] offset:1024
    global_load_dwordx4 a[8:11], v2, s[30:31] offset:2048
    global_load_dwordx4 a[12:15], v2, s[30:31] offset:3072
    v_add_u32 v2, 4096, v2
    global_load_dwordx4 a[16:19], v2, s[30:31] offset:0
    global_load_dwordx4 a[20:23], v2, s[30:31] offset:1024
    global_load_dwordx4 a[24:27], v2, s[30:31] offset:2048
    global_load_dwordx4 a[28:31], v2, s[30:31] offset:3072
    v_add_u32 v2, 4096, v2
    global_load_dwordx4 a[32:35], v2, s[30:31] offset:0
    global_load_dwordx4 a[36:39], v2, s[30:31] offset:1024
    global_load_dwordx4 a[40:43], v2, s[30:31] offset:2048
    global_load_dwordx4 a[44:47], v2, s[30:31] offset:3072
    v_add_u32 v2, 4096, v2
    global_load_dwordx4 a[48:51], v2, s[30:31] offset:0
    global_load_dwordx4 a[52:55], v2, s[30:31] offset:1024
    global_load_dwordx4 a[56:59], v2, s[30:31] offset:2048
    global_load_dwordx4 a[60:63], v2, s[30:31] offset:3072
    v_add_u32 v2, 4096, v2
    global_load_dwordx4 a[64:67], v2, s[30:31] offset:0
    global_load_dwordx4 a[68:71], v2, s[30:31] offset:1024
    global_load_dwordx4 a[72:75], v2, s[30:31] offset:2048
    global_load_dwordx4 a[76:79], v2, s[30:31] offset:3072
    v_add_u32 v2, 4096, v2
    global_load_dwordx4 a[80:83], v2, s[30:31] offset:0
    global_load_dwordx4 a[84:87], v2, s[30:31] offset:1024
    global_load_dwordx4 a[88:91], v2, s[30:31] offset:2048
    global_load_dwordx4 a[92:95], v2, s[30:31] offset:3072
    v_add_u32 v2, 4096, v2
    global_load_dwordx4 a[96:99], v2, s[30:31] offset:0
    global_load_dwordx4 a[100:103], v2, s[30:31] offset:1024
    global_load_dwordx4 a[104:107], v2, s[30:31] offset:2048
    global_load_dwordx4 a[108:111], v2, s[30:31] offset:3072
    v_add_u32 v2, 4096, v2
    global_load_dwordx4 a[112:115], v2, s[30:31] offset:0
    global_load_dwordx4 a[116:119], v2, s[30:31] offset:1024
    global_load_dwordx4 a[120:123], v2, s[30:31] offset:2048
    global_load_dwordx4 a[124:127], v2, s[30:31] offset:3072
    v_add_u32 v2, 4096, v2
    global_load_dwordx4 a[128:131], v2, s[30:31] offset:0
    global_load_dwordx4 a[132:135], v2, s[30:31] offset:1024
    global_load_dwordx4 a[136:139], v2, s[30:31] offset:2048
    global_load_dwordx4 a[140:143], v2, s[30:31] offset:3072
    v_add_u32 v2, 4096, v2
    global_load_dwordx4 a[144:147], v2, s[30:31] offset:0
    global_load_dwordx4 a[148:151], v2, s[30:31] offset:1024
    global_load_dwordx4 a[152:155], v2, s[30:31] offset:2048
    global_load_dwordx4 a[156:159], v2, s[30:31] offset:3072
    v_add_u32 v2, 4096, v2
    global_load_dwordx4 a[160:163], v2, s[30:31] offset:0
    global_load_dwordx4 a[164:167], v2, s[30:31] offset:1024
    global_load_dwordx4 a[168:171], v2, s[30:31] offset:2048
    global_load_dwordx4 a[172:175], v2, s[30:31] offset:3072
    v_add_u32 v2, 4096, v2
    global_load_dwordx4 a[176:179], v2, s[30:31] offset:0
    global_load_dwordx4 a[180:183], v2, s[30:31] offset:1024
    global_load_dwordx4 a[184:187], v2, s[30:31] offset:2048
    global_load_dwordx4 a[188:191], v2, s[30:31] offset:3072
    v_add_u32 v2, 4096, v2
    global_load_dwordx4 a[192:195], v2, s[30:31] offset:0
    global_load_dwordx4 a[196:199], v2, s[30:31] offset:1024
    global_load_dwordx4 a[200:203], v2, s[30:31] offset:2048
    global_load_dwordx4 a[204:207], v2, s[30:31] offset:3072
    v_add_u32 v2, 4096, v2
    global_load_dwordx4 a[208:211], v2, s[30:31] offset:0
    global_load_dwordx4 a[212:215], v2, s[30:31] offset:1024
    global_load_dwordx4 a[216:219], v2, s[30:31] offset:2048
    global_load_dwordx4 a[220:223], v2, s[30:31] offset:3072
    v_add_u32 v2, 4096, v2
    global_load_dwordx4 a[224:227], v2, s[30:31] offset:0
    global_load_dwordx4 a[228:231], v2, s[30:31] offset:1024
    global_load_dwordx4 a[232:235], v2, s[30:31] offset:2048
    global_load_dwordx4 a[236:239], v2, s[30:31] offset:3072
    v_add_u32 v2, 4096, v2
    global_load_dwordx4 a[240:243], v2, s[30:31] offset:0
    global_load_dwordx4 a[244:247], v2, s[30:31] offset:1024
    global_load_dwordx4 a[248:251], v2, s[30:31] offset:2048
    global_load_dwordx4 a[252:255], v2, s[30:31] offset:3072
    v_add_u32 v2, 4096, v2
    global_load_dwordx4 v[176:179], v2, s[30:31] offset:0
    global_load_dwordx4 v[180:183], v2, s[30:31] offset:1024
    global_load_dwordx4 v[184:187], v2, s[30:31] offset:2048
    global_load_dwordx4 v[188:191], v2, s[30:31] offset:3072
    v_add_u32 v2, 4096, v2
    global_load_dwordx4 v[192:195], v2, s[30:31] offset:0
    global_load_dwordx4 v[196:199], v2, s[30:31] offset:1024
    global_load_dwordx4 v[200:203], v2, s[30:31] offset:2048
    global_load_dwordx4 v[204:207], v2, s[30:31] offset:3072
    v_add_u32 v2, 4096, v2
    global_load_dwordx4 v[208:211], v2, s[30:31] offset:0
    global_load_dwordx4 v[212:215], v2, s[30:31] offset:1024
    global_load_dwordx4 v[216:219], v2, s[30:31] offset:2048
    global_load_dwordx4 v[220:223], v2, s[30:31] offset:3072
    v_add_u32 v2, 4096, v2
    global_load_dwordx4 v[224:227], v2, s[30:31] offset:0
    global_load_dwordx4 v[228:231], v2, s[30:31] offset:1024
    global_load_dwordx4 v[232:235], v2, s[30:31] offset:2048
    global_load_dwordx4 v[236:239], v2, s[30:31] offset:3072
    v_add_u32 v2, 4096, v2
    global_load_dwordx4 v[240:243], v2, s[30:31] offset:0
    global_load_dwordx4 v[244:247], v2, s[30:31] offset:1024
    global_load_dwordx4 v[248:251], v2, s[30:31] offset:2048
    global_load_dwordx4 v[252:255], v2, s[30:31] offset:3072
    v_add_u32 v2, 4096, v2

    s_mul_i32 s28, s3, 14336
    s_add_u32 s28, s28, 16384
    v_lshl_add_u32 v8, v1, 4, s28
    s_waitcnt vmcnt(63)

    ds_write_b128 v8, v[16:19] offset:0
    ds_write_b128 v8, v[20:23] offset:1024
    ds_write_b128 v8, v[24:27] offset:2048
    ds_write_b128 v8, v[28:31] offset:3072
    ds_write_b128 v8, v[32:35] offset:4096
    ds_write_b128 v8, v[36:39] offset:5120
    ds_write_b128 v8, v[40:43] offset:6144
    ds_write_b128 v8, v[44:47] offset:7168
    ds_write_b128 v8, v[48:51] offset:8192
    ds_write_b128 v8, v[52:55] offset:9216
    ds_write_b128 v8, v[56:59] offset:10240
    ds_write_b128 v8, v[60:63] offset:11264
    ds_write_b128 v8, v[64:67] offset:12288
    ds_write_b128 v8, v[68:71] offset:13312

    v_and_b32 v10, 7, v1
    v_lshrrev_b32 v11, 4, v1
    v_lshrrev_b32 v12, 1, v11
    v_lshlrev_b32 v5, 7, v12
    v_lshl_add_u32 v5, v10, 4, v5
    v_and_b32 v12, 1, v11
    v_lshl_add_u32 v5, v12, 3, v5
    s_mul_i32 s28, s3, 1792
    v_add_u32 v5, s28, v5
    s_mul_i32 s28, s3, 7168
    v_lshl_add_u32 v7, v1, 4, s28
    v_add_u32 v9, 4096, v7
    v_and_b32 v12, 15, v1
    v_lshrrev_b32 v11, 4, v1
    v_lshlrev_b32 v3, 4, v1
    v_add_u32 v3, 4096, v3
    v_add_u32 v4, 8192, v3
    v_add_u32 v6, 16384, v3
    v_add_u32 v158, 24576, v3
    v_mul_u32_u24 v10, 208, v12
    v_lshl_add_u32 v10, v11, 4, v10
    s_mul_i32 s28, s3, 6656
    s_add_u32 s28, s28, 73728
    v_add_u32 v10, s28, v10
    v_lshrrev_b32 v12, 3, v0
    v_and_b32 v13, 7, v0
    v_mul_u32_u24 v11, 208, v12
    v_add_u32 v11, 73728, v11
    v_lshl_add_u32 v2, v13, 2, v11
    v_add_u32 v2, 128, v2
    v_lshl_add_u32 v11, v13, 4, v11
    v_lshlrev_b32 v14, 2, v13
    v_cmp_le_u32 s[44:45], v14, v12
    v_add_u32 v14, 1, v14
    v_cmp_le_u32 s[46:47], v14, v12
    v_add_u32 v14, 1, v14
    v_cmp_le_u32 s[48:49], v14, v12
    v_add_u32 v14, 1, v14
    v_cmp_le_u32 s[50:51], v14, v12
    v_lshlrev_b32 v14, 6, v12
    v_and_b32 v15, 3, v13
    v_lshl_add_u32 v14, v15, 4, v14
    v_lshrrev_b32 v15, 2, v13
    v_lshl_add_u32 v14, v15, 3, v14
    v_lshlrev_b32 v12, 4, v12
    v_lshl_add_u32 v12, v13, 1, v12
    v_add_u32 v0, 2048, v12
    v_mov_b32 v1, v14
    v_mov_b32 v156, 0
    v_mov_b32 v157, 0
    s_mul_i32 s28, s14, 28672
    s_add_u32 s28, s28, 0x1500000
    s_add_u32 s38, s4, s28
    s_addc_u32 s39, s5, 0
    s_lshl_b32 s28, s14, 15
    s_add_u32 s28, s28, 0xe82000
    s_add_u32 s16, s4, s28
    s_addc_u32 s17, s5, 0
    s_lshl_b32 s28, s14, 4
    s_add_u32 s28, s28, s26
    s_mul_i32 s28, s28, 2560
    s_add_u32 s28, s28, 0x1200000
    s_add_u32 s18, s4, s28
    s_addc_u32 s19, s5, 0
    s_mul_i32 s28, s14, 28672
    s_add_u32 s28, s28, 0x3600000
    s_add_u32 s24, s4, s28
    s_addc_u32 s25, s5, 0
    s_add_u32 s52, s24, 57344
    s_addc_u32 s53, s25, 0
    s_mov_b32 s42, 0
    s_mov_b32 s43, 0xf149f2ca
    s_waitcnt lgkmcnt(0)

    global_load_dwordx4 v[16:19], v3, s[24:25] offset:-4096
    global_load_dwordx4 v[20:23], v3, s[24:25] offset:-3072
    global_load_dwordx4 v[24:27], v3, s[24:25] offset:-2048
    global_load_dwordx4 v[28:31], v3, s[24:25] offset:-1024
    global_load_dwordx4 v[32:35], v3, s[24:25] offset:0
    global_load_dwordx4 v[36:39], v3, s[24:25] offset:1024
    global_load_dwordx4 v[40:43], v3, s[24:25] offset:2048
    global_load_dwordx4 v[44:47], v3, s[24:25] offset:3072
    global_load_dwordx4 v[48:51], v4, s[24:25] offset:-4096
    global_load_dwordx4 v[52:55], v4, s[24:25] offset:-3072
    global_load_dwordx4 v[56:59], v4, s[24:25] offset:-2048
    global_load_dwordx4 v[60:63], v4, s[24:25] offset:-1024
    global_load_dwordx4 v[64:67], v4, s[24:25] offset:0
    global_load_dwordx4 v[68:71], v4, s[24:25] offset:1024
    global_load_dwordx4 v[128:131], v7, s[38:39] offset:0
    global_load_dwordx4 v[132:135], v7, s[38:39] offset:1024
    global_load_dwordx4 v[136:139], v7, s[38:39] offset:2048
    global_load_dwordx4 v[140:143], v7, s[38:39] offset:3072
    global_load_dwordx4 v[144:147], v9, s[38:39] offset:0
    global_load_dwordx4 v[148:151], v9, s[38:39] offset:1024
    global_load_dwordx4 v[152:155], v9, s[38:39] offset:2048
    s_waitcnt vmcnt(0)
GX_loop:
    v_add_u32 v12, s42, v10
    ds_read_b128 v[100:103], v8 offset:0
    ds_read_b128 v[104:107], v8 offset:1024
    ds_read_b128 v[108:111], v8 offset:2048
    ds_read_b128 v[112:115], v8 offset:3072
    ds_read_b128 v[116:119], v8 offset:4096
    ds_read_b128 v[120:123], v8 offset:5120
    ds_read_b128 v[124:127], v8 offset:6144
    v_mfma_f32_16x16x32_bf16 v[72:75], a[0:3], v[16:19], 0
    v_mfma_f32_16x16x32_bf16 v[76:79], a[56:59], v[16:19], 0
    v_mfma_f32_16x16x32_bf16 v[80:83], a[112:115], v[16:19], 0
    v_mfma_f32_16x16x32_bf16 v[84:87], a[168:171], v[16:19], 0
    v_mfma_f32_16x16x32_bf16 v[88:91], a[224:227], v[16:19], 0
    v_mfma_f32_16x16x32_bf16 v[92:95], v[200:203], v[16:19], 0
    s_waitcnt lgkmcnt(0)
    v_mfma_f32_16x16x32_bf16 v[96:99], v[100:103], v[16:19], 0
    ds_read_b128 v[100:103], v8 offset:7168
    global_load_dwordx4 v[16:19], v4, s[24:25] offset:2048
    v_mfma_f32_16x16x32_bf16 v[72:75], a[4:7], v[20:23], v[72:75]
    v_mfma_f32_16x16x32_bf16 v[76:79], a[60:63], v[20:23], v[76:79]
    v_mfma_f32_16x16x32_bf16 v[80:83], a[116:119], v[20:23], v[80:83]
    v_mfma_f32_16x16x32_bf16 v[84:87], a[172:175], v[20:23], v[84:87]
    v_mfma_f32_16x16x32_bf16 v[88:91], a[228:231], v[20:23], v[88:91]
    v_mfma_f32_16x16x32_bf16 v[92:95], v[204:207], v[20:23], v[92:95]
    v_mfma_f32_16x16x32_bf16 v[96:99], v[104:107], v[20:23], v[96:99]
    ds_read_b128 v[104:107], v8 offset:8192
    global_load_dwordx4 v[20:23], v4, s[24:25] offset:3072
    v_mfma_f32_16x16x32_bf16 v[72:75], a[8:11], v[24:27], v[72:75]
    v_mfma_f32_16x16x32_bf16 v[76:79], a[64:67], v[24:27], v[76:79]
    v_mfma_f32_16x16x32_bf16 v[80:83], a[120:123], v[24:27], v[80:83]
    v_mfma_f32_16x16x32_bf16 v[84:87], a[176:179], v[24:27], v[84:87]
    v_mfma_f32_16x16x32_bf16 v[88:91], a[232:235], v[24:27], v[88:91]
    v_mfma_f32_16x16x32_bf16 v[92:95], v[208:211], v[24:27], v[92:95]
    v_mfma_f32_16x16x32_bf16 v[96:99], v[108:111], v[24:27], v[96:99]
    ds_read_b128 v[108:111], v8 offset:9216
    global_load_dwordx4 v[24:27], v6, s[24:25] offset:-4096
    v_mfma_f32_16x16x32_bf16 v[72:75], a[12:15], v[28:31], v[72:75]
    v_mfma_f32_16x16x32_bf16 v[76:79], a[68:71], v[28:31], v[76:79]
    v_mfma_f32_16x16x32_bf16 v[80:83], a[124:127], v[28:31], v[80:83]
    v_mfma_f32_16x16x32_bf16 v[84:87], a[180:183], v[28:31], v[84:87]
    v_mfma_f32_16x16x32_bf16 v[88:91], a[236:239], v[28:31], v[88:91]
    v_mfma_f32_16x16x32_bf16 v[92:95], v[212:215], v[28:31], v[92:95]
    v_mfma_f32_16x16x32_bf16 v[96:99], v[112:115], v[28:31], v[96:99]
    ds_read_b128 v[112:115], v8 offset:10240
    global_load_dwordx4 v[28:31], v6, s[24:25] offset:-3072
    v_mfma_f32_16x16x32_bf16 v[72:75], a[16:19], v[32:35], v[72:75]
    v_mfma_f32_16x16x32_bf16 v[76:79], a[72:75], v[32:35], v[76:79]
    v_mfma_f32_16x16x32_bf16 v[80:83], a[128:131], v[32:35], v[80:83]
    v_mfma_f32_16x16x32_bf16 v[84:87], a[184:187], v[32:35], v[84:87]
    v_mfma_f32_16x16x32_bf16 v[88:91], a[240:243], v[32:35], v[88:91]
    v_mfma_f32_16x16x32_bf16 v[92:95], v[216:219], v[32:35], v[92:95]
    v_mfma_f32_16x16x32_bf16 v[96:99], v[116:119], v[32:35], v[96:99]
    ds_read_b128 v[116:119], v8 offset:11264
    global_load_dwordx4 v[32:35], v6, s[24:25] offset:-2048
    v_mfma_f32_16x16x32_bf16 v[72:75], a[20:23], v[36:39], v[72:75]
    v_mfma_f32_16x16x32_bf16 v[76:79], a[76:79], v[36:39], v[76:79]
    v_mfma_f32_16x16x32_bf16 v[80:83], a[132:135], v[36:39], v[80:83]
    v_mfma_f32_16x16x32_bf16 v[84:87], a[188:191], v[36:39], v[84:87]
    v_mfma_f32_16x16x32_bf16 v[88:91], a[244:247], v[36:39], v[88:91]
    v_mfma_f32_16x16x32_bf16 v[92:95], v[220:223], v[36:39], v[92:95]
    v_mfma_f32_16x16x32_bf16 v[96:99], v[120:123], v[36:39], v[96:99]
    ds_read_b128 v[120:123], v8 offset:12288
    global_load_dwordx4 v[36:39], v6, s[24:25] offset:-1024
    v_mfma_f32_16x16x32_bf16 v[72:75], a[24:27], v[40:43], v[72:75]
    v_mfma_f32_16x16x32_bf16 v[76:79], a[80:83], v[40:43], v[76:79]
    v_mfma_f32_16x16x32_bf16 v[80:83], a[136:139], v[40:43], v[80:83]
    v_mfma_f32_16x16x32_bf16 v[84:87], a[192:195], v[40:43], v[84:87]
    v_mfma_f32_16x16x32_bf16 v[88:91], a[248:251], v[40:43], v[88:91]
    v_mfma_f32_16x16x32_bf16 v[92:95], v[224:227], v[40:43], v[92:95]
    v_mfma_f32_16x16x32_bf16 v[96:99], v[124:127], v[40:43], v[96:99]
    ds_read_b128 v[124:127], v8 offset:13312
    global_load_dwordx4 v[40:43], v6, s[24:25] offset:0
    v_mfma_f32_16x16x32_bf16 v[72:75], a[28:31], v[44:47], v[72:75]
    v_mfma_f32_16x16x32_bf16 v[76:79], a[84:87], v[44:47], v[76:79]
    v_mfma_f32_16x16x32_bf16 v[80:83], a[140:143], v[44:47], v[80:83]
    v_mfma_f32_16x16x32_bf16 v[84:87], a[196:199], v[44:47], v[84:87]
    v_mfma_f32_16x16x32_bf16 v[88:91], a[252:255], v[44:47], v[88:91]
    v_mfma_f32_16x16x32_bf16 v[92:95], v[228:231], v[44:47], v[92:95]
    s_waitcnt lgkmcnt(6)
    v_mfma_f32_16x16x32_bf16 v[96:99], v[100:103], v[44:47], v[96:99]
    global_load_dwordx4 v[44:47], v6, s[24:25] offset:1024
    v_mfma_f32_16x16x32_bf16 v[72:75], a[32:35], v[48:51], v[72:75]
    v_mfma_f32_16x16x32_bf16 v[76:79], a[88:91], v[48:51], v[76:79]
    v_mfma_f32_16x16x32_bf16 v[80:83], a[144:147], v[48:51], v[80:83]
    v_mfma_f32_16x16x32_bf16 v[84:87], a[200:203], v[48:51], v[84:87]
    v_mfma_f32_16x16x32_bf16 v[88:91], v[176:179], v[48:51], v[88:91]
    v_mfma_f32_16x16x32_bf16 v[92:95], v[232:235], v[48:51], v[92:95]
    s_waitcnt lgkmcnt(5)
    v_mfma_f32_16x16x32_bf16 v[96:99], v[104:107], v[48:51], v[96:99]
    global_load_dwordx4 v[48:51], v6, s[24:25] offset:2048
    v_mfma_f32_16x16x32_bf16 v[72:75], a[36:39], v[52:55], v[72:75]
    v_mfma_f32_16x16x32_bf16 v[76:79], a[92:95], v[52:55], v[76:79]
    v_mfma_f32_16x16x32_bf16 v[80:83], a[148:151], v[52:55], v[80:83]
    v_mfma_f32_16x16x32_bf16 v[84:87], a[204:207], v[52:55], v[84:87]
    v_mfma_f32_16x16x32_bf16 v[88:91], v[180:183], v[52:55], v[88:91]
    v_mfma_f32_16x16x32_bf16 v[92:95], v[236:239], v[52:55], v[92:95]
    s_waitcnt lgkmcnt(4)
    v_mfma_f32_16x16x32_bf16 v[96:99], v[108:111], v[52:55], v[96:99]
    global_load_dwordx4 v[52:55], v6, s[24:25] offset:3072
    v_mfma_f32_16x16x32_bf16 v[72:75], a[40:43], v[56:59], v[72:75]
    v_mfma_f32_16x16x32_bf16 v[76:79], a[96:99], v[56:59], v[76:79]
    v_mfma_f32_16x16x32_bf16 v[80:83], a[152:155], v[56:59], v[80:83]
    v_mfma_f32_16x16x32_bf16 v[84:87], a[208:211], v[56:59], v[84:87]
    v_mfma_f32_16x16x32_bf16 v[88:91], v[184:187], v[56:59], v[88:91]
    v_mfma_f32_16x16x32_bf16 v[92:95], v[240:243], v[56:59], v[92:95]
    s_waitcnt lgkmcnt(3)
    v_mfma_f32_16x16x32_bf16 v[96:99], v[112:115], v[56:59], v[96:99]
    global_load_dwordx4 v[56:59], v158, s[24:25] offset:-4096
    v_mfma_f32_16x16x32_bf16 v[72:75], a[44:47], v[60:63], v[72:75]
    v_mfma_f32_16x16x32_bf16 v[76:79], a[100:103], v[60:63], v[76:79]
    v_mfma_f32_16x16x32_bf16 v[80:83], a[156:159], v[60:63], v[80:83]
    v_mfma_f32_16x16x32_bf16 v[84:87], a[212:215], v[60:63], v[84:87]
    v_mfma_f32_16x16x32_bf16 v[88:91], v[188:191], v[60:63], v[88:91]
    v_mfma_f32_16x16x32_bf16 v[92:95], v[244:247], v[60:63], v[92:95]
    s_waitcnt lgkmcnt(2)
    v_mfma_f32_16x16x32_bf16 v[96:99], v[116:119], v[60:63], v[96:99]
    global_load_dwordx4 v[60:63], v158, s[24:25] offset:-3072
    v_mfma_f32_16x16x32_bf16 v[72:75], a[48:51], v[64:67], v[72:75]
    v_mfma_f32_16x16x32_bf16 v[76:79], a[104:107], v[64:67], v[76:79]
    v_mfma_f32_16x16x32_bf16 v[80:83], a[160:163], v[64:67], v[80:83]
    v_mfma_f32_16x16x32_bf16 v[84:87], a[216:219], v[64:67], v[84:87]
    v_mfma_f32_16x16x32_bf16 v[88:91], v[192:195], v[64:67], v[88:91]
    v_mfma_f32_16x16x32_bf16 v[92:95], v[248:251], v[64:67], v[92:95]
    s_waitcnt lgkmcnt(1)
    v_mfma_f32_16x16x32_bf16 v[96:99], v[120:123], v[64:67], v[96:99]
    global_load_dwordx4 v[64:67], v158, s[24:25] offset:-2048
    v_mfma_f32_16x16x32_bf16 v[72:75], a[52:55], v[68:71], v[72:75]
    v_mfma_f32_16x16x32_bf16 v[76:79], a[108:111], v[68:71], v[76:79]
    v_mfma_f32_16x16x32_bf16 v[80:83], a[164:167], v[68:71], v[80:83]
    v_mfma_f32_16x16x32_bf16 v[84:87], a[220:223], v[68:71], v[84:87]
    v_mfma_f32_16x16x32_bf16 v[88:91], v[196:199], v[68:71], v[88:91]
    v_mfma_f32_16x16x32_bf16 v[92:95], v[252:255], v[68:71], v[92:95]
    s_waitcnt lgkmcnt(0)
    v_mfma_f32_16x16x32_bf16 v[96:99], v[124:127], v[68:71], v[96:99]
    global_load_dwordx4 v[68:71], v158, s[24:25] offset:-1024
    s_nop 0
    v_cvt_pk_bf16_f32 v160, v72, v73
    v_cvt_pk_bf16_f32 v161, v74, v75
    v_cvt_pk_bf16_f32 v162, v76, v77
    v_cvt_pk_bf16_f32 v163, v78, v79
    v_cvt_pk_bf16_f32 v164, v80, v81
    v_cvt_pk_bf16_f32 v165, v82, v83
    v_cvt_pk_bf16_f32 v166, v84, v85
    v_cvt_pk_bf16_f32 v167, v86, v87
    v_cvt_pk_bf16_f32 v168, v88, v89
    v_cvt_pk_bf16_f32 v169, v90, v91
    v_cvt_pk_bf16_f32 v170, v92, v93
    v_cvt_pk_bf16_f32 v171, v94, v95
    v_cvt_pk_bf16_f32 v172, v96, v97
    v_cvt_pk_bf16_f32 v173, v98, v99
    v_mov_b32 v174, 0
    v_mov_b32 v175, 0
    s_waitcnt vmcnt(14)
    v_mfma_f32_16x16x32_bf16 v[72:75], v[128:131], v[160:163], 0
    v_mfma_f32_16x16x32_bf16 v[72:75], v[132:135], v[164:167], v[72:75]
    v_mfma_f32_16x16x32_bf16 v[72:75], v[136:139], v[168:171], v[72:75]
    v_mfma_f32_16x16x32_bf16 v[72:75], v[152:155], v[172:175], v[72:75]
    s_nop 7
    ds_write_b128 v12, v[72:75]
    s_nop 1
    ds_read_b128 v[100:103], v8 offset:0
    ds_read_b128 v[104:107], v8 offset:1024
    ds_read_b128 v[108:111], v8 offset:2048
    ds_read_b128 v[112:115], v8 offset:3072
    ds_read_b128 v[116:119], v8 offset:4096
    ds_read_b128 v[120:123], v8 offset:5120
    ds_read_b128 v[124:127], v8 offset:6144
    s_waitcnt vmcnt(13)
    v_mfma_f32_16x16x32_bf16 v[72:75], a[0:3], v[16:19], 0
    v_mfma_f32_16x16x32_bf16 v[76:79], a[56:59], v[16:19], 0
    v_mfma_f32_16x16x32_bf16 v[80:83], a[112:115], v[16:19], 0
    v_mfma_f32_16x16x32_bf16 v[84:87], a[168:171], v[16:19], 0
    v_mfma_f32_16x16x32_bf16 v[88:91], a[224:227], v[16:19], 0
    v_mfma_f32_16x16x32_bf16 v[92:95], v[200:203], v[16:19], 0
    s_waitcnt lgkmcnt(0)
    v_mfma_f32_16x16x32_bf16 v[96:99], v[100:103], v[16:19], 0
    ds_read_b128 v[100:103], v8 offset:7168
    global_load_dwordx4 v[16:19], v3, s[52:53] offset:-4096
    s_waitcnt vmcnt(13)
    v_mfma_f32_16x16x32_bf16 v[72:75], a[4:7], v[20:23], v[72:75]
    v_mfma_f32_16x16x32_bf16 v[76:79], a[60:63], v[20:23], v[76:79]
    v_mfma_f32_16x16x32_bf16 v[80:83], a[116:119], v[20:23], v[80:83]
    v_mfma_f32_16x16x32_bf16 v[84:87], a[172:175], v[20:23], v[84:87]
    v_mfma_f32_16x16x32_bf16 v[88:91], a[228:231], v[20:23], v[88:91]
    v_mfma_f32_16x16x32_bf16 v[92:95], v[204:207], v[20:23], v[92:95]
    v_mfma_f32_16x16x32_bf16 v[96:99], v[104:107], v[20:23], v[96:99]
    ds_read_b128 v[104:107], v8 offset:8192
    global_load_dwordx4 v[20:23], v3, s[52:53] offset:-3072
    s_waitcnt vmcnt(13)
    v_mfma_f32_16x16x32_bf16 v[72:75], a[8:11], v[24:27], v[72:75]
    v_mfma_f32_16x16x32_bf16 v[76:79], a[64:67], v[24:27], v[76:79]
    v_mfma_f32_16x16x32_bf16 v[80:83], a[120:123], v[24:27], v[80:83]
    v_mfma_f32_16x16x32_bf16 v[84:87], a[176:179], v[24:27], v[84:87]
    v_mfma_f32_16x16x32_bf16 v[88:91], a[232:235], v[24:27], v[88:91]
    v_mfma_f32_16x16x32_bf16 v[92:95], v[208:211], v[24:27], v[92:95]
    v_mfma_f32_16x16x32_bf16 v[96:99], v[108:111], v[24:27], v[96:99]
    ds_read_b128 v[108:111], v8 offset:9216
    global_load_dwordx4 v[24:27], v3, s[52:53] offset:-2048
    s_waitcnt vmcnt(13)
    v_mfma_f32_16x16x32_bf16 v[72:75], a[12:15], v[28:31], v[72:75]
    v_mfma_f32_16x16x32_bf16 v[76:79], a[68:71], v[28:31], v[76:79]
    v_mfma_f32_16x16x32_bf16 v[80:83], a[124:127], v[28:31], v[80:83]
    v_mfma_f32_16x16x32_bf16 v[84:87], a[180:183], v[28:31], v[84:87]
    v_mfma_f32_16x16x32_bf16 v[88:91], a[236:239], v[28:31], v[88:91]
    v_mfma_f32_16x16x32_bf16 v[92:95], v[212:215], v[28:31], v[92:95]
    v_mfma_f32_16x16x32_bf16 v[96:99], v[112:115], v[28:31], v[96:99]
    ds_read_b128 v[112:115], v8 offset:10240
    global_load_dwordx4 v[28:31], v3, s[52:53] offset:-1024
    s_waitcnt vmcnt(13)
    v_mfma_f32_16x16x32_bf16 v[72:75], a[16:19], v[32:35], v[72:75]
    v_mfma_f32_16x16x32_bf16 v[76:79], a[72:75], v[32:35], v[76:79]
    v_mfma_f32_16x16x32_bf16 v[80:83], a[128:131], v[32:35], v[80:83]
    v_mfma_f32_16x16x32_bf16 v[84:87], a[184:187], v[32:35], v[84:87]
    v_mfma_f32_16x16x32_bf16 v[88:91], a[240:243], v[32:35], v[88:91]
    v_mfma_f32_16x16x32_bf16 v[92:95], v[216:219], v[32:35], v[92:95]
    v_mfma_f32_16x16x32_bf16 v[96:99], v[116:119], v[32:35], v[96:99]
    ds_read_b128 v[116:119], v8 offset:11264
    global_load_dwordx4 v[32:35], v3, s[52:53] offset:0
    s_waitcnt vmcnt(13)
    v_mfma_f32_16x16x32_bf16 v[72:75], a[20:23], v[36:39], v[72:75]
    v_mfma_f32_16x16x32_bf16 v[76:79], a[76:79], v[36:39], v[76:79]
    v_mfma_f32_16x16x32_bf16 v[80:83], a[132:135], v[36:39], v[80:83]
    v_mfma_f32_16x16x32_bf16 v[84:87], a[188:191], v[36:39], v[84:87]
    v_mfma_f32_16x16x32_bf16 v[88:91], a[244:247], v[36:39], v[88:91]
    v_mfma_f32_16x16x32_bf16 v[92:95], v[220:223], v[36:39], v[92:95]
    v_mfma_f32_16x16x32_bf16 v[96:99], v[120:123], v[36:39], v[96:99]
    ds_read_b128 v[120:123], v8 offset:12288
    global_load_dwordx4 v[36:39], v3, s[52:53] offset:1024
    s_waitcnt vmcnt(13)
    v_mfma_f32_16x16x32_bf16 v[72:75], a[24:27], v[40:43], v[72:75]
    v_mfma_f32_16x16x32_bf16 v[76:79], a[80:83], v[40:43], v[76:79]
    v_mfma_f32_16x16x32_bf16 v[80:83], a[136:139], v[40:43], v[80:83]
    v_mfma_f32_16x16x32_bf16 v[84:87], a[192:195], v[40:43], v[84:87]
    v_mfma_f32_16x16x32_bf16 v[88:91], a[248:251], v[40:43], v[88:91]
    v_mfma_f32_16x16x32_bf16 v[92:95], v[224:227], v[40:43], v[92:95]
    v_mfma_f32_16x16x32_bf16 v[96:99], v[124:127], v[40:43], v[96:99]
    ds_read_b128 v[124:127], v8 offset:13312
    global_load_dwordx4 v[40:43], v3, s[52:53] offset:2048
    s_waitcnt vmcnt(13)
    v_mfma_f32_16x16x32_bf16 v[72:75], a[28:31], v[44:47], v[72:75]
    v_mfma_f32_16x16x32_bf16 v[76:79], a[84:87], v[44:47], v[76:79]
    v_mfma_f32_16x16x32_bf16 v[80:83], a[140:143], v[44:47], v[80:83]
    v_mfma_f32_16x16x32_bf16 v[84:87], a[196:199], v[44:47], v[84:87]
    v_mfma_f32_16x16x32_bf16 v[88:91], a[252:255], v[44:47], v[88:91]
    v_mfma_f32_16x16x32_bf16 v[92:95], v[228:231], v[44:47], v[92:95]
    s_waitcnt lgkmcnt(6)
    v_mfma_f32_16x16x32_bf16 v[96:99], v[100:103], v[44:47], v[96:99]
    global_load_dwordx4 v[44:47], v3, s[52:53] offset:3072
    s_waitcnt vmcnt(13)
    v_mfma_f32_16x16x32_bf16 v[72:75], a[32:35], v[48:51], v[72:75]
    v_mfma_f32_16x16x32_bf16 v[76:79], a[88:91], v[48:51], v[76:79]
    v_mfma_f32_16x16x32_bf16 v[80:83], a[144:147], v[48:51], v[80:83]
    v_mfma_f32_16x16x32_bf16 v[84:87], a[200:203], v[48:51], v[84:87]
    v_mfma_f32_16x16x32_bf16 v[88:91], v[176:179], v[48:51], v[88:91]
    v_mfma_f32_16x16x32_bf16 v[92:95], v[232:235], v[48:51], v[92:95]
    s_waitcnt lgkmcnt(5)
    v_mfma_f32_16x16x32_bf16 v[96:99], v[104:107], v[48:51], v[96:99]
    global_load_dwordx4 v[48:51], v4, s[52:53] offset:-4096
    s_waitcnt vmcnt(13)
    v_mfma_f32_16x16x32_bf16 v[72:75], a[36:39], v[52:55], v[72:75]
    v_mfma_f32_16x16x32_bf16 v[76:79], a[92:95], v[52:55], v[76:79]
    v_mfma_f32_16x16x32_bf16 v[80:83], a[148:151], v[52:55], v[80:83]
    v_mfma_f32_16x16x32_bf16 v[84:87], a[204:207], v[52:55], v[84:87]
    v_mfma_f32_16x16x32_bf16 v[88:91], v[180:183], v[52:55], v[88:91]
    v_mfma_f32_16x16x32_bf16 v[92:95], v[236:239], v[52:55], v[92:95]
    s_waitcnt lgkmcnt(4)
    v_mfma_f32_16x16x32_bf16 v[96:99], v[108:111], v[52:55], v[96:99]
    global_load_dwordx4 v[52:55], v4, s[52:53] offset:-3072
    s_waitcnt vmcnt(13)
    v_mfma_f32_16x16x32_bf16 v[72:75], a[40:43], v[56:59], v[72:75]
    v_mfma_f32_16x16x32_bf16 v[76:79], a[96:99], v[56:59], v[76:79]
    v_mfma_f32_16x16x32_bf16 v[80:83], a[152:155], v[56:59], v[80:83]
    v_mfma_f32_16x16x32_bf16 v[84:87], a[208:211], v[56:59], v[84:87]
    v_mfma_f32_16x16x32_bf16 v[88:91], v[184:187], v[56:59], v[88:91]
    v_mfma_f32_16x16x32_bf16 v[92:95], v[240:243], v[56:59], v[92:95]
    s_waitcnt lgkmcnt(3)
    v_mfma_f32_16x16x32_bf16 v[96:99], v[112:115], v[56:59], v[96:99]
    global_load_dwordx4 v[56:59], v4, s[52:53] offset:-2048
    s_waitcnt vmcnt(13)
    v_mfma_f32_16x16x32_bf16 v[72:75], a[44:47], v[60:63], v[72:75]
    v_mfma_f32_16x16x32_bf16 v[76:79], a[100:103], v[60:63], v[76:79]
    v_mfma_f32_16x16x32_bf16 v[80:83], a[156:159], v[60:63], v[80:83]
    v_mfma_f32_16x16x32_bf16 v[84:87], a[212:215], v[60:63], v[84:87]
    v_mfma_f32_16x16x32_bf16 v[88:91], v[188:191], v[60:63], v[88:91]
    v_mfma_f32_16x16x32_bf16 v[92:95], v[244:247], v[60:63], v[92:95]
    s_waitcnt lgkmcnt(2)
    v_mfma_f32_16x16x32_bf16 v[96:99], v[116:119], v[60:63], v[96:99]
    global_load_dwordx4 v[60:63], v4, s[52:53] offset:-1024
    s_waitcnt vmcnt(13)
    v_mfma_f32_16x16x32_bf16 v[72:75], a[48:51], v[64:67], v[72:75]
    v_mfma_f32_16x16x32_bf16 v[76:79], a[104:107], v[64:67], v[76:79]
    v_mfma_f32_16x16x32_bf16 v[80:83], a[160:163], v[64:67], v[80:83]
    v_mfma_f32_16x16x32_bf16 v[84:87], a[216:219], v[64:67], v[84:87]
    v_mfma_f32_16x16x32_bf16 v[88:91], v[192:195], v[64:67], v[88:91]
    v_mfma_f32_16x16x32_bf16 v[92:95], v[248:251], v[64:67], v[92:95]
    s_waitcnt lgkmcnt(1)
    v_mfma_f32_16x16x32_bf16 v[96:99], v[120:123], v[64:67], v[96:99]
    global_load_dwordx4 v[64:67], v4, s[52:53] offset:0
    s_waitcnt vmcnt(13)
    v_mfma_f32_16x16x32_bf16 v[72:75], a[52:55], v[68:71], v[72:75]
    v_mfma_f32_16x16x32_bf16 v[76:79], a[108:111], v[68:71], v[76:79]
    v_mfma_f32_16x16x32_bf16 v[80:83], a[164:167], v[68:71], v[80:83]
    v_mfma_f32_16x16x32_bf16 v[84:87], a[220:223], v[68:71], v[84:87]
    v_mfma_f32_16x16x32_bf16 v[88:91], v[196:199], v[68:71], v[88:91]
    v_mfma_f32_16x16x32_bf16 v[92:95], v[252:255], v[68:71], v[92:95]
    s_waitcnt lgkmcnt(0)
    v_mfma_f32_16x16x32_bf16 v[96:99], v[124:127], v[68:71], v[96:99]
    global_load_dwordx4 v[68:71], v4, s[52:53] offset:1024
    s_nop 0
    v_cvt_pk_bf16_f32 v100, v72, v73
    v_cvt_pk_bf16_f32 v101, v74, v75
    v_cvt_pk_bf16_f32 v102, v76, v77
    v_cvt_pk_bf16_f32 v103, v78, v79
    v_cvt_pk_bf16_f32 v104, v80, v81
    v_cvt_pk_bf16_f32 v105, v82, v83
    v_cvt_pk_bf16_f32 v106, v84, v85
    v_cvt_pk_bf16_f32 v107, v86, v87
    v_cvt_pk_bf16_f32 v108, v88, v89
    v_cvt_pk_bf16_f32 v109, v90, v91
    v_cvt_pk_bf16_f32 v110, v92, v93
    v_cvt_pk_bf16_f32 v111, v94, v95
    v_cvt_pk_bf16_f32 v112, v96, v97
    v_cvt_pk_bf16_f32 v113, v98, v99
    v_mov_b32 v114, 0
    v_mov_b32 v115, 0
    v_mfma_f32_16x16x32_bf16 v[88:91], v[128:131], v[100:103], 0
    v_mfma_f32_16x16x32_bf16 v[92:95], v[140:143], v[100:103], 0
    v_mfma_f32_16x16x32_bf16 v[88:91], v[132:135], v[104:107], v[88:91]
    v_mfma_f32_16x16x32_bf16 v[92:95], v[144:147], v[104:107], v[92:95]
    v_mfma_f32_16x16x32_bf16 v[88:91], v[136:139], v[108:111], v[88:91]
    v_mfma_f32_16x16x32_bf16 v[92:95], v[148:151], v[108:111], v[92:95]
    v_mfma_f32_16x16x32_bf16 v[88:91], v[152:155], v[112:115], v[88:91]
    v_mfma_f32_16x16x32_bf16 v[92:95], v[154:157], v[112:115], v[92:95]
    v_mov_b32 v86, 0
    v_mov_b32 v87, 0
    global_load_dwordx2 v[72:73], v5, s[16:17] offset:0 sc1
    global_load_dwordx2 v[74:75], v5, s[16:17] offset:256 sc1
    global_load_dwordx2 v[76:77], v5, s[16:17] offset:512 sc1
    global_load_dwordx2 v[78:79], v5, s[16:17] offset:768 sc1
    global_load_dwordx2 v[80:81], v5, s[16:17] offset:1024 sc1
    global_load_dwordx2 v[82:83], v5, s[16:17] offset:1280 sc1
    global_load_dwordx2 v[84:85], v5, s[16:17] offset:1536 sc1
Gxm_C0:
    s_waitcnt vmcnt(5)
    v_max3_u32 v15, v72, v73, v74
    v_max_u32 v15, v15, v75
    v_cmp_eq_u32 vcc, -1, v15
    s_cbranch_vccnz Gxm_R0
Gxm_S0:
    v_mfma_f32_16x16x32_bf16 v[116:119], v[72:75], v[160:163], 0
    s_waitcnt vmcnt(3)
    v_max3_u32 v15, v76, v77, v78
    v_max_u32 v15, v15, v79
    v_cmp_eq_u32 vcc, -1, v15
    v_mfma_f32_16x16x32_bf16 v[120:123], v[72:75], v[100:103], 0
    s_cbranch_vccnz Gxm_R1
Gxm_S1:
    v_mfma_f32_16x16x32_bf16 v[116:119], v[76:79], v[164:167], v[116:119]
    s_waitcnt vmcnt(1)
    v_max3_u32 v15, v80, v81, v82
    v_max_u32 v15, v15, v83
    v_cmp_eq_u32 vcc, -1, v15
    v_mfma_f32_16x16x32_bf16 v[120:123], v[76:79], v[104:107], v[120:123]
    s_cbranch_vccnz Gxm_R2
Gxm_S2:
    v_mfma_f32_16x16x32_bf16 v[116:119], v[80:83], v[168:171], v[116:119]
    s_waitcnt vmcnt(0)
    v_max3_u32 v15, v84, v85, v86
    v_max_u32 v15, v15, v87
    v_cmp_eq_u32 vcc, -1, v15
    v_mfma_f32_16x16x32_bf16 v[120:123], v[80:83], v[108:111], v[120:123]
    s_cbranch_vccnz Gxm_R3
Gxm_S3:
    v_mfma_f32_16x16x32_bf16 v[116:119], v[84:87], v[172:175], v[116:119]
    v_mfma_f32_16x16x32_bf16 v[120:123], v[84:87], v[112:115], v[120:123]

    ds_write_b128 v12, v[88:91] offset:3328
    ds_write_b128 v12, v[92:95] offset:3392
    v_add_u32 v13, s42, v11
    v_add_u32 v14, s42, v2
    s_nop 3
    ds_write_b128 v12, v[116:119] offset:128
    ds_write_b128 v12, v[120:123] offset:3456

    s_cmp_ge_u32 s14, 62
    s_cselect_b32 s28, 0, 57344
    s_add_u32 s38, s38, s28
    s_addc_u32 s39, s39, 0
    global_load_dwordx4 v[128:131], v7, s[38:39] offset:0
    global_load_dwordx4 v[132:135], v7, s[38:39] offset:1024
    global_load_dwordx4 v[136:139], v7, s[38:39] offset:2048
    global_load_dwordx4 v[140:143], v7, s[38:39] offset:3072
    global_load_dwordx4 v[144:147], v9, s[38:39] offset:0
    global_load_dwordx4 v[148:151], v9, s[38:39] offset:1024
    global_load_dwordx4 v[152:155], v9, s[38:39] offset:2048
    s_waitcnt lgkmcnt(0)
    s_barrier
    ds_read_b128 v[72:75], v13 offset:0
    ds_read_b128 v[76:79], v13 offset:6656
    ds_read_b128 v[80:83], v13 offset:13312
    ds_read_b128 v[84:87], v13 offset:19968
    ds_read_b32 v88, v14 offset:0
    ds_read_b32 v89, v14 offset:6656
    ds_read_b32 v90, v14 offset:13312
    ds_read_b32 v91, v14 offset:19968
    v_mov_b32 v92, s43
    s_waitcnt lgkmcnt(0)
    v_add_f32 v72, v72, v76
    v_add_f32 v80, v80, v84
    v_add_f32 v72, v72, v80
    v_cndmask_b32 v72, v92, v72, s[44:45]
    v_add_f32 v73, v73, v77
    v_add_f32 v81, v81, v85
    v_add_f32 v73, v73, v81
    v_cndmask_b32 v73, v92, v73, s[46:47]
    v_add_f32 v74, v74, v78
    v_add_f32 v82, v82, v86
    v_add_f32 v74, v74, v82
    v_cndmask_b32 v74, v92, v74, s[48:49]
    v_add_f32 v75, v75, v79
    v_add_f32 v83, v83, v87
    v_add_f32 v75, v75, v83
    v_cndmask_b32 v75, v92, v75, s[50:51]

    v_add_f32 v88, v88, v89
    v_add_f32 v90, v90, v91
    v_add_f32 v88, v88, v90
    v_max3_f32 v92, v72, v73, v74
    v_max3_f32 v92, v92, v75, v88

    s_nop 1
    v_max_f32_dpp v92, v92, v92 quad_perm:[1,0,3,2] row_mask:0xf bank_mask:0xf
    s_nop 1
    v_max_f32_dpp v92, v92, v92 quad_perm:[2,3,0,1] row_mask:0xf bank_mask:0xf
    s_nop 1
    v_max_f32_dpp v92, v92, v92 row_half_mirror row_mask:0xf bank_mask:0xf
    v_sub_f32 v72, v72, v92
    v_sub_f32 v73, v73, v92
    v_sub_f32 v74, v74, v92
    v_sub_f32 v75, v75, v92
    v_sub_f32 v88, v88, v92
    v_exp_f32 v72, v72
    v_exp_f32 v73, v73
    v_exp_f32 v74, v74
    v_exp_f32 v75, v75
    v_exp_f32 v88, v88

    s_nop 0
    v_add_f32 v93, v72, v73
    v_add_f32 v94, v74, v75
    v_add_f32 v93, v93, v88
    v_add_f32 v93, v93, v94

    s_nop 1
    v_add_f32_dpp v93, v93, v93 quad_perm:[1,0,3,2] row_mask:0xf bank_mask:0xf
    s_nop 1
    v_add_f32_dpp v93, v93, v93 quad_perm:[2,3,0,1] row_mask:0xf bank_mask:0xf
    s_nop 1
    v_add_f32_dpp v93, v93, v93 row_half_mirror row_mask:0xf bank_mask:0xf
    v_rcp_f32 v93, v93
    s_nop 0
    v_mul_f32 v72, v72, v93
    v_mul_f32 v73, v73, v93
    v_mul_f32 v74, v74, v93
    v_mul_f32 v75, v75, v93
    v_mul_f32 v88, v88, v93

    v_cvt_pk_bf16_f32 v124, v72, v73
    v_cvt_pk_bf16_f32 v125, v74, v75
    v_mov_b32_dpp v89, v88 quad_perm:[1,0,3,2] row_mask:0xf bank_mask:0xf
    global_store_dwordx2 v1, v[124:125], s[18:19] sc1
    v_cvt_pk_bf16_f32 v126, v88, v89
    s_mov_b32 exec_lo, 0x55555555
    s_mov_b32 exec_hi, 0x55555555
    global_store_dword v0, v126, s[18:19] sc1
    s_mov_b64 exec, -1
    s_add_u32 s14, s14, 2
    s_cmp_ge_u32 s14, 64
    s_cbranch_scc1 M_end
    s_add_u32 s16, s16, 65536
    s_addc_u32 s17, s17, 0
    s_add_u32 s18, s18, 81920
    s_addc_u32 s19, s19, 0
    s_mov_b32 s24, s52
    s_mov_b32 s25, s53
    s_cmp_ge_u32 s14, 62
    s_cbranch_scc1 GX_noinc
    s_add_u32 s52, s52, 57344
    s_addc_u32 s53, s53, 0
GX_noinc:
    s_xor_b32 s42, s42, 26624
    s_branch GX_loop

R_UO:
    s_sleep 127
    s_sleep 127
    s_sleep 127
    s_sleep 127
    s_and_b32 s14, s26, 1
    s_lshr_b32 s26, s26, 1

    s_lshl_b32 s28, s26, 4
    s_lshl_b32 s29, s3, 2
    s_add_u32 s28, s28, s29
    s_mul_i32 s28, s28, 14336
    s_add_u32 s28, s28, 0x640000
    s_add_u32 s30, s4, s28
    s_addc_u32 s31, s5, 0
    v_lshlrev_b32 v2, 4, v1

    global_load_dwordx4 a[0:3], v2, s[30:31] offset:0
    global_load_dwordx4 a[4:7], v2, s[30:31] offset:1024
    global_load_dwordx4 a[8:11], v2, s[30:31] offset:2048
    global_load_dwordx4 a[12:15], v2, s[30:31] offset:3072
    v_add_u32 v2, 4096, v2
    global_load_dwordx4 a[16:19], v2, s[30:31] offset:0
    global_load_dwordx4 a[20:23], v2, s[30:31] offset:1024
    global_load_dwordx4 a[24:27], v2, s[30:31] offset:2048
    global_load_dwordx4 a[28:31], v2, s[30:31] offset:3072
    v_add_u32 v2, 4096, v2
    global_load_dwordx4 a[32:35], v2, s[30:31] offset:0
    global_load_dwordx4 a[36:39], v2, s[30:31] offset:1024
    global_load_dwordx4 a[40:43], v2, s[30:31] offset:2048
    global_load_dwordx4 a[44:47], v2, s[30:31] offset:3072
    v_add_u32 v2, 4096, v2
    global_load_dwordx4 a[48:51], v2, s[30:31] offset:0
    global_load_dwordx4 a[52:55], v2, s[30:31] offset:1024
    global_load_dwordx4 a[56:59], v2, s[30:31] offset:2048
    global_load_dwordx4 a[60:63], v2, s[30:31] offset:3072
    v_add_u32 v2, 4096, v2
    global_load_dwordx4 a[64:67], v2, s[30:31] offset:0
    global_load_dwordx4 a[68:71], v2, s[30:31] offset:1024
    global_load_dwordx4 a[72:75], v2, s[30:31] offset:2048
    global_load_dwordx4 a[76:79], v2, s[30:31] offset:3072
    v_add_u32 v2, 4096, v2
    global_load_dwordx4 a[80:83], v2, s[30:31] offset:0
    global_load_dwordx4 a[84:87], v2, s[30:31] offset:1024
    global_load_dwordx4 a[88:91], v2, s[30:31] offset:2048
    global_load_dwordx4 a[92:95], v2, s[30:31] offset:3072
    v_add_u32 v2, 4096, v2
    global_load_dwordx4 a[96:99], v2, s[30:31] offset:0
    global_load_dwordx4 a[100:103], v2, s[30:31] offset:1024
    global_load_dwordx4 a[104:107], v2, s[30:31] offset:2048
    global_load_dwordx4 a[108:111], v2, s[30:31] offset:3072
    v_add_u32 v2, 4096, v2
    global_load_dwordx4 a[112:115], v2, s[30:31] offset:0
    global_load_dwordx4 a[116:119], v2, s[30:31] offset:1024
    global_load_dwordx4 a[120:123], v2, s[30:31] offset:2048
    global_load_dwordx4 a[124:127], v2, s[30:31] offset:3072
    v_add_u32 v2, 4096, v2
    global_load_dwordx4 a[128:131], v2, s[30:31] offset:0
    global_load_dwordx4 a[132:135], v2, s[30:31] offset:1024
    global_load_dwordx4 a[136:139], v2, s[30:31] offset:2048
    global_load_dwordx4 a[140:143], v2, s[30:31] offset:3072
    v_add_u32 v2, 4096, v2
    global_load_dwordx4 a[144:147], v2, s[30:31] offset:0
    global_load_dwordx4 a[148:151], v2, s[30:31] offset:1024
    global_load_dwordx4 a[152:155], v2, s[30:31] offset:2048
    global_load_dwordx4 a[156:159], v2, s[30:31] offset:3072
    v_add_u32 v2, 4096, v2
    global_load_dwordx4 a[160:163], v2, s[30:31] offset:0
    global_load_dwordx4 a[164:167], v2, s[30:31] offset:1024
    global_load_dwordx4 a[168:171], v2, s[30:31] offset:2048
    global_load_dwordx4 a[172:175], v2, s[30:31] offset:3072
    v_add_u32 v2, 4096, v2
    global_load_dwordx4 a[176:179], v2, s[30:31] offset:0
    global_load_dwordx4 a[180:183], v2, s[30:31] offset:1024
    global_load_dwordx4 a[184:187], v2, s[30:31] offset:2048
    global_load_dwordx4 a[188:191], v2, s[30:31] offset:3072
    v_add_u32 v2, 4096, v2
    global_load_dwordx4 a[192:195], v2, s[30:31] offset:0
    global_load_dwordx4 a[196:199], v2, s[30:31] offset:1024
    global_load_dwordx4 a[200:203], v2, s[30:31] offset:2048
    global_load_dwordx4 a[204:207], v2, s[30:31] offset:3072
    v_add_u32 v2, 4096, v2
    global_load_dwordx4 a[208:211], v2, s[30:31] offset:0
    global_load_dwordx4 a[212:215], v2, s[30:31] offset:1024
    global_load_dwordx4 a[216:219], v2, s[30:31] offset:2048
    global_load_dwordx4 a[220:223], v2, s[30:31] offset:3072
    v_add_u32 v2, 4096, v2

    v_lshlrev_b32 v5, 4, v1
    v_and_b32 v10, 7, v1
    v_lshrrev_b32 v11, 4, v1
    v_and_b32 v12, 15, v1
    v_lshlrev_b32 v3, 4, v10
    v_lshl_add_u32 v3, v11, 7, v3
    v_add_u32 v4, 4096, v3
    v_lshlrev_b32 v6, 6, v12
    v_lshl_add_u32 v6, v11, 4, v6
    v_add_u32 v7, 2560, v6
    v_add_u32 v8, 5120, v6
    v_add_u32 v9, 7680, v6
    v_lshrrev_b32 v13, 1, v11
    v_mul_u32_u24 v10, 5120, v13
    v_lshl_add_u32 v10, v12, 4, v10
    v_and_b32 v13, 1, v11
    v_lshl_add_u32 v10, v13, 3, v10
    v_add_u32 v10, 2048, v10
    v_mul_u32_u24 v13, 528, v12
    v_lshl_add_u32 v11, v11, 4, v13
    s_lshl_b32 s28, s3, 7
    v_add_u32 v11, s28, v11
    v_lshrrev_b32 v13, 3, v0
    v_and_b32 v14, 7, v0
    v_mul_u32_u24 v12, 1056, v14
    v_lshl_add_u32 v12, v13, 2, v12
    v_mul_u32_u24 v13, 1792, v13
    v_lshl_add_u32 v13, v14, 2, v13
    s_lshl_b32 s28, s26, 5
    s_add_u32 s28, s28, 896
    v_add_u32 v13, s28, v13
    s_lshl_b32 s28, s26, 5
    s_lshl_b32 s29, s3, 3
    s_add_u32 s28, s28, s29
    s_add_u32 s28, s28, 0x1100000
    v_mov_b32 v14, s28
    s_mov_b32 s34, 0
    s_mov_b32 s35, -1
    s_mov_b32 s22, 0
    s_mov_b32 s42, 0
    s_lshl_b32 s28, s14, 15
    s_add_u32 s28, s28, 0xe82000
    s_add_u32 s16, s4, s28
    s_addc_u32 s17, s5, 0
    s_lshl_b32 s28, s14, 4
    s_lshl_b32 s29, s3, 2
    s_add_u32 s28, s28, s29
    s_mul_i32 s28, s28, 2560
    s_add_u32 s28, s28, 0x1200000
    s_add_u32 s18, s4, s28
    s_addc_u32 s19, s5, 0
    s_mul_i32 s28, s14, 57344
    s_add_u32 s38, s10, s28
    s_addc_u32 s39, s11, 0
    s_lshl_b32 s28, s26, 14
    s_lshl_b32 s29, s3, 12
    s_add_u32 s28, s28, s29
    s_mul_i32 s29, s14, 458752
    s_add_u32 s28, s28, s29
    s_add_u32 s28, s28, 0x1800000
    s_add_u32 s40, s4, s28
    s_addc_u32 s41, s5, 0

X2_loop:

    s_cmp_gt_u32 s22, s14
    s_cbranch_scc0 X2_fl
X2_flok:

    global_load_dwordx4 v[72:75], v5, s[40:41] offset:0 sc1
    global_load_dwordx4 v[76:79], v5, s[40:41] offset:1024 sc1
    global_load_dwordx4 v[80:83], v5, s[40:41] offset:2048 sc1
    global_load_dwordx4 v[84:87], v5, s[40:41] offset:3072 sc1
    global_load_dwordx4 v[16:19], v3, s[16:17] offset:0 sc1
    global_load_dwordx4 v[20:23], v3, s[16:17] offset:512 sc1
    global_load_dwordx4 v[24:27], v3, s[16:17] offset:1024 sc1
    global_load_dwordx4 v[28:31], v3, s[16:17] offset:1536 sc1
    global_load_dwordx4 v[32:35], v3, s[16:17] offset:2048 sc1
    global_load_dwordx4 v[36:39], v3, s[16:17] offset:2560 sc1
    global_load_dwordx4 v[40:43], v3, s[16:17] offset:3072 sc1
    global_load_dwordx4 v[44:47], v3, s[16:17] offset:3584 sc1
    global_load_dwordx4 v[48:51], v4, s[16:17] offset:0 sc1
    global_load_dwordx4 v[52:55], v4, s[16:17] offset:512 sc1
    global_load_dwordx4 v[56:59], v4, s[16:17] offset:1024 sc1
    global_load_dwordx4 v[60:63], v4, s[16:17] offset:1536 sc1
    global_load_dwordx4 v[64:67], v4, s[16:17] offset:2048 sc1
    global_load_dwordx4 v[68:71], v4, s[16:17] offset:2560 sc1
    global_load_dwordx4 v[176:179], v6, s[18:19] offset:0 sc1
    global_load_dwordx4 v[180:183], v7, s[18:19] offset:0 sc1
    global_load_dwordx4 v[184:187], v8, s[18:19] offset:0 sc1
    global_load_dwordx4 v[188:191], v9, s[18:19] offset:0 sc1
    global_load_dwordx2 v[192:193], v10, s[18:19] offset:0 sc1
    global_load_dwordx2 v[194:195], v10, s[18:19] offset:2560 sc1
    global_load_dwordx4 v[196:199], v6, s[18:19] offset:1024 sc1
    global_load_dwordx4 v[200:203], v7, s[18:19] offset:1024 sc1
    global_load_dwordx4 v[204:207], v8, s[18:19] offset:1024 sc1
    global_load_dwordx4 v[208:211], v9, s[18:19] offset:1024 sc1
    global_load_dwordx2 v[212:213], v10, s[18:19] offset:256 sc1
    global_load_dwordx2 v[214:215], v10, s[18:19] offset:2816 sc1
Xm_C0:
    s_waitcnt vmcnt(25)
    v_max3_u32 v15, v16, v17, v18
    v_max_u32 v15, v15, v19
    v_cmp_eq_u32 vcc, -1, v15
    s_cbranch_vccnz Xm_R0
Xm_S0:
    v_mfma_f32_16x16x32_bf16 v[128:131], v[16:19], a[0:3], 0
    s_waitcnt vmcnt(24)
    v_max3_u32 v15, v20, v21, v22
    v_max_u32 v15, v15, v23
    v_cmp_eq_u32 vcc, -1, v15
    v_mfma_f32_16x16x32_bf16 v[132:135], v[16:19], a[56:59], 0
    v_mfma_f32_16x16x32_bf16 v[136:139], v[16:19], a[112:115], 0
    v_mfma_f32_16x16x32_bf16 v[140:143], v[16:19], a[168:171], 0
    s_cbranch_vccnz Xm_R1
Xm_S1:
    v_mfma_f32_16x16x32_bf16 v[128:131], v[20:23], a[4:7], v[128:131]
    s_waitcnt vmcnt(23)
    v_max3_u32 v15, v24, v25, v26
    v_max_u32 v15, v15, v27
    v_cmp_eq_u32 vcc, -1, v15
    v_mfma_f32_16x16x32_bf16 v[132:135], v[20:23], a[60:63], v[132:135]
    v_mfma_f32_16x16x32_bf16 v[136:139], v[20:23], a[116:119], v[136:139]
    v_mfma_f32_16x16x32_bf16 v[140:143], v[20:23], a[172:175], v[140:143]
    s_cbranch_vccnz Xm_R2
Xm_S2:
    v_mfma_f32_16x16x32_bf16 v[128:131], v[24:27], a[8:11], v[128:131]
    s_waitcnt vmcnt(22)
    v_max3_u32 v15, v28, v29, v30
    v_max_u32 v15, v15, v31
    v_cmp_eq_u32 vcc, -1, v15
    v_mfma_f32_16x16x32_bf16 v[132:135], v[24:27], a[64:67], v[132:135]
    v_mfma_f32_16x16x32_bf16 v[136:139], v[24:27], a[120:123], v[136:139]
    v_mfma_f32_16x16x32_bf16 v[140:143], v[24:27], a[176:179], v[140:143]
    s_cbranch_vccnz Xm_R3
Xm_S3:
    v_mfma_f32_16x16x32_bf16 v[128:131], v[28:31], a[12:15], v[128:131]
    s_waitcnt vmcnt(21)
    v_max3_u32 v15, v32, v33, v34
    v_max_u32 v15, v15, v35
    v_cmp_eq_u32 vcc, -1, v15
    v_mfma_f32_16x16x32_bf16 v[132:135], v[28:31], a[68:71], v[132:135]
    v_mfma_f32_16x16x32_bf16 v[136:139], v[28:31], a[124:127], v[136:139]
    v_mfma_f32_16x16x32_bf16 v[140:143], v[28:31], a[180:183], v[140:143]
    s_cbranch_vccnz Xm_R4
Xm_S4:
    v_mfma_f32_16x16x32_bf16 v[128:131], v[32:35], a[16:19], v[128:131]
    s_waitcnt vmcnt(20)
    v_max3_u32 v15, v36, v37, v38
    v_max_u32 v15, v15, v39
    v_cmp_eq_u32 vcc, -1, v15
    v_mfma_f32_16x16x32_bf16 v[132:135], v[32:35], a[72:75], v[132:135]
    v_mfma_f32_16x16x32_bf16 v[136:139], v[32:35], a[128:131], v[136:139]
    v_mfma_f32_16x16x32_bf16 v[140:143], v[32:35], a[184:187], v[140:143]
    s_cbranch_vccnz Xm_R5
Xm_S5:
    v_mfma_f32_16x16x32_bf16 v[128:131], v[36:39], a[20:23], v[128:131]
    s_waitcnt vmcnt(19)
    v_max3_u32 v15, v40, v41, v42
    v_max_u32 v15, v15, v43
    v_cmp_eq_u32 vcc, -1, v15
    v_mfma_f32_16x16x32_bf16 v[132:135], v[36:39], a[76:79], v[132:135]
    v_mfma_f32_16x16x32_bf16 v[136:139], v[36:39], a[132:135], v[136:139]
    v_mfma_f32_16x16x32_bf16 v[140:143], v[36:39], a[188:191], v[140:143]
    s_cbranch_vccnz Xm_R6
Xm_S6:
    v_mfma_f32_16x16x32_bf16 v[128:131], v[40:43], a[24:27], v[128:131]
    s_waitcnt vmcnt(18)
    v_max3_u32 v15, v44, v45, v46
    v_max_u32 v15, v15, v47
    v_cmp_eq_u32 vcc, -1, v15
    v_mfma_f32_16x16x32_bf16 v[132:135], v[40:43], a[80:83], v[132:135]
    v_mfma_f32_16x16x32_bf16 v[136:139], v[40:43], a[136:139], v[136:139]
    v_mfma_f32_16x16x32_bf16 v[140:143], v[40:43], a[192:195], v[140:143]
    s_cbranch_vccnz Xm_R7
Xm_S7:
    v_mfma_f32_16x16x32_bf16 v[128:131], v[44:47], a[28:31], v[128:131]
    s_waitcnt vmcnt(17)
    v_max3_u32 v15, v48, v49, v50
    v_max_u32 v15, v15, v51
    v_cmp_eq_u32 vcc, -1, v15
    v_mfma_f32_16x16x32_bf16 v[132:135], v[44:47], a[84:87], v[132:135]
    v_mfma_f32_16x16x32_bf16 v[136:139], v[44:47], a[140:143], v[136:139]
    v_mfma_f32_16x16x32_bf16 v[140:143], v[44:47], a[196:199], v[140:143]
    s_cbranch_vccnz Xm_R8
Xm_S8:
    v_mfma_f32_16x16x32_bf16 v[128:131], v[48:51], a[32:35], v[128:131]
    s_waitcnt vmcnt(16)
    v_max3_u32 v15, v52, v53, v54
    v_max_u32 v15, v15, v55
    v_cmp_eq_u32 vcc, -1, v15
    v_mfma_f32_16x16x32_bf16 v[132:135], v[48:51], a[88:91], v[132:135]
    v_mfma_f32_16x16x32_bf16 v[136:139], v[48:51], a[144:147], v[136:139]
    v_mfma_f32_16x16x32_bf16 v[140:143], v[48:51], a[200:203], v[140:143]
    s_cbranch_vccnz Xm_R9
Xm_S9:
    v_mfma_f32_16x16x32_bf16 v[128:131], v[52:55], a[36:39], v[128:131]
    s_waitcnt vmcnt(15)
    v_max3_u32 v15, v56, v57, v58
    v_max_u32 v15, v15, v59
    v_cmp_eq_u32 vcc, -1, v15
    v_mfma_f32_16x16x32_bf16 v[132:135], v[52:55], a[92:95], v[132:135]
    v_mfma_f32_16x16x32_bf16 v[136:139], v[52:55], a[148:151], v[136:139]
    v_mfma_f32_16x16x32_bf16 v[140:143], v[52:55], a[204:207], v[140:143]
    s_cbranch_vccnz Xm_R10
Xm_S10:
    v_mfma_f32_16x16x32_bf16 v[128:131], v[56:59], a[40:43], v[128:131]
    s_waitcnt vmcnt(14)
    v_max3_u32 v15, v60, v61, v62
    v_max_u32 v15, v15, v63
    v_cmp_eq_u32 vcc, -1, v15
    v_mfma_f32_16x16x32_bf16 v[132:135], v[56:59], a[96:99], v[132:135]
    v_mfma_f32_16x16x32_bf16 v[136:139], v[56:59], a[152:155], v[136:139]
    v_mfma_f32_16x16x32_bf16 v[140:143], v[56:59], a[208:211], v[140:143]
    s_cbranch_vccnz Xm_R11
Xm_S11:
    v_mfma_f32_16x16x32_bf16 v[128:131], v[60:63], a[44:47], v[128:131]
    s_waitcnt vmcnt(13)
    v_max3_u32 v15, v64, v65, v66
    v_max_u32 v15, v15, v67
    v_cmp_eq_u32 vcc, -1, v15
    v_mfma_f32_16x16x32_bf16 v[132:135], v[60:63], a[100:103], v[132:135]
    v_mfma_f32_16x16x32_bf16 v[136:139], v[60:63], a[156:159], v[136:139]
    v_mfma_f32_16x16x32_bf16 v[140:143], v[60:63], a[212:215], v[140:143]
    s_cbranch_vccnz Xm_R12
Xm_S12:
    v_mfma_f32_16x16x32_bf16 v[128:131], v[64:67], a[48:51], v[128:131]
    s_waitcnt vmcnt(12)
    v_max3_u32 v15, v68, v69, v70
    v_max_u32 v15, v15, v71
    v_cmp_eq_u32 vcc, -1, v15
    v_mfma_f32_16x16x32_bf16 v[132:135], v[64:67], a[104:107], v[132:135]
    v_mfma_f32_16x16x32_bf16 v[136:139], v[64:67], a[160:163], v[136:139]
    v_mfma_f32_16x16x32_bf16 v[140:143], v[64:67], a[216:219], v[140:143]
    s_cbranch_vccnz Xm_R13
Xm_S13:
    v_mfma_f32_16x16x32_bf16 v[128:131], v[68:71], a[52:55], v[128:131]
    s_waitcnt vmcnt(11)
    v_max3_u32 v15, v176, v177, v178
    v_max_u32 v15, v15, v179
    v_cmp_eq_u32 vcc, -1, v15
    v_mfma_f32_16x16x32_bf16 v[132:135], v[68:71], a[108:111], v[132:135]
    v_mfma_f32_16x16x32_bf16 v[136:139], v[68:71], a[164:167], v[136:139]
    v_mfma_f32_16x16x32_bf16 v[140:143], v[68:71], a[220:223], v[140:143]
    s_nop 4
    v_cvt_pk_bf16_f32 v92, v128, v129
    v_cvt_pk_bf16_f32 v93, v130, v131
    v_cvt_pk_bf16_f32 v94, v132, v133
    v_cvt_pk_bf16_f32 v95, v134, v135
    v_cvt_pk_bf16_f32 v96, v136, v137
    v_cvt_pk_bf16_f32 v97, v138, v139
    v_cvt_pk_bf16_f32 v98, v140, v141
    v_cvt_pk_bf16_f32 v99, v142, v143
    v_cndmask_b32 v88, v92, v96, s[34:35]
    v_cndmask_b32 v89, v93, v97, s[34:35]
    v_cndmask_b32 v90, v94, v98, s[34:35]
    v_cndmask_b32 v91, v95, v99, s[34:35]
    s_cbranch_vccnz Xm_R14
Xm_S14:
    v_mfma_f32_16x16x32_bf16 v[144:147], v[176:179], v[72:75], 0
    s_waitcnt vmcnt(10)
    v_max3_u32 v15, v180, v181, v182
    v_max_u32 v15, v15, v183
    v_cmp_eq_u32 vcc, -1, v15
    s_cbranch_vccnz Xm_R15
Xm_S15:
    v_mfma_f32_16x16x32_bf16 v[144:147], v[180:183], v[76:79], v[144:147]
    s_waitcnt vmcnt(9)
    v_max3_u32 v15, v184, v185, v186
    v_max_u32 v15, v15, v187
    v_cmp_eq_u32 vcc, -1, v15
    s_cbranch_vccnz Xm_R16
Xm_S16:
    v_mfma_f32_16x16x32_bf16 v[144:147], v[184:187], v[80:83], v[144:147]
    s_waitcnt vmcnt(8)
    v_max3_u32 v15, v188, v189, v190
    v_max_u32 v15, v15, v191
    v_cmp_eq_u32 vcc, -1, v15
    s_cbranch_vccnz Xm_R17
Xm_S17:
    v_mfma_f32_16x16x32_bf16 v[144:147], v[188:191], v[84:87], v[144:147]
    s_waitcnt vmcnt(6)
    v_max3_u32 v15, v192, v193, v194
    v_max_u32 v15, v15, v195
    v_cmp_eq_u32 vcc, -1, v15
    s_cbranch_vccnz Xm_R18
Xm_S18:
    v_mfma_f32_16x16x32_bf16 v[144:147], v[192:195], v[88:91], v[144:147]
    s_waitcnt vmcnt(5)
    v_max3_u32 v15, v196, v197, v198
    v_max_u32 v15, v15, v199
    v_cmp_eq_u32 vcc, -1, v15
    s_cbranch_vccnz Xm_R19
Xm_S19:
    v_mfma_f32_16x16x32_bf16 v[148:151], v[196:199], v[72:75], 0
    s_waitcnt vmcnt(4)
    v_max3_u32 v15, v200, v201, v202
    v_max_u32 v15, v15, v203
    v_cmp_eq_u32 vcc, -1, v15
    s_cbranch_vccnz Xm_R20
Xm_S20:
    v_mfma_f32_16x16x32_bf16 v[148:151], v[200:203], v[76:79], v[148:151]
    s_waitcnt vmcnt(3)
    v_max3_u32 v15, v204, v205, v206
    v_max_u32 v15, v15, v207
    v_cmp_eq_u32 vcc, -1, v15
    s_cbranch_vccnz Xm_R21
Xm_S21:
    v_mfma_f32_16x16x32_bf16 v[148:151], v[204:207], v[80:83], v[148:151]
    s_waitcnt vmcnt(2)
    v_max3_u32 v15, v208, v209, v210
    v_max_u32 v15, v15, v211
    v_cmp_eq_u32 vcc, -1, v15
    s_cbranch_vccnz Xm_R22
Xm_S22:
    v_mfma_f32_16x16x32_bf16 v[148:151], v[208:211], v[84:87], v[148:151]
    s_waitcnt vmcnt(0)
    v_max3_u32 v15, v212, v213, v214
    v_max_u32 v15, v15, v215
    v_cmp_eq_u32 vcc, -1, v15
    s_cbranch_vccnz Xm_R23
Xm_S23:
    v_mfma_f32_16x16x32_bf16 v[148:151], v[212:215], v[88:91], v[148:151]

    v_add_u32 v60, s42, v11
    v_add_u32 v61, s42, v12
    s_nop 6
    ds_write_b128 v60, v[144:147]
    ds_write_b128 v60, v[148:151] offset:64
    s_waitcnt lgkmcnt(0)
    s_barrier

    ds_read2_b32 v[62:63], v61 offset0:0 offset1:132
    ds_read2_b32 v[64:65], v61 offset0:32 offset1:164
    ds_read2_b32 v[66:67], v61 offset0:64 offset1:196
    ds_read2_b32 v[68:69], v61 offset0:96 offset1:228

    s_waitcnt lgkmcnt(0)
    v_add_f32 v62, v62, v64
    v_add_f32 v63, v63, v65
    v_add_f32 v66, v66, v68
    v_add_f32 v67, v67, v69
    v_add_f32 v62, v62, v66
    v_add_f32 v63, v63, v67
    v_cvt_pk_bf16_f32 v100, v62, v63
    global_store_dword v13, v100, s[38:39]
    s_add_u32 s14, s14, 2
    s_cmp_ge_u32 s14, 64
    s_cbranch_scc1 M_end
    s_add_u32 s16, s16, 65536
    s_addc_u32 s17, s17, 0
    s_add_u32 s18, s18, 81920
    s_addc_u32 s19, s19, 0
    s_add_u32 s38, s38, 114688
    s_addc_u32 s39, s39, 0
    s_add_u32 s40, s40, 917504
    s_addc_u32 s41, s41, 0
    s_xor_b32 s42, s42, 8448
    s_branch X2_loop

R_A:
    s_sleep 127
    s_sleep 127
    s_sleep 127
    s_sleep 127
    s_sleep 127

    s_load_dwordx4 s[80:83], s[0:1], 8
    s_load_dwordx2 s[84:85], s[0:1], 24
    v_and_b32 v3, 15, v1
    v_lshrrev_b32 v4, 4, v1
    s_lshl_b32 s46, s26, 2
    s_add_u32 s46, s46, s3
    s_waitcnt lgkmcnt(0)
A0_loop:
    s_cmp_ge_u32 s46, 896
    s_cbranch_scc1 A0_notqk
    s_mov_b32 s27, s46
    s_cmp_ge_u32 s27, 448
    s_cselect_b32 s28, 1, 0
    s_mul_i32 s29, s28, 448
    s_sub_u32 s29, s27, s29
    s_mov_b32 s40, 0x12492493
    s_mul_hi_u32 s30, s29, s40
    s_mul_i32 s31, s30, 14
    s_sub_u32 s31, s29, s31
    s_lshr_b32 s32, s30, 1
    s_and_b32 s33, s30, 1
    s_lshl_b32 s34, s33, 4
    v_add_u32 v5, s34, v3
    v_min_u32 v6, 27, v5
    s_mul_i32 s35, s32, 1568
    v_lshl_add_u32 v6, v6, 1, s35

    global_load_ushort v16, v6, s[82:83] offset:0
    global_load_ushort v17, v6, s[82:83] offset:56
    global_load_ushort v18, v6, s[82:83] offset:112
    global_load_ushort v19, v6, s[82:83] offset:168
    global_load_ushort v20, v6, s[82:83] offset:224
    global_load_ushort v21, v6, s[82:83] offset:280
    global_load_ushort v22, v6, s[82:83] offset:336
    global_load_ushort v23, v6, s[82:83] offset:392
    global_load_ushort v24, v6, s[82:83] offset:448
    global_load_ushort v25, v6, s[82:83] offset:504
    global_load_ushort v26, v6, s[82:83] offset:560
    global_load_ushort v27, v6, s[82:83] offset:616
    global_load_ushort v28, v6, s[82:83] offset:672
    global_load_ushort v29, v6, s[82:83] offset:728
    global_load_ushort v30, v6, s[82:83] offset:784
    global_load_ushort v31, v6, s[82:83] offset:840
    global_load_ushort v32, v6, s[82:83] offset:896
    global_load_ushort v33, v6, s[82:83] offset:952
    global_load_ushort v34, v6, s[82:83] offset:1008
    global_load_ushort v35, v6, s[82:83] offset:1064
    global_load_ushort v36, v6, s[82:83] offset:1120
    global_load_ushort v37, v6, s[82:83] offset:1176
    global_load_ushort v38, v6, s[82:83] offset:1232
    global_load_ushort v39, v6, s[82:83] offset:1288
    global_load_ushort v40, v6, s[82:83] offset:1344
    global_load_ushort v41, v6, s[82:83] offset:1400
    global_load_ushort v42, v6, s[82:83] offset:1456
    global_load_ushort v43, v6, s[82:83] offset:1512

    s_lshl_b32 s36, s31, 5
    v_lshl_add_u32 v7, v4, 3, s36
    v_mul_u32_u24 v7, 2688, v7
    s_mul_i32 s37, s28, 896
    s_mul_i32 s38, s32, 56
    s_add_u32 s37, s37, s38
    v_add_u32 v7, s37, v7
    s_waitcnt vmcnt(0)

    v_lshlrev_b32 v16, 16, v16
    v_lshlrev_b32 v17, 16, v17
    v_lshlrev_b32 v18, 16, v18
    v_lshlrev_b32 v19, 16, v19
    v_lshlrev_b32 v20, 16, v20
    v_lshlrev_b32 v21, 16, v21
    v_lshlrev_b32 v22, 16, v22
    v_lshlrev_b32 v23, 16, v23
    v_lshlrev_b32 v24, 16, v24
    v_lshlrev_b32 v25, 16, v25
    v_lshlrev_b32 v26, 16, v26
    v_lshlrev_b32 v27, 16, v27
    v_lshlrev_b32 v28, 16, v28
    v_lshlrev_b32 v29, 16, v29
    v_lshlrev_b32 v30, 16, v30
    v_lshlrev_b32 v31, 16, v31
    v_lshlrev_b32 v32, 16, v32
    v_lshlrev_b32 v33, 16, v33
    v_lshlrev_b32 v34, 16, v34
    v_lshlrev_b32 v35, 16, v35
    v_lshlrev_b32 v36, 16, v36
    v_lshlrev_b32 v37, 16, v37
    v_lshlrev_b32 v38, 16, v38
    v_lshlrev_b32 v39, 16, v39
    v_lshlrev_b32 v40, 16, v40
    v_lshlrev_b32 v41, 16, v41
    v_lshlrev_b32 v42, 16, v42
    v_lshlrev_b32 v43, 16, v43
    global_load_dwordx2 v[48:49], v7, s[80:81] offset:0
    global_load_dwordx2 v[50:51], v7, s[80:81] offset:8
    global_load_dwordx2 v[52:53], v7, s[80:81] offset:16
    global_load_dwordx2 v[54:55], v7, s[80:81] offset:24
    global_load_dwordx2 v[56:57], v7, s[80:81] offset:32
    global_load_dwordx2 v[58:59], v7, s[80:81] offset:40
    global_load_dwordx2 v[60:61], v7, s[80:81] offset:48
    v_add_u32 v7, 2688, v7
    v_mov_b32 v64, 0
    s_waitcnt vmcnt(0)
    v_lshlrev_b32 v72, 16, v48
    v_and_b32 v73, 0xffff0000, v48
    v_fmac_f32 v64, v72, v16
    v_fmac_f32 v64, v73, v17
    v_lshlrev_b32 v72, 16, v49
    v_and_b32 v73, 0xffff0000, v49
    v_fmac_f32 v64, v72, v18
    v_fmac_f32 v64, v73, v19
    v_lshlrev_b32 v72, 16, v50
    v_and_b32 v73, 0xffff0000, v50
    v_fmac_f32 v64, v72, v20
    v_fmac_f32 v64, v73, v21
    v_lshlrev_b32 v72, 16, v51
    v_and_b32 v73, 0xffff0000, v51
    v_fmac_f32 v64, v72, v22
    v_fmac_f32 v64, v73, v23
    v_lshlrev_b32 v72, 16, v52
    v_and_b32 v73, 0xffff0000, v52
    v_fmac_f32 v64, v72, v24
    v_fmac_f32 v64, v73, v25
    v_lshlrev_b32 v72, 16, v53
    v_and_b32 v73, 0xffff0000, v53
    v_fmac_f32 v64, v72, v26
    v_fmac_f32 v64, v73, v27
    v_lshlrev_b32 v72, 16, v54
    v_and_b32 v73, 0xffff0000, v54
    v_fmac_f32 v64, v72, v28
    v_fmac_f32 v64, v73, v29
    v_lshlrev_b32 v72, 16, v55
    v_and_b32 v73, 0xffff0000, v55
    v_fmac_f32 v64, v72, v30
    v_fmac_f32 v64, v73, v31
    v_lshlrev_b32 v72, 16, v56
    v_and_b32 v73, 0xffff0000, v56
    v_fmac_f32 v64, v72, v32
    v_fmac_f32 v64, v73, v33
    v_lshlrev_b32 v72, 16, v57
    v_and_b32 v73, 0xffff0000, v57
    v_fmac_f32 v64, v72, v34
    v_fmac_f32 v64, v73, v35
    v_lshlrev_b32 v72, 16, v58
    v_and_b32 v73, 0xffff0000, v58
    v_fmac_f32 v64, v72, v36
    v_fmac_f32 v64, v73, v37
    v_lshlrev_b32 v72, 16, v59
    v_and_b32 v73, 0xffff0000, v59
    v_fmac_f32 v64, v72, v38
    v_fmac_f32 v64, v73, v39
    v_lshlrev_b32 v72, 16, v60
    v_and_b32 v73, 0xffff0000, v60
    v_fmac_f32 v64, v72, v40
    v_fmac_f32 v64, v73, v41
    v_lshlrev_b32 v72, 16, v61
    v_and_b32 v73, 0xffff0000, v61
    v_fmac_f32 v64, v72, v42
    v_fmac_f32 v64, v73, v43
    global_load_dwordx2 v[48:49], v7, s[80:81] offset:0
    global_load_dwordx2 v[50:51], v7, s[80:81] offset:8
    global_load_dwordx2 v[52:53], v7, s[80:81] offset:16
    global_load_dwordx2 v[54:55], v7, s[80:81] offset:24
    global_load_dwordx2 v[56:57], v7, s[80:81] offset:32
    global_load_dwordx2 v[58:59], v7, s[80:81] offset:40
    global_load_dwordx2 v[60:61], v7, s[80:81] offset:48
    v_add_u32 v7, 2688, v7
    v_mov_b32 v65, 0
    s_waitcnt vmcnt(0)
    v_lshlrev_b32 v72, 16, v48
    v_and_b32 v73, 0xffff0000, v48
    v_fmac_f32 v65, v72, v16
    v_fmac_f32 v65, v73, v17
    v_lshlrev_b32 v72, 16, v49
    v_and_b32 v73, 0xffff0000, v49
    v_fmac_f32 v65, v72, v18
    v_fmac_f32 v65, v73, v19
    v_lshlrev_b32 v72, 16, v50
    v_and_b32 v73, 0xffff0000, v50
    v_fmac_f32 v65, v72, v20
    v_fmac_f32 v65, v73, v21
    v_lshlrev_b32 v72, 16, v51
    v_and_b32 v73, 0xffff0000, v51
    v_fmac_f32 v65, v72, v22
    v_fmac_f32 v65, v73, v23
    v_lshlrev_b32 v72, 16, v52
    v_and_b32 v73, 0xffff0000, v52
    v_fmac_f32 v65, v72, v24
    v_fmac_f32 v65, v73, v25
    v_lshlrev_b32 v72, 16, v53
    v_and_b32 v73, 0xffff0000, v53
    v_fmac_f32 v65, v72, v26
    v_fmac_f32 v65, v73, v27
    v_lshlrev_b32 v72, 16, v54
    v_and_b32 v73, 0xffff0000, v54
    v_fmac_f32 v65, v72, v28
    v_fmac_f32 v65, v73, v29
    v_lshlrev_b32 v72, 16, v55
    v_and_b32 v73, 0xffff0000, v55
    v_fmac_f32 v65, v72, v30
    v_fmac_f32 v65, v73, v31
    v_lshlrev_b32 v72, 16, v56
    v_and_b32 v73, 0xffff0000, v56
    v_fmac_f32 v65, v72, v32
    v_fmac_f32 v65, v73, v33
    v_lshlrev_b32 v72, 16, v57
    v_and_b32 v73, 0xffff0000, v57
    v_fmac_f32 v65, v72, v34
    v_fmac_f32 v65, v73, v35
    v_lshlrev_b32 v72, 16, v58
    v_and_b32 v73, 0xffff0000, v58
    v_fmac_f32 v65, v72, v36
    v_fmac_f32 v65, v73, v37
    v_lshlrev_b32 v72, 16, v59
    v_and_b32 v73, 0xffff0000, v59
    v_fmac_f32 v65, v72, v38
    v_fmac_f32 v65, v73, v39
    v_lshlrev_b32 v72, 16, v60
    v_and_b32 v73, 0xffff0000, v60
    v_fmac_f32 v65, v72, v40
    v_fmac_f32 v65, v73, v41
    v_lshlrev_b32 v72, 16, v61
    v_and_b32 v73, 0xffff0000, v61
    v_fmac_f32 v65, v72, v42
    v_fmac_f32 v65, v73, v43
    global_load_dwordx2 v[48:49], v7, s[80:81] offset:0
    global_load_dwordx2 v[50:51], v7, s[80:81] offset:8
    global_load_dwordx2 v[52:53], v7, s[80:81] offset:16
    global_load_dwordx2 v[54:55], v7, s[80:81] offset:24
    global_load_dwordx2 v[56:57], v7, s[80:81] offset:32
    global_load_dwordx2 v[58:59], v7, s[80:81] offset:40
    global_load_dwordx2 v[60:61], v7, s[80:81] offset:48
    v_add_u32 v7, 2688, v7
    v_mov_b32 v66, 0
    s_waitcnt vmcnt(0)
    v_lshlrev_b32 v72, 16, v48
    v_and_b32 v73, 0xffff0000, v48
    v_fmac_f32 v66, v72, v16
    v_fmac_f32 v66, v73, v17
    v_lshlrev_b32 v72, 16, v49
    v_and_b32 v73, 0xffff0000, v49
    v_fmac_f32 v66, v72, v18
    v_fmac_f32 v66, v73, v19
    v_lshlrev_b32 v72, 16, v50
    v_and_b32 v73, 0xffff0000, v50
    v_fmac_f32 v66, v72, v20
    v_fmac_f32 v66, v73, v21
    v_lshlrev_b32 v72, 16, v51
    v_and_b32 v73, 0xffff0000, v51
    v_fmac_f32 v66, v72, v22
    v_fmac_f32 v66, v73, v23
    v_lshlrev_b32 v72, 16, v52
    v_and_b32 v73, 0xffff0000, v52
    v_fmac_f32 v66, v72, v24
    v_fmac_f32 v66, v73, v25
    v_lshlrev_b32 v72, 16, v53
    v_and_b32 v73, 0xffff0000, v53
    v_fmac_f32 v66, v72, v26
    v_fmac_f32 v66, v73, v27
    v_lshlrev_b32 v72, 16, v54
    v_and_b32 v73, 0xffff0000, v54
    v_fmac_f32 v66, v72, v28
    v_fmac_f32 v66, v73, v29
    v_lshlrev_b32 v72, 16, v55
    v_and_b32 v73, 0xffff0000, v55
    v_fmac_f32 v66, v72, v30
    v_fmac_f32 v66, v73, v31
    v_lshlrev_b32 v72, 16, v56
    v_and_b32 v73, 0xffff0000, v56
    v_fmac_f32 v66, v72, v32
    v_fmac_f32 v66, v73, v33
    v_lshlrev_b32 v72, 16, v57
    v_and_b32 v73, 0xffff0000, v57
    v_fmac_f32 v66, v72, v34
    v_fmac_f32 v66, v73, v35
    v_lshlrev_b32 v72, 16, v58
    v_and_b32 v73, 0xffff0000, v58
    v_fmac_f32 v66, v72, v36
    v_fmac_f32 v66, v73, v37
    v_lshlrev_b32 v72, 16, v59
    v_and_b32 v73, 0xffff0000, v59
    v_fmac_f32 v66, v72, v38
    v_fmac_f32 v66, v73, v39
    v_lshlrev_b32 v72, 16, v60
    v_and_b32 v73, 0xffff0000, v60
    v_fmac_f32 v66, v72, v40
    v_fmac_f32 v66, v73, v41
    v_lshlrev_b32 v72, 16, v61
    v_and_b32 v73, 0xffff0000, v61
    v_fmac_f32 v66, v72, v42
    v_fmac_f32 v66, v73, v43
    global_load_dwordx2 v[48:49], v7, s[80:81] offset:0
    global_load_dwordx2 v[50:51], v7, s[80:81] offset:8
    global_load_dwordx2 v[52:53], v7, s[80:81] offset:16
    global_load_dwordx2 v[54:55], v7, s[80:81] offset:24
    global_load_dwordx2 v[56:57], v7, s[80:81] offset:32
    global_load_dwordx2 v[58:59], v7, s[80:81] offset:40
    global_load_dwordx2 v[60:61], v7, s[80:81] offset:48
    v_add_u32 v7, 2688, v7
    v_mov_b32 v67, 0
    s_waitcnt vmcnt(0)
    v_lshlrev_b32 v72, 16, v48
    v_and_b32 v73, 0xffff0000, v48
    v_fmac_f32 v67, v72, v16
    v_fmac_f32 v67, v73, v17
    v_lshlrev_b32 v72, 16, v49
    v_and_b32 v73, 0xffff0000, v49
    v_fmac_f32 v67, v72, v18
    v_fmac_f32 v67, v73, v19
    v_lshlrev_b32 v72, 16, v50
    v_and_b32 v73, 0xffff0000, v50
    v_fmac_f32 v67, v72, v20
    v_fmac_f32 v67, v73, v21
    v_lshlrev_b32 v72, 16, v51
    v_and_b32 v73, 0xffff0000, v51
    v_fmac_f32 v67, v72, v22
    v_fmac_f32 v67, v73, v23
    v_lshlrev_b32 v72, 16, v52
    v_and_b32 v73, 0xffff0000, v52
    v_fmac_f32 v67, v72, v24
    v_fmac_f32 v67, v73, v25
    v_lshlrev_b32 v72, 16, v53
    v_and_b32 v73, 0xffff0000, v53
    v_fmac_f32 v67, v72, v26
    v_fmac_f32 v67, v73, v27
    v_lshlrev_b32 v72, 16, v54
    v_and_b32 v73, 0xffff0000, v54
    v_fmac_f32 v67, v72, v28
    v_fmac_f32 v67, v73, v29
    v_lshlrev_b32 v72, 16, v55
    v_and_b32 v73, 0xffff0000, v55
    v_fmac_f32 v67, v72, v30
    v_fmac_f32 v67, v73, v31
    v_lshlrev_b32 v72, 16, v56
    v_and_b32 v73, 0xffff0000, v56
    v_fmac_f32 v67, v72, v32
    v_fmac_f32 v67, v73, v33
    v_lshlrev_b32 v72, 16, v57
    v_and_b32 v73, 0xffff0000, v57
    v_fmac_f32 v67, v72, v34
    v_fmac_f32 v67, v73, v35
    v_lshlrev_b32 v72, 16, v58
    v_and_b32 v73, 0xffff0000, v58
    v_fmac_f32 v67, v72, v36
    v_fmac_f32 v67, v73, v37
    v_lshlrev_b32 v72, 16, v59
    v_and_b32 v73, 0xffff0000, v59
    v_fmac_f32 v67, v72, v38
    v_fmac_f32 v67, v73, v39
    v_lshlrev_b32 v72, 16, v60
    v_and_b32 v73, 0xffff0000, v60
    v_fmac_f32 v67, v72, v40
    v_fmac_f32 v67, v73, v41
    v_lshlrev_b32 v72, 16, v61
    v_and_b32 v73, 0xffff0000, v61
    v_fmac_f32 v67, v72, v42
    v_fmac_f32 v67, v73, v43
    global_load_dwordx2 v[48:49], v7, s[80:81] offset:0
    global_load_dwordx2 v[50:51], v7, s[80:81] offset:8
    global_load_dwordx2 v[52:53], v7, s[80:81] offset:16
    global_load_dwordx2 v[54:55], v7, s[80:81] offset:24
    global_load_dwordx2 v[56:57], v7, s[80:81] offset:32
    global_load_dwordx2 v[58:59], v7, s[80:81] offset:40
    global_load_dwordx2 v[60:61], v7, s[80:81] offset:48
    v_add_u32 v7, 2688, v7
    v_mov_b32 v68, 0
    s_waitcnt vmcnt(0)
    v_lshlrev_b32 v72, 16, v48
    v_and_b32 v73, 0xffff0000, v48
    v_fmac_f32 v68, v72, v16
    v_fmac_f32 v68, v73, v17
    v_lshlrev_b32 v72, 16, v49
    v_and_b32 v73, 0xffff0000, v49
    v_fmac_f32 v68, v72, v18
    v_fmac_f32 v68, v73, v19
    v_lshlrev_b32 v72, 16, v50
    v_and_b32 v73, 0xffff0000, v50
    v_fmac_f32 v68, v72, v20
    v_fmac_f32 v68, v73, v21
    v_lshlrev_b32 v72, 16, v51
    v_and_b32 v73, 0xffff0000, v51
    v_fmac_f32 v68, v72, v22
    v_fmac_f32 v68, v73, v23
    v_lshlrev_b32 v72, 16, v52
    v_and_b32 v73, 0xffff0000, v52
    v_fmac_f32 v68, v72, v24
    v_fmac_f32 v68, v73, v25
    v_lshlrev_b32 v72, 16, v53
    v_and_b32 v73, 0xffff0000, v53
    v_fmac_f32 v68, v72, v26
    v_fmac_f32 v68, v73, v27
    v_lshlrev_b32 v72, 16, v54
    v_and_b32 v73, 0xffff0000, v54
    v_fmac_f32 v68, v72, v28
    v_fmac_f32 v68, v73, v29
    v_lshlrev_b32 v72, 16, v55
    v_and_b32 v73, 0xffff0000, v55
    v_fmac_f32 v68, v72, v30
    v_fmac_f32 v68, v73, v31
    v_lshlrev_b32 v72, 16, v56
    v_and_b32 v73, 0xffff0000, v56
    v_fmac_f32 v68, v72, v32
    v_fmac_f32 v68, v73, v33
    v_lshlrev_b32 v72, 16, v57
    v_and_b32 v73, 0xffff0000, v57
    v_fmac_f32 v68, v72, v34
    v_fmac_f32 v68, v73, v35
    v_lshlrev_b32 v72, 16, v58
    v_and_b32 v73, 0xffff0000, v58
    v_fmac_f32 v68, v72, v36
    v_fmac_f32 v68, v73, v37
    v_lshlrev_b32 v72, 16, v59
    v_and_b32 v73, 0xffff0000, v59
    v_fmac_f32 v68, v72, v38
    v_fmac_f32 v68, v73, v39
    v_lshlrev_b32 v72, 16, v60
    v_and_b32 v73, 0xffff0000, v60
    v_fmac_f32 v68, v72, v40
    v_fmac_f32 v68, v73, v41
    v_lshlrev_b32 v72, 16, v61
    v_and_b32 v73, 0xffff0000, v61
    v_fmac_f32 v68, v72, v42
    v_fmac_f32 v68, v73, v43
    global_load_dwordx2 v[48:49], v7, s[80:81] offset:0
    global_load_dwordx2 v[50:51], v7, s[80:81] offset:8
    global_load_dwordx2 v[52:53], v7, s[80:81] offset:16
    global_load_dwordx2 v[54:55], v7, s[80:81] offset:24
    global_load_dwordx2 v[56:57], v7, s[80:81] offset:32
    global_load_dwordx2 v[58:59], v7, s[80:81] offset:40
    global_load_dwordx2 v[60:61], v7, s[80:81] offset:48
    v_add_u32 v7, 2688, v7
    v_mov_b32 v69, 0
    s_waitcnt vmcnt(0)
    v_lshlrev_b32 v72, 16, v48
    v_and_b32 v73, 0xffff0000, v48
    v_fmac_f32 v69, v72, v16
    v_fmac_f32 v69, v73, v17
    v_lshlrev_b32 v72, 16, v49
    v_and_b32 v73, 0xffff0000, v49
    v_fmac_f32 v69, v72, v18
    v_fmac_f32 v69, v73, v19
    v_lshlrev_b32 v72, 16, v50
    v_and_b32 v73, 0xffff0000, v50
    v_fmac_f32 v69, v72, v20
    v_fmac_f32 v69, v73, v21
    v_lshlrev_b32 v72, 16, v51
    v_and_b32 v73, 0xffff0000, v51
    v_fmac_f32 v69, v72, v22
    v_fmac_f32 v69, v73, v23
    v_lshlrev_b32 v72, 16, v52
    v_and_b32 v73, 0xffff0000, v52
    v_fmac_f32 v69, v72, v24
    v_fmac_f32 v69, v73, v25
    v_lshlrev_b32 v72, 16, v53
    v_and_b32 v73, 0xffff0000, v53
    v_fmac_f32 v69, v72, v26
    v_fmac_f32 v69, v73, v27
    v_lshlrev_b32 v72, 16, v54
    v_and_b32 v73, 0xffff0000, v54
    v_fmac_f32 v69, v72, v28
    v_fmac_f32 v69, v73, v29
    v_lshlrev_b32 v72, 16, v55
    v_and_b32 v73, 0xffff0000, v55
    v_fmac_f32 v69, v72, v30
    v_fmac_f32 v69, v73, v31
    v_lshlrev_b32 v72, 16, v56
    v_and_b32 v73, 0xffff0000, v56
    v_fmac_f32 v69, v72, v32
    v_fmac_f32 v69, v73, v33
    v_lshlrev_b32 v72, 16, v57
    v_and_b32 v73, 0xffff0000, v57
    v_fmac_f32 v69, v72, v34
    v_fmac_f32 v69, v73, v35
    v_lshlrev_b32 v72, 16, v58
    v_and_b32 v73, 0xffff0000, v58
    v_fmac_f32 v69, v72, v36
    v_fmac_f32 v69, v73, v37
    v_lshlrev_b32 v72, 16, v59
    v_and_b32 v73, 0xffff0000, v59
    v_fmac_f32 v69, v72, v38
    v_fmac_f32 v69, v73, v39
    v_lshlrev_b32 v72, 16, v60
    v_and_b32 v73, 0xffff0000, v60
    v_fmac_f32 v69, v72, v40
    v_fmac_f32 v69, v73, v41
    v_lshlrev_b32 v72, 16, v61
    v_and_b32 v73, 0xffff0000, v61
    v_fmac_f32 v69, v72, v42
    v_fmac_f32 v69, v73, v43
    global_load_dwordx2 v[48:49], v7, s[80:81] offset:0
    global_load_dwordx2 v[50:51], v7, s[80:81] offset:8
    global_load_dwordx2 v[52:53], v7, s[80:81] offset:16
    global_load_dwordx2 v[54:55], v7, s[80:81] offset:24
    global_load_dwordx2 v[56:57], v7, s[80:81] offset:32
    global_load_dwordx2 v[58:59], v7, s[80:81] offset:40
    global_load_dwordx2 v[60:61], v7, s[80:81] offset:48
    v_add_u32 v7, 2688, v7
    v_mov_b32 v70, 0
    s_waitcnt vmcnt(0)
    v_lshlrev_b32 v72, 16, v48
    v_and_b32 v73, 0xffff0000, v48
    v_fmac_f32 v70, v72, v16
    v_fmac_f32 v70, v73, v17
    v_lshlrev_b32 v72, 16, v49
    v_and_b32 v73, 0xffff0000, v49
    v_fmac_f32 v70, v72, v18
    v_fmac_f32 v70, v73, v19
    v_lshlrev_b32 v72, 16, v50
    v_and_b32 v73, 0xffff0000, v50
    v_fmac_f32 v70, v72, v20
    v_fmac_f32 v70, v73, v21
    v_lshlrev_b32 v72, 16, v51
    v_and_b32 v73, 0xffff0000, v51
    v_fmac_f32 v70, v72, v22
    v_fmac_f32 v70, v73, v23
    v_lshlrev_b32 v72, 16, v52
    v_and_b32 v73, 0xffff0000, v52
    v_fmac_f32 v70, v72, v24
    v_fmac_f32 v70, v73, v25
    v_lshlrev_b32 v72, 16, v53
    v_and_b32 v73, 0xffff0000, v53
    v_fmac_f32 v70, v72, v26
    v_fmac_f32 v70, v73, v27
    v_lshlrev_b32 v72, 16, v54
    v_and_b32 v73, 0xffff0000, v54
    v_fmac_f32 v70, v72, v28
    v_fmac_f32 v70, v73, v29
    v_lshlrev_b32 v72, 16, v55
    v_and_b32 v73, 0xffff0000, v55
    v_fmac_f32 v70, v72, v30
    v_fmac_f32 v70, v73, v31
    v_lshlrev_b32 v72, 16, v56
    v_and_b32 v73, 0xffff0000, v56
    v_fmac_f32 v70, v72, v32
    v_fmac_f32 v70, v73, v33
    v_lshlrev_b32 v72, 16, v57
    v_and_b32 v73, 0xffff0000, v57
    v_fmac_f32 v70, v72, v34
    v_fmac_f32 v70, v73, v35
    v_lshlrev_b32 v72, 16, v58
    v_and_b32 v73, 0xffff0000, v58
    v_fmac_f32 v70, v72, v36
    v_fmac_f32 v70, v73, v37
    v_lshlrev_b32 v72, 16, v59
    v_and_b32 v73, 0xffff0000, v59
    v_fmac_f32 v70, v72, v38
    v_fmac_f32 v70, v73, v39
    v_lshlrev_b32 v72, 16, v60
    v_and_b32 v73, 0xffff0000, v60
    v_fmac_f32 v70, v72, v40
    v_fmac_f32 v70, v73, v41
    v_lshlrev_b32 v72, 16, v61
    v_and_b32 v73, 0xffff0000, v61
    v_fmac_f32 v70, v72, v42
    v_fmac_f32 v70, v73, v43
    global_load_dwordx2 v[48:49], v7, s[80:81] offset:0
    global_load_dwordx2 v[50:51], v7, s[80:81] offset:8
    global_load_dwordx2 v[52:53], v7, s[80:81] offset:16
    global_load_dwordx2 v[54:55], v7, s[80:81] offset:24
    global_load_dwordx2 v[56:57], v7, s[80:81] offset:32
    global_load_dwordx2 v[58:59], v7, s[80:81] offset:40
    global_load_dwordx2 v[60:61], v7, s[80:81] offset:48
    v_add_u32 v7, 2688, v7
    v_mov_b32 v71, 0
    s_waitcnt vmcnt(0)
    v_lshlrev_b32 v72, 16, v48
    v_and_b32 v73, 0xffff0000, v48
    v_fmac_f32 v71, v72, v16
    v_fmac_f32 v71, v73, v17
    v_lshlrev_b32 v72, 16, v49
    v_and_b32 v73, 0xffff0000, v49
    v_fmac_f32 v71, v72, v18
    v_fmac_f32 v71, v73, v19
    v_lshlrev_b32 v72, 16, v50
    v_and_b32 v73, 0xffff0000, v50
    v_fmac_f32 v71, v72, v20
    v_fmac_f32 v71, v73, v21
    v_lshlrev_b32 v72, 16, v51
    v_and_b32 v73, 0xffff0000, v51
    v_fmac_f32 v71, v72, v22
    v_fmac_f32 v71, v73, v23
    v_lshlrev_b32 v72, 16, v52
    v_and_b32 v73, 0xffff0000, v52
    v_fmac_f32 v71, v72, v24
    v_fmac_f32 v71, v73, v25
    v_lshlrev_b32 v72, 16, v53
    v_and_b32 v73, 0xffff0000, v53
    v_fmac_f32 v71, v72, v26
    v_fmac_f32 v71, v73, v27
    v_lshlrev_b32 v72, 16, v54
    v_and_b32 v73, 0xffff0000, v54
    v_fmac_f32 v71, v72, v28
    v_fmac_f32 v71, v73, v29
    v_lshlrev_b32 v72, 16, v55
    v_and_b32 v73, 0xffff0000, v55
    v_fmac_f32 v71, v72, v30
    v_fmac_f32 v71, v73, v31
    v_lshlrev_b32 v72, 16, v56
    v_and_b32 v73, 0xffff0000, v56
    v_fmac_f32 v71, v72, v32
    v_fmac_f32 v71, v73, v33
    v_lshlrev_b32 v72, 16, v57
    v_and_b32 v73, 0xffff0000, v57
    v_fmac_f32 v71, v72, v34
    v_fmac_f32 v71, v73, v35
    v_lshlrev_b32 v72, 16, v58
    v_and_b32 v73, 0xffff0000, v58
    v_fmac_f32 v71, v72, v36
    v_fmac_f32 v71, v73, v37
    v_lshlrev_b32 v72, 16, v59
    v_and_b32 v73, 0xffff0000, v59
    v_fmac_f32 v71, v72, v38
    v_fmac_f32 v71, v73, v39
    v_lshlrev_b32 v72, 16, v60
    v_and_b32 v73, 0xffff0000, v60
    v_fmac_f32 v71, v72, v40
    v_fmac_f32 v71, v73, v41
    v_lshlrev_b32 v72, 16, v61
    v_and_b32 v73, 0xffff0000, v61
    v_fmac_f32 v71, v72, v42
    v_fmac_f32 v71, v73, v43
    s_mov_b32 s38, 0x3fb8aa3b
    v_cmp_gt_u32 vcc, 28, v5
    v_mul_f32 v64, s38, v64
    v_cndmask_b32 v64, 0, v64, vcc
    v_mul_f32 v65, s38, v65
    v_cndmask_b32 v65, 0, v65, vcc
    v_mul_f32 v66, s38, v66
    v_cndmask_b32 v66, 0, v66, vcc
    v_mul_f32 v67, s38, v67
    v_cndmask_b32 v67, 0, v67, vcc
    v_mul_f32 v68, s38, v68
    v_cndmask_b32 v68, 0, v68, vcc
    v_mul_f32 v69, s38, v69
    v_cndmask_b32 v69, 0, v69, vcc
    v_mul_f32 v70, s38, v70
    v_cndmask_b32 v70, 0, v70, vcc
    v_mul_f32 v71, s38, v71
    v_cndmask_b32 v71, 0, v71, vcc
    v_cvt_pk_bf16_f32 v76, v64, v65
    v_cvt_pk_bf16_f32 v77, v66, v67
    v_cvt_pk_bf16_f32 v78, v68, v69
    v_cvt_pk_bf16_f32 v79, v70, v71

    s_lshl_b32 s37, s29, 10
    s_mul_i32 s38, s28, 524288
    s_add_u32 s37, s37, s38
    s_add_u32 s37, s37, 0xc80000
    v_lshl_add_u32 v8, v1, 4, s37
    global_store_dwordx4 v8, v[76:79], s[4:5] sc1
    s_branch A0_next

A0_notqk:

    s_cmp_ge_u32 s46, 1344
    s_cbranch_scc1 A0_notv
    s_sub_u32 s29, s46, 896
    s_mov_b32 s40, 0x12492493
    s_mul_hi_u32 s30, s29, s40
    s_mul_i32 s31, s30, 14
    s_sub_u32 s31, s29, s31
    s_lshr_b32 s32, s30, 1
    s_and_b32 s33, s30, 1
    s_lshl_b32 s34, s33, 4
    v_add_u32 v5, s34, v3
    v_min_u32 v6, 27, v5
    s_lshl_b32 s36, s31, 5
    v_lshl_add_u32 v7, v4, 3, s36
    v_mul_u32_u24 v7, 2688, v7
    s_mul_i32 s38, s32, 56
    s_add_u32 s37, s38, 1792
    v_add_u32 v7, s37, v7
    v_lshl_add_u32 v7, v6, 1, v7

    global_load_ushort v16, v7, s[80:81]
    v_add_u32 v7, 2688, v7
    global_load_ushort v17, v7, s[80:81]
    v_add_u32 v7, 2688, v7
    global_load_ushort v18, v7, s[80:81]
    v_add_u32 v7, 2688, v7
    global_load_ushort v19, v7, s[80:81]
    v_add_u32 v7, 2688, v7
    global_load_ushort v20, v7, s[80:81]
    v_add_u32 v7, 2688, v7
    global_load_ushort v21, v7, s[80:81]
    v_add_u32 v7, 2688, v7
    global_load_ushort v22, v7, s[80:81]
    v_add_u32 v7, 2688, v7
    global_load_ushort v23, v7, s[80:81]
    v_add_u32 v7, 2688, v7
    s_waitcnt vmcnt(0)
    v_cmp_gt_u32 vcc, 28, v5
    v_lshl_or_b32 v76, v17, 16, v16
    v_cndmask_b32 v76, 0, v76, vcc
    v_lshl_or_b32 v77, v19, 16, v18
    v_cndmask_b32 v77, 0, v77, vcc
    v_lshl_or_b32 v78, v21, 16, v20
    v_cndmask_b32 v78, 0, v78, vcc
    v_lshl_or_b32 v79, v23, 16, v22
    v_cndmask_b32 v79, 0, v79, vcc

    s_lshl_b32 s37, s29, 10
    s_add_u32 s37, s37, 0xd80000
    v_lshl_add_u32 v8, v1, 4, s37
    global_store_dwordx4 v8, v[76:79], s[4:5] sc1
    s_branch A0_next

A0_notv:

    s_sub_u32 s29, s46, 1344
    s_lshr_b32 s30, s29, 4
    s_and_b32 s32, s29, 15
    s_mul_i32 s36, s32, 28*896
    s_lshl_b32 s37, s30, 5
    s_add_u32 s36, s36, s37
    v_lshl_add_u32 v7, v3, 1, s36
    v_mul_u32_u24 v9, 4*896, v4
    v_add_u32 v7, v7, v9
    v_min_u32 v10, 2, v4
    v_mul_u32_u24 v9, 4*896, v10
    v_lshl_add_u32 v11, v3, 1, s36
    v_add_u32 v11, v11, v9
    v_add_u32 v11, 16*896, v11

    global_load_ushort v16, v7, s[84:85] offset:0
    global_load_ushort v20, v11, s[84:85] offset:0
    global_load_ushort v17, v7, s[84:85] offset:896
    global_load_ushort v21, v11, s[84:85] offset:896
    global_load_ushort v18, v7, s[84:85] offset:1792
    global_load_ushort v22, v11, s[84:85] offset:1792
    global_load_ushort v19, v7, s[84:85] offset:2688
    global_load_ushort v23, v11, s[84:85] offset:2688
    s_waitcnt vmcnt(0)
    v_cmp_gt_u32 vcc, 3, v4
    v_lshl_or_b32 v76, v17, 16, v16
    v_lshl_or_b32 v77, v19, 16, v18
    v_lshl_or_b32 v78, v21, 16, v20
    v_lshl_or_b32 v79, v23, 16, v22
    v_cndmask_b32 v78, 0, v78, vcc
    v_cndmask_b32 v79, 0, v79, vcc

    s_lshl_b32 s37, s29, 10
    s_add_u32 s37, s37, 0xe00000
    v_lshl_add_u32 v8, v1, 4, s37
    global_store_dwordx4 v8, v[76:79], s[4:5] sc1
    s_branch A0_next

A0_next:
    s_add_u32 s46, s46, 256
    s_cmp_lt_u32 s46, 1792
    s_cbranch_scc1 A0_loop
    s_waitcnt vmcnt(0)
    s_barrier
    v_mov_b32 v5, 20
    s_cmp_lg_u32 s3, 0
    s_cbranch_scc1 A0_bw
    v_mov_b32 v10, 1
    s_mov_b64 exec, 1
    global_atomic_add v5, v10, s[6:7]
    s_mov_b64 exec, -1
A0_bw:
    global_load_dword v10, v5, s[6:7] sc1
    s_waitcnt vmcnt(0)
    v_readfirstlane_b32 s28, v10
    s_cmp_ge_u32 s28, 64
    s_cbranch_scc1 A0_bok
    s_sleep 8
    s_sub_u32 s15, s15, 1
    s_cbranch_scc1 M_end
    s_branch A0_bw
A0_bok:

    s_mul_i32 s28, s26, 28672
    s_add_u32 s24, s12, s28
    s_addc_u32 s25, s13, 0
    v_and_b32 v12, 15, v1
    v_lshrrev_b32 v11, 4, v1
    v_mul_u32_u24 v3, 896, v12
    v_lshl_add_u32 v3, v11, 4, v3
    v_add_u32 v4, 14336, v3
    v_lshlrev_b32 v2, 4, v1
    v_cmp_gt_u32 s[34:35], 12, v12
    v_cmp_eq_u32 s[36:37], 12, v12
    v_cmp_gt_u32 s[38:39], 3, v11
    v_cmp_eq_u32 s[40:41], 3, v11
    v_lshlrev_b32 v6, 10, v11
    v_lshl_add_u32 v6, v12, 2, v6
    v_add_u32 v7, 4096, v6
    v_lshlrev_b32 v8, 8, v12
    v_lshl_add_u32 v8, v11, 4, v8
    v_add_u32 v9, 4096, v8
    s_mov_b32 s42, 0xf149f2ca
    s_mov_b32 s43, 0x7149f2ca
    s_mov_b32 s44, 0x3f803f80
    s_mov_b32 s45, 0x358637bd
    s_mov_b32 s14, 0

    global_load_dwordx4 v[16:19], v3, s[24:25] offset:0
    global_load_dwordx4 v[20:23], v3, s[24:25] offset:64
    global_load_dwordx4 v[24:27], v3, s[24:25] offset:128
    global_load_dwordx4 v[28:31], v3, s[24:25] offset:192
    global_load_dwordx4 v[32:35], v3, s[24:25] offset:256
    global_load_dwordx4 v[36:39], v3, s[24:25] offset:320
    global_load_dwordx4 v[40:43], v3, s[24:25] offset:384
    global_load_dwordx4 v[44:47], v3, s[24:25] offset:448
    global_load_dwordx4 v[48:51], v3, s[24:25] offset:512
    global_load_dwordx4 v[52:55], v3, s[24:25] offset:576
    global_load_dwordx4 v[56:59], v3, s[24:25] offset:640
    global_load_dwordx4 v[60:63], v3, s[24:25] offset:704
    global_load_dwordx4 v[64:67], v3, s[24:25] offset:768
    global_load_dwordx4 v[68:71], v3, s[24:25] offset:832
    global_load_dwordx4 v[72:75], v4, s[24:25] offset:0
    global_load_dwordx4 v[76:79], v4, s[24:25] offset:64
    global_load_dwordx4 v[80:83], v4, s[24:25] offset:128
    global_load_dwordx4 v[84:87], v4, s[24:25] offset:192
    global_load_dwordx4 v[88:91], v4, s[24:25] offset:256
    global_load_dwordx4 v[92:95], v4, s[24:25] offset:320
    global_load_dwordx4 v[96:99], v4, s[24:25] offset:384
    global_load_dwordx4 v[100:103], v4, s[24:25] offset:448
    global_load_dwordx4 v[104:107], v4, s[24:25] offset:512
    global_load_dwordx4 v[108:111], v4, s[24:25] offset:576
    global_load_dwordx4 v[112:115], v4, s[24:25] offset:640
    global_load_dwordx4 v[116:119], v4, s[24:25] offset:704
    global_load_dwordx4 v[120:123], v4, s[24:25] offset:768
    global_load_dwordx4 v[124:127], v4, s[24:25] offset:832
A1_loop:
    s_add_u32 s28, s14, s26
    s_and_b32 s28, s28, 3

    s_lshl_b32 s27, s3, 2
    s_add_u32 s27, s27, s28
    s_mul_i32 s28, s27, 28672
    s_add_u32 s29, s28, 0xd00000
    s_add_u32 s30, s4, s29
    s_addc_u32 s31, s5, 0
    s_add_u32 s29, s28, 0xd80000
    s_add_u32 s32, s4, s29
    s_addc_u32 s33, s5, 0
    s_lshl_b32 s28, s27, 13
    s_add_u32 s28, s28, 0x1104000
    s_add_u32 s16, s4, s28
    s_addc_u32 s17, s5, 0
    v_mov_b32 v5, v2

    global_load_dwordx4 a[0:3], v5, s[30:31] offset:0
    global_load_dwordx4 a[112:115], v5, s[32:33] offset:0
    global_load_dwordx4 a[4:7], v5, s[30:31] offset:1024
    global_load_dwordx4 a[116:119], v5, s[32:33] offset:1024
    global_load_dwordx4 a[8:11], v5, s[30:31] offset:2048
    global_load_dwordx4 a[120:123], v5, s[32:33] offset:2048
    global_load_dwordx4 a[12:15], v5, s[30:31] offset:3072
    global_load_dwordx4 a[124:127], v5, s[32:33] offset:3072
    v_add_u32 v5, 4096, v5
    global_load_dwordx4 a[16:19], v5, s[30:31] offset:0
    global_load_dwordx4 a[128:131], v5, s[32:33] offset:0
    global_load_dwordx4 a[20:23], v5, s[30:31] offset:1024
    global_load_dwordx4 a[132:135], v5, s[32:33] offset:1024
    global_load_dwordx4 a[24:27], v5, s[30:31] offset:2048
    global_load_dwordx4 a[136:139], v5, s[32:33] offset:2048
    global_load_dwordx4 a[28:31], v5, s[30:31] offset:3072
    global_load_dwordx4 a[140:143], v5, s[32:33] offset:3072
    v_add_u32 v5, 4096, v5
    global_load_dwordx4 a[32:35], v5, s[30:31] offset:0
    global_load_dwordx4 a[144:147], v5, s[32:33] offset:0
    global_load_dwordx4 a[36:39], v5, s[30:31] offset:1024
    global_load_dwordx4 a[148:151], v5, s[32:33] offset:1024
    global_load_dwordx4 a[40:43], v5, s[30:31] offset:2048
    global_load_dwordx4 a[152:155], v5, s[32:33] offset:2048
    global_load_dwordx4 a[44:47], v5, s[30:31] offset:3072
    global_load_dwordx4 a[156:159], v5, s[32:33] offset:3072
    v_add_u32 v5, 4096, v5
    global_load_dwordx4 a[48:51], v5, s[30:31] offset:0
    global_load_dwordx4 a[160:163], v5, s[32:33] offset:0
    global_load_dwordx4 a[52:55], v5, s[30:31] offset:1024
    global_load_dwordx4 a[164:167], v5, s[32:33] offset:1024
    global_load_dwordx4 a[56:59], v5, s[30:31] offset:2048
    global_load_dwordx4 a[168:171], v5, s[32:33] offset:2048
    global_load_dwordx4 a[60:63], v5, s[30:31] offset:3072
    global_load_dwordx4 a[172:175], v5, s[32:33] offset:3072
    v_add_u32 v5, 4096, v5
    global_load_dwordx4 a[64:67], v5, s[30:31] offset:0
    global_load_dwordx4 a[176:179], v5, s[32:33] offset:0
    global_load_dwordx4 a[68:71], v5, s[30:31] offset:1024
    global_load_dwordx4 a[180:183], v5, s[32:33] offset:1024
    global_load_dwordx4 a[72:75], v5, s[30:31] offset:2048
    global_load_dwordx4 a[184:187], v5, s[32:33] offset:2048
    global_load_dwordx4 a[76:79], v5, s[30:31] offset:3072
    global_load_dwordx4 a[188:191], v5, s[32:33] offset:3072
    v_add_u32 v5, 4096, v5
    global_load_dwordx4 a[80:83], v5, s[30:31] offset:0
    global_load_dwordx4 a[192:195], v5, s[32:33] offset:0
    global_load_dwordx4 a[84:87], v5, s[30:31] offset:1024
    global_load_dwordx4 a[196:199], v5, s[32:33] offset:1024
    global_load_dwordx4 a[88:91], v5, s[30:31] offset:2048
    global_load_dwordx4 a[200:203], v5, s[32:33] offset:2048
    global_load_dwordx4 a[92:95], v5, s[30:31] offset:3072
    global_load_dwordx4 a[204:207], v5, s[32:33] offset:3072
    v_add_u32 v5, 4096, v5
    global_load_dwordx4 a[96:99], v5, s[30:31] offset:0
    global_load_dwordx4 a[208:211], v5, s[32:33] offset:0
    global_load_dwordx4 a[100:103], v5, s[30:31] offset:1024
    global_load_dwordx4 a[212:215], v5, s[32:33] offset:1024
    global_load_dwordx4 a[104:107], v5, s[30:31] offset:2048
    global_load_dwordx4 a[216:219], v5, s[32:33] offset:2048
    global_load_dwordx4 a[108:111], v5, s[30:31] offset:3072
    global_load_dwordx4 a[220:223], v5, s[32:33] offset:3072
    v_add_u32 v5, 4096, v5
    s_waitcnt vmcnt(0)
    v_mfma_f32_16x16x32_bf16 v[128:131], v[16:19], a[0:3], 0
    v_mfma_f32_16x16x32_bf16 v[132:135], v[72:75], a[0:3], 0
    v_mfma_f32_16x16x32_bf16 v[136:139], v[16:19], a[56:59], 0
    v_mfma_f32_16x16x32_bf16 v[140:143], v[72:75], a[56:59], 0
    v_mfma_f32_16x16x32_bf16 v[144:147], v[16:19], a[112:115], 0
    v_mfma_f32_16x16x32_bf16 v[148:151], v[72:75], a[112:115], 0
    v_mfma_f32_16x16x32_bf16 v[152:155], v[16:19], a[168:171], 0
    v_mfma_f32_16x16x32_bf16 v[156:159], v[72:75], a[168:171], 0
    v_mfma_f32_16x16x32_bf16 v[128:131], v[20:23], a[4:7], v[128:131]
    v_mfma_f32_16x16x32_bf16 v[132:135], v[76:79], a[4:7], v[132:135]
    v_mfma_f32_16x16x32_bf16 v[136:139], v[20:23], a[60:63], v[136:139]
    v_mfma_f32_16x16x32_bf16 v[140:143], v[76:79], a[60:63], v[140:143]
    v_mfma_f32_16x16x32_bf16 v[144:147], v[20:23], a[116:119], v[144:147]
    v_mfma_f32_16x16x32_bf16 v[148:151], v[76:79], a[116:119], v[148:151]
    v_mfma_f32_16x16x32_bf16 v[152:155], v[20:23], a[172:175], v[152:155]
    v_mfma_f32_16x16x32_bf16 v[156:159], v[76:79], a[172:175], v[156:159]
    v_mfma_f32_16x16x32_bf16 v[128:131], v[24:27], a[8:11], v[128:131]
    v_mfma_f32_16x16x32_bf16 v[132:135], v[80:83], a[8:11], v[132:135]
    v_mfma_f32_16x16x32_bf16 v[136:139], v[24:27], a[64:67], v[136:139]
    v_mfma_f32_16x16x32_bf16 v[140:143], v[80:83], a[64:67], v[140:143]
    v_mfma_f32_16x16x32_bf16 v[144:147], v[24:27], a[120:123], v[144:147]
    v_mfma_f32_16x16x32_bf16 v[148:151], v[80:83], a[120:123], v[148:151]
    v_mfma_f32_16x16x32_bf16 v[152:155], v[24:27], a[176:179], v[152:155]
    v_mfma_f32_16x16x32_bf16 v[156:159], v[80:83], a[176:179], v[156:159]
    v_mfma_f32_16x16x32_bf16 v[128:131], v[28:31], a[12:15], v[128:131]
    v_mfma_f32_16x16x32_bf16 v[132:135], v[84:87], a[12:15], v[132:135]
    v_mfma_f32_16x16x32_bf16 v[136:139], v[28:31], a[68:71], v[136:139]
    v_mfma_f32_16x16x32_bf16 v[140:143], v[84:87], a[68:71], v[140:143]
    v_mfma_f32_16x16x32_bf16 v[144:147], v[28:31], a[124:127], v[144:147]
    v_mfma_f32_16x16x32_bf16 v[148:151], v[84:87], a[124:127], v[148:151]
    v_mfma_f32_16x16x32_bf16 v[152:155], v[28:31], a[180:183], v[152:155]
    v_mfma_f32_16x16x32_bf16 v[156:159], v[84:87], a[180:183], v[156:159]
    v_mfma_f32_16x16x32_bf16 v[128:131], v[32:35], a[16:19], v[128:131]
    v_mfma_f32_16x16x32_bf16 v[132:135], v[88:91], a[16:19], v[132:135]
    v_mfma_f32_16x16x32_bf16 v[136:139], v[32:35], a[72:75], v[136:139]
    v_mfma_f32_16x16x32_bf16 v[140:143], v[88:91], a[72:75], v[140:143]
    v_mfma_f32_16x16x32_bf16 v[144:147], v[32:35], a[128:131], v[144:147]
    v_mfma_f32_16x16x32_bf16 v[148:151], v[88:91], a[128:131], v[148:151]
    v_mfma_f32_16x16x32_bf16 v[152:155], v[32:35], a[184:187], v[152:155]
    v_mfma_f32_16x16x32_bf16 v[156:159], v[88:91], a[184:187], v[156:159]
    v_mfma_f32_16x16x32_bf16 v[128:131], v[36:39], a[20:23], v[128:131]
    v_mfma_f32_16x16x32_bf16 v[132:135], v[92:95], a[20:23], v[132:135]
    v_mfma_f32_16x16x32_bf16 v[136:139], v[36:39], a[76:79], v[136:139]
    v_mfma_f32_16x16x32_bf16 v[140:143], v[92:95], a[76:79], v[140:143]
    v_mfma_f32_16x16x32_bf16 v[144:147], v[36:39], a[132:135], v[144:147]
    v_mfma_f32_16x16x32_bf16 v[148:151], v[92:95], a[132:135], v[148:151]
    v_mfma_f32_16x16x32_bf16 v[152:155], v[36:39], a[188:191], v[152:155]
    v_mfma_f32_16x16x32_bf16 v[156:159], v[92:95], a[188:191], v[156:159]
    v_mfma_f32_16x16x32_bf16 v[128:131], v[40:43], a[24:27], v[128:131]
    v_mfma_f32_16x16x32_bf16 v[132:135], v[96:99], a[24:27], v[132:135]
    v_mfma_f32_16x16x32_bf16 v[136:139], v[40:43], a[80:83], v[136:139]
    v_mfma_f32_16x16x32_bf16 v[140:143], v[96:99], a[80:83], v[140:143]
    v_mfma_f32_16x16x32_bf16 v[144:147], v[40:43], a[136:139], v[144:147]
    v_mfma_f32_16x16x32_bf16 v[148:151], v[96:99], a[136:139], v[148:151]
    v_mfma_f32_16x16x32_bf16 v[152:155], v[40:43], a[192:195], v[152:155]
    v_mfma_f32_16x16x32_bf16 v[156:159], v[96:99], a[192:195], v[156:159]
    v_mfma_f32_16x16x32_bf16 v[128:131], v[44:47], a[28:31], v[128:131]
    v_mfma_f32_16x16x32_bf16 v[132:135], v[100:103], a[28:31], v[132:135]
    v_mfma_f32_16x16x32_bf16 v[136:139], v[44:47], a[84:87], v[136:139]
    v_mfma_f32_16x16x32_bf16 v[140:143], v[100:103], a[84:87], v[140:143]
    v_mfma_f32_16x16x32_bf16 v[144:147], v[44:47], a[140:143], v[144:147]
    v_mfma_f32_16x16x32_bf16 v[148:151], v[100:103], a[140:143], v[148:151]
    v_mfma_f32_16x16x32_bf16 v[152:155], v[44:47], a[196:199], v[152:155]
    v_mfma_f32_16x16x32_bf16 v[156:159], v[100:103], a[196:199], v[156:159]
    v_mfma_f32_16x16x32_bf16 v[128:131], v[48:51], a[32:35], v[128:131]
    v_mfma_f32_16x16x32_bf16 v[132:135], v[104:107], a[32:35], v[132:135]
    v_mfma_f32_16x16x32_bf16 v[136:139], v[48:51], a[88:91], v[136:139]
    v_mfma_f32_16x16x32_bf16 v[140:143], v[104:107], a[88:91], v[140:143]
    v_mfma_f32_16x16x32_bf16 v[144:147], v[48:51], a[144:147], v[144:147]
    v_mfma_f32_16x16x32_bf16 v[148:151], v[104:107], a[144:147], v[148:151]
    v_mfma_f32_16x16x32_bf16 v[152:155], v[48:51], a[200:203], v[152:155]
    v_mfma_f32_16x16x32_bf16 v[156:159], v[104:107], a[200:203], v[156:159]
    v_mfma_f32_16x16x32_bf16 v[128:131], v[52:55], a[36:39], v[128:131]
    v_mfma_f32_16x16x32_bf16 v[132:135], v[108:111], a[36:39], v[132:135]
    v_mfma_f32_16x16x32_bf16 v[136:139], v[52:55], a[92:95], v[136:139]
    v_mfma_f32_16x16x32_bf16 v[140:143], v[108:111], a[92:95], v[140:143]
    v_mfma_f32_16x16x32_bf16 v[144:147], v[52:55], a[148:151], v[144:147]
    v_mfma_f32_16x16x32_bf16 v[148:151], v[108:111], a[148:151], v[148:151]
    v_mfma_f32_16x16x32_bf16 v[152:155], v[52:55], a[204:207], v[152:155]
    v_mfma_f32_16x16x32_bf16 v[156:159], v[108:111], a[204:207], v[156:159]
    v_mfma_f32_16x16x32_bf16 v[128:131], v[56:59], a[40:43], v[128:131]
    v_mfma_f32_16x16x32_bf16 v[132:135], v[112:115], a[40:43], v[132:135]
    v_mfma_f32_16x16x32_bf16 v[136:139], v[56:59], a[96:99], v[136:139]
    v_mfma_f32_16x16x32_bf16 v[140:143], v[112:115], a[96:99], v[140:143]
    v_mfma_f32_16x16x32_bf16 v[144:147], v[56:59], a[152:155], v[144:147]
    v_mfma_f32_16x16x32_bf16 v[148:151], v[112:115], a[152:155], v[148:151]
    v_mfma_f32_16x16x32_bf16 v[152:155], v[56:59], a[208:211], v[152:155]
    v_mfma_f32_16x16x32_bf16 v[156:159], v[112:115], a[208:211], v[156:159]
    v_mfma_f32_16x16x32_bf16 v[128:131], v[60:63], a[44:47], v[128:131]
    v_mfma_f32_16x16x32_bf16 v[132:135], v[116:119], a[44:47], v[132:135]
    v_mfma_f32_16x16x32_bf16 v[136:139], v[60:63], a[100:103], v[136:139]
    v_mfma_f32_16x16x32_bf16 v[140:143], v[116:119], a[100:103], v[140:143]
    v_mfma_f32_16x16x32_bf16 v[144:147], v[60:63], a[156:159], v[144:147]
    v_mfma_f32_16x16x32_bf16 v[148:151], v[116:119], a[156:159], v[148:151]
    v_mfma_f32_16x16x32_bf16 v[152:155], v[60:63], a[212:215], v[152:155]
    v_mfma_f32_16x16x32_bf16 v[156:159], v[116:119], a[212:215], v[156:159]
    v_mfma_f32_16x16x32_bf16 v[128:131], v[64:67], a[48:51], v[128:131]
    v_mfma_f32_16x16x32_bf16 v[132:135], v[120:123], a[48:51], v[132:135]
    v_mfma_f32_16x16x32_bf16 v[136:139], v[64:67], a[104:107], v[136:139]
    v_mfma_f32_16x16x32_bf16 v[140:143], v[120:123], a[104:107], v[140:143]
    v_mfma_f32_16x16x32_bf16 v[144:147], v[64:67], a[160:163], v[144:147]
    v_mfma_f32_16x16x32_bf16 v[148:151], v[120:123], a[160:163], v[148:151]
    v_mfma_f32_16x16x32_bf16 v[152:155], v[64:67], a[216:219], v[152:155]
    v_mfma_f32_16x16x32_bf16 v[156:159], v[120:123], a[216:219], v[156:159]
    v_mfma_f32_16x16x32_bf16 v[128:131], v[68:71], a[52:55], v[128:131]
    v_mfma_f32_16x16x32_bf16 v[132:135], v[124:127], a[52:55], v[132:135]
    v_mfma_f32_16x16x32_bf16 v[136:139], v[68:71], a[108:111], v[136:139]
    v_mfma_f32_16x16x32_bf16 v[140:143], v[124:127], a[108:111], v[140:143]
    v_mfma_f32_16x16x32_bf16 v[144:147], v[68:71], a[164:167], v[144:147]
    v_mfma_f32_16x16x32_bf16 v[148:151], v[124:127], a[164:167], v[148:151]
    v_mfma_f32_16x16x32_bf16 v[152:155], v[68:71], a[220:223], v[152:155]
    v_mfma_f32_16x16x32_bf16 v[156:159], v[124:127], a[220:223], v[156:159]
    s_nop 7
    v_mov_b32 v168, s42
    v_mov_b32 v169, s43
    v_cndmask_b32 v168, v168, v136, s[34:35]
    v_cndmask_b32 v169, v169, v136, s[34:35]
    v_max_f32 v160, v128, v168
    v_min_f32 v164, v128, v169
    v_mov_b32 v168, s42
    v_mov_b32 v169, s43
    v_cndmask_b32 v168, v168, v137, s[34:35]
    v_cndmask_b32 v169, v169, v137, s[34:35]
    v_max_f32 v161, v129, v168
    v_min_f32 v165, v129, v169
    v_mov_b32 v168, s42
    v_mov_b32 v169, s43
    v_cndmask_b32 v168, v168, v138, s[34:35]
    v_cndmask_b32 v169, v169, v138, s[34:35]
    v_max_f32 v162, v130, v168
    v_min_f32 v166, v130, v169
    v_mov_b32 v168, s42
    v_mov_b32 v169, s43
    v_cndmask_b32 v168, v168, v139, s[34:35]
    v_cndmask_b32 v169, v169, v139, s[34:35]
    v_max_f32 v163, v131, v168
    v_min_f32 v167, v131, v169
    v_max_f32_dpp v160, v160, v160 quad_perm:[1,0,3,2] row_mask:0xf bank_mask:0xf
    v_max_f32_dpp v161, v161, v161 quad_perm:[1,0,3,2] row_mask:0xf bank_mask:0xf
    v_max_f32_dpp v162, v162, v162 quad_perm:[1,0,3,2] row_mask:0xf bank_mask:0xf
    v_max_f32_dpp v163, v163, v163 quad_perm:[1,0,3,2] row_mask:0xf bank_mask:0xf
    v_min_f32_dpp v164, v164, v164 quad_perm:[1,0,3,2] row_mask:0xf bank_mask:0xf
    v_min_f32_dpp v165, v165, v165 quad_perm:[1,0,3,2] row_mask:0xf bank_mask:0xf
    v_min_f32_dpp v166, v166, v166 quad_perm:[1,0,3,2] row_mask:0xf bank_mask:0xf
    v_min_f32_dpp v167, v167, v167 quad_perm:[1,0,3,2] row_mask:0xf bank_mask:0xf
    v_max_f32_dpp v160, v160, v160 quad_perm:[2,3,0,1] row_mask:0xf bank_mask:0xf
    v_max_f32_dpp v161, v161, v161 quad_perm:[2,3,0,1] row_mask:0xf bank_mask:0xf
    v_max_f32_dpp v162, v162, v162 quad_perm:[2,3,0,1] row_mask:0xf bank_mask:0xf
    v_max_f32_dpp v163, v163, v163 quad_perm:[2,3,0,1] row_mask:0xf bank_mask:0xf
    v_min_f32_dpp v164, v164, v164 quad_perm:[2,3,0,1] row_mask:0xf bank_mask:0xf
    v_min_f32_dpp v165, v165, v165 quad_perm:[2,3,0,1] row_mask:0xf bank_mask:0xf
    v_min_f32_dpp v166, v166, v166 quad_perm:[2,3,0,1] row_mask:0xf bank_mask:0xf
    v_min_f32_dpp v167, v167, v167 quad_perm:[2,3,0,1] row_mask:0xf bank_mask:0xf
    v_max_f32_dpp v160, v160, v160 row_half_mirror row_mask:0xf bank_mask:0xf
    v_max_f32_dpp v161, v161, v161 row_half_mirror row_mask:0xf bank_mask:0xf
    v_max_f32_dpp v162, v162, v162 row_half_mirror row_mask:0xf bank_mask:0xf
    v_max_f32_dpp v163, v163, v163 row_half_mirror row_mask:0xf bank_mask:0xf
    v_min_f32_dpp v164, v164, v164 row_half_mirror row_mask:0xf bank_mask:0xf
    v_min_f32_dpp v165, v165, v165 row_half_mirror row_mask:0xf bank_mask:0xf
    v_min_f32_dpp v166, v166, v166 row_half_mirror row_mask:0xf bank_mask:0xf
    v_min_f32_dpp v167, v167, v167 row_half_mirror row_mask:0xf bank_mask:0xf
    v_max_f32_dpp v160, v160, v160 row_mirror row_mask:0xf bank_mask:0xf
    v_max_f32_dpp v161, v161, v161 row_mirror row_mask:0xf bank_mask:0xf
    v_max_f32_dpp v162, v162, v162 row_mirror row_mask:0xf bank_mask:0xf
    v_max_f32_dpp v163, v163, v163 row_mirror row_mask:0xf bank_mask:0xf
    v_min_f32_dpp v164, v164, v164 row_mirror row_mask:0xf bank_mask:0xf
    v_min_f32_dpp v165, v165, v165 row_mirror row_mask:0xf bank_mask:0xf
    v_min_f32_dpp v166, v166, v166 row_mirror row_mask:0xf bank_mask:0xf
    v_min_f32_dpp v167, v167, v167 row_mirror row_mask:0xf bank_mask:0xf
    v_sub_f32 v192, v128, v160
    v_sub_f32 v208, v164, v128
    v_sub_f32 v200, v136, v160
    v_sub_f32 v216, v164, v136
    v_sub_f32 v193, v129, v161
    v_sub_f32 v209, v165, v129
    v_sub_f32 v201, v137, v161
    v_sub_f32 v217, v165, v137
    v_sub_f32 v194, v130, v162
    v_sub_f32 v210, v166, v130
    v_sub_f32 v202, v138, v162
    v_sub_f32 v218, v166, v138
    v_sub_f32 v195, v131, v163
    v_sub_f32 v211, v167, v131
    v_sub_f32 v203, v139, v163
    v_sub_f32 v219, v167, v139
    v_exp_f32 v192, v192
    v_exp_f32 v200, v200
    v_exp_f32 v208, v208
    v_exp_f32 v216, v216
    v_exp_f32 v193, v193
    v_exp_f32 v201, v201
    v_exp_f32 v209, v209
    v_exp_f32 v217, v217
    v_exp_f32 v194, v194
    v_exp_f32 v202, v202
    v_exp_f32 v210, v210
    v_exp_f32 v218, v218
    v_exp_f32 v195, v195
    v_exp_f32 v203, v203
    v_exp_f32 v211, v211
    v_exp_f32 v219, v219
    s_nop 0
    v_cndmask_b32 v200, 0, v200, s[34:35]
    v_cndmask_b32 v216, 0, v216, s[34:35]
    v_cndmask_b32 v201, 0, v201, s[34:35]
    v_cndmask_b32 v217, 0, v217, s[34:35]
    v_cndmask_b32 v202, 0, v202, s[34:35]
    v_cndmask_b32 v218, 0, v218, s[34:35]
    v_cndmask_b32 v203, 0, v203, s[34:35]
    v_cndmask_b32 v219, 0, v219, s[34:35]
    v_add_f32 v160, v192, v200
    v_add_f32 v164, v208, v216
    v_add_f32 v161, v193, v201
    v_add_f32 v165, v209, v217
    v_add_f32 v162, v194, v202
    v_add_f32 v166, v210, v218
    v_add_f32 v163, v195, v203
    v_add_f32 v167, v211, v219
    v_add_f32_dpp v160, v160, v160 quad_perm:[1,0,3,2] row_mask:0xf bank_mask:0xf
    v_add_f32_dpp v161, v161, v161 quad_perm:[1,0,3,2] row_mask:0xf bank_mask:0xf
    v_add_f32_dpp v162, v162, v162 quad_perm:[1,0,3,2] row_mask:0xf bank_mask:0xf
    v_add_f32_dpp v163, v163, v163 quad_perm:[1,0,3,2] row_mask:0xf bank_mask:0xf
    v_add_f32_dpp v164, v164, v164 quad_perm:[1,0,3,2] row_mask:0xf bank_mask:0xf
    v_add_f32_dpp v165, v165, v165 quad_perm:[1,0,3,2] row_mask:0xf bank_mask:0xf
    v_add_f32_dpp v166, v166, v166 quad_perm:[1,0,3,2] row_mask:0xf bank_mask:0xf
    v_add_f32_dpp v167, v167, v167 quad_perm:[1,0,3,2] row_mask:0xf bank_mask:0xf
    v_add_f32_dpp v160, v160, v160 quad_perm:[2,3,0,1] row_mask:0xf bank_mask:0xf
    v_add_f32_dpp v161, v161, v161 quad_perm:[2,3,0,1] row_mask:0xf bank_mask:0xf
    v_add_f32_dpp v162, v162, v162 quad_perm:[2,3,0,1] row_mask:0xf bank_mask:0xf
    v_add_f32_dpp v163, v163, v163 quad_perm:[2,3,0,1] row_mask:0xf bank_mask:0xf
    v_add_f32_dpp v164, v164, v164 quad_perm:[2,3,0,1] row_mask:0xf bank_mask:0xf
    v_add_f32_dpp v165, v165, v165 quad_perm:[2,3,0,1] row_mask:0xf bank_mask:0xf
    v_add_f32_dpp v166, v166, v166 quad_perm:[2,3,0,1] row_mask:0xf bank_mask:0xf
    v_add_f32_dpp v167, v167, v167 quad_perm:[2,3,0,1] row_mask:0xf bank_mask:0xf
    v_add_f32_dpp v160, v160, v160 row_half_mirror row_mask:0xf bank_mask:0xf
    v_add_f32_dpp v161, v161, v161 row_half_mirror row_mask:0xf bank_mask:0xf
    v_add_f32_dpp v162, v162, v162 row_half_mirror row_mask:0xf bank_mask:0xf
    v_add_f32_dpp v163, v163, v163 row_half_mirror row_mask:0xf bank_mask:0xf
    v_add_f32_dpp v164, v164, v164 row_half_mirror row_mask:0xf bank_mask:0xf
    v_add_f32_dpp v165, v165, v165 row_half_mirror row_mask:0xf bank_mask:0xf
    v_add_f32_dpp v166, v166, v166 row_half_mirror row_mask:0xf bank_mask:0xf
    v_add_f32_dpp v167, v167, v167 row_half_mirror row_mask:0xf bank_mask:0xf
    v_add_f32_dpp v160, v160, v160 row_mirror row_mask:0xf bank_mask:0xf
    v_add_f32_dpp v161, v161, v161 row_mirror row_mask:0xf bank_mask:0xf
    v_add_f32_dpp v162, v162, v162 row_mirror row_mask:0xf bank_mask:0xf
    v_add_f32_dpp v163, v163, v163 row_mirror row_mask:0xf bank_mask:0xf
    v_add_f32_dpp v164, v164, v164 row_mirror row_mask:0xf bank_mask:0xf
    v_add_f32_dpp v165, v165, v165 row_mirror row_mask:0xf bank_mask:0xf
    v_add_f32_dpp v166, v166, v166 row_mirror row_mask:0xf bank_mask:0xf
    v_add_f32_dpp v167, v167, v167 row_mirror row_mask:0xf bank_mask:0xf
    v_rcp_f32 v160, v160
    v_rcp_f32 v161, v161
    v_rcp_f32 v162, v162
    v_rcp_f32 v163, v163
    v_rcp_f32 v164, v164
    v_rcp_f32 v165, v165
    v_rcp_f32 v166, v166
    v_rcp_f32 v167, v167
    s_nop 0
    v_mul_f32 v192, v192, v160
    v_mul_f32 v200, v200, v160
    v_mul_f32 v208, v208, v164
    v_mul_f32 v216, v216, v164
    v_mul_f32 v193, v193, v161
    v_mul_f32 v201, v201, v161
    v_mul_f32 v209, v209, v165
    v_mul_f32 v217, v217, v165
    v_mul_f32 v194, v194, v162
    v_mul_f32 v202, v202, v162
    v_mul_f32 v210, v210, v166
    v_mul_f32 v218, v218, v166
    v_mul_f32 v195, v195, v163
    v_mul_f32 v203, v203, v163
    v_mul_f32 v211, v211, v167
    v_mul_f32 v219, v219, v167
    v_mov_b32 v168, s42
    v_mov_b32 v169, s43
    v_cndmask_b32 v168, v168, v140, s[34:35]
    v_cndmask_b32 v169, v169, v140, s[34:35]
    v_max_f32 v160, v132, v168
    v_min_f32 v164, v132, v169
    v_mov_b32 v168, s42
    v_mov_b32 v169, s43
    v_cndmask_b32 v168, v168, v141, s[34:35]
    v_cndmask_b32 v169, v169, v141, s[34:35]
    v_max_f32 v161, v133, v168
    v_min_f32 v165, v133, v169
    v_mov_b32 v168, s42
    v_mov_b32 v169, s43
    v_cndmask_b32 v168, v168, v142, s[34:35]
    v_cndmask_b32 v169, v169, v142, s[34:35]
    v_max_f32 v162, v134, v168
    v_min_f32 v166, v134, v169
    v_mov_b32 v168, s42
    v_mov_b32 v169, s43
    v_cndmask_b32 v168, v168, v143, s[34:35]
    v_cndmask_b32 v169, v169, v143, s[34:35]
    v_max_f32 v163, v135, v168
    v_min_f32 v167, v135, v169
    v_max_f32_dpp v160, v160, v160 quad_perm:[1,0,3,2] row_mask:0xf bank_mask:0xf
    v_max_f32_dpp v161, v161, v161 quad_perm:[1,0,3,2] row_mask:0xf bank_mask:0xf
    v_max_f32_dpp v162, v162, v162 quad_perm:[1,0,3,2] row_mask:0xf bank_mask:0xf
    v_max_f32_dpp v163, v163, v163 quad_perm:[1,0,3,2] row_mask:0xf bank_mask:0xf
    v_min_f32_dpp v164, v164, v164 quad_perm:[1,0,3,2] row_mask:0xf bank_mask:0xf
    v_min_f32_dpp v165, v165, v165 quad_perm:[1,0,3,2] row_mask:0xf bank_mask:0xf
    v_min_f32_dpp v166, v166, v166 quad_perm:[1,0,3,2] row_mask:0xf bank_mask:0xf
    v_min_f32_dpp v167, v167, v167 quad_perm:[1,0,3,2] row_mask:0xf bank_mask:0xf
    v_max_f32_dpp v160, v160, v160 quad_perm:[2,3,0,1] row_mask:0xf bank_mask:0xf
    v_max_f32_dpp v161, v161, v161 quad_perm:[2,3,0,1] row_mask:0xf bank_mask:0xf
    v_max_f32_dpp v162, v162, v162 quad_perm:[2,3,0,1] row_mask:0xf bank_mask:0xf
    v_max_f32_dpp v163, v163, v163 quad_perm:[2,3,0,1] row_mask:0xf bank_mask:0xf
    v_min_f32_dpp v164, v164, v164 quad_perm:[2,3,0,1] row_mask:0xf bank_mask:0xf
    v_min_f32_dpp v165, v165, v165 quad_perm:[2,3,0,1] row_mask:0xf bank_mask:0xf
    v_min_f32_dpp v166, v166, v166 quad_perm:[2,3,0,1] row_mask:0xf bank_mask:0xf
    v_min_f32_dpp v167, v167, v167 quad_perm:[2,3,0,1] row_mask:0xf bank_mask:0xf
    v_max_f32_dpp v160, v160, v160 row_half_mirror row_mask:0xf bank_mask:0xf
    v_max_f32_dpp v161, v161, v161 row_half_mirror row_mask:0xf bank_mask:0xf
    v_max_f32_dpp v162, v162, v162 row_half_mirror row_mask:0xf bank_mask:0xf
    v_max_f32_dpp v163, v163, v163 row_half_mirror row_mask:0xf bank_mask:0xf
    v_min_f32_dpp v164, v164, v164 row_half_mirror row_mask:0xf bank_mask:0xf
    v_min_f32_dpp v165, v165, v165 row_half_mirror row_mask:0xf bank_mask:0xf
    v_min_f32_dpp v166, v166, v166 row_half_mirror row_mask:0xf bank_mask:0xf
    v_min_f32_dpp v167, v167, v167 row_half_mirror row_mask:0xf bank_mask:0xf
    v_max_f32_dpp v160, v160, v160 row_mirror row_mask:0xf bank_mask:0xf
    v_max_f32_dpp v161, v161, v161 row_mirror row_mask:0xf bank_mask:0xf
    v_max_f32_dpp v162, v162, v162 row_mirror row_mask:0xf bank_mask:0xf
    v_max_f32_dpp v163, v163, v163 row_mirror row_mask:0xf bank_mask:0xf
    v_min_f32_dpp v164, v164, v164 row_mirror row_mask:0xf bank_mask:0xf
    v_min_f32_dpp v165, v165, v165 row_mirror row_mask:0xf bank_mask:0xf
    v_min_f32_dpp v166, v166, v166 row_mirror row_mask:0xf bank_mask:0xf
    v_min_f32_dpp v167, v167, v167 row_mirror row_mask:0xf bank_mask:0xf
    v_sub_f32 v196, v132, v160
    v_sub_f32 v212, v164, v132
    v_sub_f32 v204, v140, v160
    v_sub_f32 v220, v164, v140
    v_sub_f32 v197, v133, v161
    v_sub_f32 v213, v165, v133
    v_sub_f32 v205, v141, v161
    v_sub_f32 v221, v165, v141
    v_sub_f32 v198, v134, v162
    v_sub_f32 v214, v166, v134
    v_sub_f32 v206, v142, v162
    v_sub_f32 v222, v166, v142
    v_sub_f32 v199, v135, v163
    v_sub_f32 v215, v167, v135
    v_sub_f32 v207, v143, v163
    v_sub_f32 v223, v167, v143
    v_exp_f32 v196, v196
    v_exp_f32 v204, v204
    v_exp_f32 v212, v212
    v_exp_f32 v220, v220
    v_exp_f32 v197, v197
    v_exp_f32 v205, v205
    v_exp_f32 v213, v213
    v_exp_f32 v221, v221
    v_exp_f32 v198, v198
    v_exp_f32 v206, v206
    v_exp_f32 v214, v214
    v_exp_f32 v222, v222
    v_exp_f32 v199, v199
    v_exp_f32 v207, v207
    v_exp_f32 v215, v215
    v_exp_f32 v223, v223
    s_nop 0
    v_cndmask_b32 v204, 0, v204, s[34:35]
    v_cndmask_b32 v220, 0, v220, s[34:35]
    v_cndmask_b32 v205, 0, v205, s[34:35]
    v_cndmask_b32 v221, 0, v221, s[34:35]
    v_cndmask_b32 v206, 0, v206, s[34:35]
    v_cndmask_b32 v222, 0, v222, s[34:35]
    v_cndmask_b32 v207, 0, v207, s[34:35]
    v_cndmask_b32 v223, 0, v223, s[34:35]
    v_add_f32 v160, v196, v204
    v_add_f32 v164, v212, v220
    v_add_f32 v161, v197, v205
    v_add_f32 v165, v213, v221
    v_add_f32 v162, v198, v206
    v_add_f32 v166, v214, v222
    v_add_f32 v163, v199, v207
    v_add_f32 v167, v215, v223
    v_add_f32_dpp v160, v160, v160 quad_perm:[1,0,3,2] row_mask:0xf bank_mask:0xf
    v_add_f32_dpp v161, v161, v161 quad_perm:[1,0,3,2] row_mask:0xf bank_mask:0xf
    v_add_f32_dpp v162, v162, v162 quad_perm:[1,0,3,2] row_mask:0xf bank_mask:0xf
    v_add_f32_dpp v163, v163, v163 quad_perm:[1,0,3,2] row_mask:0xf bank_mask:0xf
    v_add_f32_dpp v164, v164, v164 quad_perm:[1,0,3,2] row_mask:0xf bank_mask:0xf
    v_add_f32_dpp v165, v165, v165 quad_perm:[1,0,3,2] row_mask:0xf bank_mask:0xf
    v_add_f32_dpp v166, v166, v166 quad_perm:[1,0,3,2] row_mask:0xf bank_mask:0xf
    v_add_f32_dpp v167, v167, v167 quad_perm:[1,0,3,2] row_mask:0xf bank_mask:0xf
    v_add_f32_dpp v160, v160, v160 quad_perm:[2,3,0,1] row_mask:0xf bank_mask:0xf
    v_add_f32_dpp v161, v161, v161 quad_perm:[2,3,0,1] row_mask:0xf bank_mask:0xf
    v_add_f32_dpp v162, v162, v162 quad_perm:[2,3,0,1] row_mask:0xf bank_mask:0xf
    v_add_f32_dpp v163, v163, v163 quad_perm:[2,3,0,1] row_mask:0xf bank_mask:0xf
    v_add_f32_dpp v164, v164, v164 quad_perm:[2,3,0,1] row_mask:0xf bank_mask:0xf
    v_add_f32_dpp v165, v165, v165 quad_perm:[2,3,0,1] row_mask:0xf bank_mask:0xf
    v_add_f32_dpp v166, v166, v166 quad_perm:[2,3,0,1] row_mask:0xf bank_mask:0xf
    v_add_f32_dpp v167, v167, v167 quad_perm:[2,3,0,1] row_mask:0xf bank_mask:0xf
    v_add_f32_dpp v160, v160, v160 row_half_mirror row_mask:0xf bank_mask:0xf
    v_add_f32_dpp v161, v161, v161 row_half_mirror row_mask:0xf bank_mask:0xf
    v_add_f32_dpp v162, v162, v162 row_half_mirror row_mask:0xf bank_mask:0xf
    v_add_f32_dpp v163, v163, v163 row_half_mirror row_mask:0xf bank_mask:0xf
    v_add_f32_dpp v164, v164, v164 row_half_mirror row_mask:0xf bank_mask:0xf
    v_add_f32_dpp v165, v165, v165 row_half_mirror row_mask:0xf bank_mask:0xf
    v_add_f32_dpp v166, v166, v166 row_half_mirror row_mask:0xf bank_mask:0xf
    v_add_f32_dpp v167, v167, v167 row_half_mirror row_mask:0xf bank_mask:0xf
    v_add_f32_dpp v160, v160, v160 row_mirror row_mask:0xf bank_mask:0xf
    v_add_f32_dpp v161, v161, v161 row_mirror row_mask:0xf bank_mask:0xf
    v_add_f32_dpp v162, v162, v162 row_mirror row_mask:0xf bank_mask:0xf
    v_add_f32_dpp v163, v163, v163 row_mirror row_mask:0xf bank_mask:0xf
    v_add_f32_dpp v164, v164, v164 row_mirror row_mask:0xf bank_mask:0xf
    v_add_f32_dpp v165, v165, v165 row_mirror row_mask:0xf bank_mask:0xf
    v_add_f32_dpp v166, v166, v166 row_mirror row_mask:0xf bank_mask:0xf
    v_add_f32_dpp v167, v167, v167 row_mirror row_mask:0xf bank_mask:0xf
    v_rcp_f32 v160, v160
    v_rcp_f32 v161, v161
    v_rcp_f32 v162, v162
    v_rcp_f32 v163, v163
    v_rcp_f32 v164, v164
    v_rcp_f32 v165, v165
    v_rcp_f32 v166, v166
    v_rcp_f32 v167, v167
    s_nop 0
    v_mul_f32 v196, v196, v160
    v_mul_f32 v204, v204, v160
    v_mul_f32 v212, v212, v164
    v_mul_f32 v220, v220, v164
    v_mul_f32 v197, v197, v161
    v_mul_f32 v205, v205, v161
    v_mul_f32 v213, v213, v165
    v_mul_f32 v221, v221, v165
    v_mul_f32 v198, v198, v162
    v_mul_f32 v206, v206, v162
    v_mul_f32 v214, v214, v166
    v_mul_f32 v222, v222, v166
    v_mul_f32 v199, v199, v163
    v_mul_f32 v207, v207, v163
    v_mul_f32 v215, v215, v167
    v_mul_f32 v223, v223, v167
    v_cvt_pk_bf16_f32 v224, v192, v193
    v_cvt_pk_bf16_f32 v225, v194, v195
    v_cvt_pk_bf16_f32 v226, v196, v197
    v_cvt_pk_bf16_f32 v227, v198, v199
    v_cvt_pk_bf16_f32 v228, v200, v201
    v_cvt_pk_bf16_f32 v229, v202, v203
    v_cvt_pk_bf16_f32 v230, v204, v205
    v_cvt_pk_bf16_f32 v231, v206, v207
    v_cvt_pk_bf16_f32 v232, v208, v209
    v_cvt_pk_bf16_f32 v233, v210, v211
    v_cvt_pk_bf16_f32 v234, v212, v213
    v_cvt_pk_bf16_f32 v235, v214, v215
    v_cvt_pk_bf16_f32 v236, v216, v217
    v_cvt_pk_bf16_f32 v237, v218, v219
    v_cvt_pk_bf16_f32 v238, v220, v221
    v_cvt_pk_bf16_f32 v239, v222, v223
    v_mov_b32 v168, s44
    v_cvt_pk_bf16_f32 v240, v144, v145
    v_cvt_pk_bf16_f32 v241, v146, v147
    v_cvt_pk_bf16_f32 v242, v148, v149
    v_cvt_pk_bf16_f32 v243, v150, v151
    v_cvt_pk_bf16_f32 v244, v152, v153
    v_cvt_pk_bf16_f32 v245, v154, v155
    v_cvt_pk_bf16_f32 v246, v156, v157
    v_cvt_pk_bf16_f32 v247, v158, v159
    v_cndmask_b32 v244, v244, v168, s[36:37]
    v_cndmask_b32 v245, v245, v168, s[36:37]
    v_cndmask_b32 v246, v246, v168, s[36:37]
    v_cndmask_b32 v247, v247, v168, s[36:37]
    s_nop 1
    v_mfma_f32_16x16x32_bf16 v[160:163], v[240:243], v[224:227], 0
    v_mfma_f32_16x16x32_bf16 v[164:167], v[240:243], v[228:231], 0
    v_mfma_f32_16x16x32_bf16 v[168:171], v[240:243], v[232:235], 0
    v_mfma_f32_16x16x32_bf16 v[172:175], v[240:243], v[236:239], 0
    v_mfma_f32_16x16x32_bf16 v[176:179], v[244:247], v[224:227], 0
    v_mfma_f32_16x16x32_bf16 v[180:183], v[244:247], v[228:231], 0
    v_mfma_f32_16x16x32_bf16 v[184:187], v[244:247], v[232:235], 0
    v_mfma_f32_16x16x32_bf16 v[188:191], v[244:247], v[236:239], 0
    s_nop 7
    global_atomic_add_f32 v6, v160, s[16:17] offset:0
    global_atomic_add_f32 v6, v161, s[16:17] offset:256
    global_atomic_add_f32 v6, v162, s[16:17] offset:512
    global_atomic_add_f32 v6, v163, s[16:17] offset:768
    global_atomic_add_f32 v6, v164, s[16:17] offset:64
    global_atomic_add_f32 v6, v165, s[16:17] offset:320
    global_atomic_add_f32 v6, v166, s[16:17] offset:576
    global_atomic_add_f32 v6, v167, s[16:17] offset:832
    global_atomic_add_f32 v6, v168, s[16:17] offset:128
    global_atomic_add_f32 v6, v169, s[16:17] offset:384
    global_atomic_add_f32 v6, v170, s[16:17] offset:640
    global_atomic_add_f32 v6, v171, s[16:17] offset:896
    global_atomic_add_f32 v6, v172, s[16:17] offset:192
    global_atomic_add_f32 v6, v173, s[16:17] offset:448
    global_atomic_add_f32 v6, v174, s[16:17] offset:704
    global_atomic_add_f32 v6, v175, s[16:17] offset:960
    global_atomic_add_f32 v7, v176, s[16:17] offset:0
    global_atomic_add_f32 v7, v177, s[16:17] offset:256
    global_atomic_add_f32 v7, v178, s[16:17] offset:512
    global_atomic_add_f32 v7, v179, s[16:17] offset:768
    global_atomic_add_f32 v7, v180, s[16:17] offset:64
    global_atomic_add_f32 v7, v181, s[16:17] offset:320
    global_atomic_add_f32 v7, v182, s[16:17] offset:576
    global_atomic_add_f32 v7, v183, s[16:17] offset:832
    global_atomic_add_f32 v7, v184, s[16:17] offset:128
    global_atomic_add_f32 v7, v185, s[16:17] offset:384
    global_atomic_add_f32 v7, v186, s[16:17] offset:640
    global_atomic_add_f32 v7, v187, s[16:17] offset:896
    global_atomic_add_f32 v7, v188, s[16:17] offset:192
    global_atomic_add_f32 v7, v189, s[16:17] offset:448
    global_atomic_add_f32 v7, v190, s[16:17] offset:704
    global_atomic_add_f32 v7, v191, s[16:17] offset:960

    s_add_u32 s14, s14, 1
    s_cmp_lt_u32 s14, 4
    s_cbranch_scc1 A1_loop
    s_waitcnt vmcnt(0)
    s_barrier
    v_mov_b32 v5, 16
    s_cmp_lg_u32 s3, 0
    s_cbranch_scc1 A_bw
    v_mov_b32 v10, 1
    s_mov_b64 exec, 1
    global_atomic_add v5, v10, s[6:7]
    s_mov_b64 exec, -1
A_bw:
    global_load_dword v10, v5, s[6:7] sc1
    s_waitcnt vmcnt(0)
    v_readfirstlane_b32 s28, v10
    s_cmp_ge_u32 s28, 64
    s_cbranch_scc1 A_bok
    s_sleep 8
    s_sub_u32 s15, s15, 1
    s_cbranch_scc1 M_end
    s_branch A_bw
A_bok:
    s_mov_b32 s14, 0

A2_loop:

    s_lshl_b32 s27, s3, 2
    s_add_u32 s27, s27, s14
    s_mul_i32 s28, s27, 28672
    s_add_u32 s29, s28, 0xc80000
    s_add_u32 s30, s4, s29
    s_addc_u32 s31, s5, 0
    s_lshl_b32 s28, s27, 13
    s_add_u32 s28, s28, 0x1104000
    s_add_u32 s16, s4, s28
    s_addc_u32 s17, s5, 0
    v_mov_b32 v5, v2

    global_load_dwordx4 a[0:3], v5, s[30:31] offset:0
    global_load_dwordx4 a[4:7], v5, s[30:31] offset:1024
    global_load_dwordx4 a[8:11], v5, s[30:31] offset:2048
    global_load_dwordx4 a[12:15], v5, s[30:31] offset:3072
    v_add_u32 v5, 4096, v5
    global_load_dwordx4 a[16:19], v5, s[30:31] offset:0
    global_load_dwordx4 a[20:23], v5, s[30:31] offset:1024
    global_load_dwordx4 a[24:27], v5, s[30:31] offset:2048
    global_load_dwordx4 a[28:31], v5, s[30:31] offset:3072
    v_add_u32 v5, 4096, v5
    global_load_dwordx4 a[32:35], v5, s[30:31] offset:0
    global_load_dwordx4 a[36:39], v5, s[30:31] offset:1024
    global_load_dwordx4 a[40:43], v5, s[30:31] offset:2048
    global_load_dwordx4 a[44:47], v5, s[30:31] offset:3072
    v_add_u32 v5, 4096, v5
    global_load_dwordx4 a[48:51], v5, s[30:31] offset:0
    global_load_dwordx4 a[52:55], v5, s[30:31] offset:1024
    global_load_dwordx4 a[56:59], v5, s[30:31] offset:2048
    global_load_dwordx4 a[60:63], v5, s[30:31] offset:3072
    v_add_u32 v5, 4096, v5
    global_load_dwordx4 a[64:67], v5, s[30:31] offset:0
    global_load_dwordx4 a[68:71], v5, s[30:31] offset:1024
    global_load_dwordx4 a[72:75], v5, s[30:31] offset:2048
    global_load_dwordx4 a[76:79], v5, s[30:31] offset:3072
    v_add_u32 v5, 4096, v5
    global_load_dwordx4 a[80:83], v5, s[30:31] offset:0
    global_load_dwordx4 a[84:87], v5, s[30:31] offset:1024
    global_load_dwordx4 a[88:91], v5, s[30:31] offset:2048
    global_load_dwordx4 a[92:95], v5, s[30:31] offset:3072
    v_add_u32 v5, 4096, v5
    global_load_dwordx4 a[96:99], v5, s[30:31] offset:0
    global_load_dwordx4 a[100:103], v5, s[30:31] offset:1024
    global_load_dwordx4 a[104:107], v5, s[30:31] offset:2048
    global_load_dwordx4 a[108:111], v5, s[30:31] offset:3072
    v_add_u32 v5, 4096, v5
    global_load_dwordx4 v[192:195], v8, s[16:17] offset:0 sc1
    global_load_dwordx4 v[196:199], v8, s[16:17] offset:64 sc1
    global_load_dwordx4 v[200:203], v8, s[16:17] offset:128 sc1
    global_load_dwordx4 v[204:207], v8, s[16:17] offset:192 sc1
    global_load_dwordx4 v[208:211], v9, s[16:17] offset:0 sc1
    global_load_dwordx4 v[212:215], v9, s[16:17] offset:64 sc1
    global_load_dwordx4 v[216:219], v9, s[16:17] offset:128 sc1
    global_load_dwordx4 v[220:223], v9, s[16:17] offset:192 sc1
    s_waitcnt vmcnt(0)
    v_mfma_f32_16x16x32_bf16 v[128:131], a[0:3], v[16:19], 0
    v_mfma_f32_16x16x32_bf16 v[132:135], a[0:3], v[72:75], 0
    v_mfma_f32_16x16x32_bf16 v[136:139], a[56:59], v[16:19], 0
    v_mfma_f32_16x16x32_bf16 v[140:143], a[56:59], v[72:75], 0
    v_mfma_f32_16x16x32_bf16 v[128:131], a[4:7], v[20:23], v[128:131]
    v_mfma_f32_16x16x32_bf16 v[132:135], a[4:7], v[76:79], v[132:135]
    v_mfma_f32_16x16x32_bf16 v[136:139], a[60:63], v[20:23], v[136:139]
    v_mfma_f32_16x16x32_bf16 v[140:143], a[60:63], v[76:79], v[140:143]
    v_mfma_f32_16x16x32_bf16 v[128:131], a[8:11], v[24:27], v[128:131]
    v_mfma_f32_16x16x32_bf16 v[132:135], a[8:11], v[80:83], v[132:135]
    v_mfma_f32_16x16x32_bf16 v[136:139], a[64:67], v[24:27], v[136:139]
    v_mfma_f32_16x16x32_bf16 v[140:143], a[64:67], v[80:83], v[140:143]
    v_mfma_f32_16x16x32_bf16 v[128:131], a[12:15], v[28:31], v[128:131]
    v_mfma_f32_16x16x32_bf16 v[132:135], a[12:15], v[84:87], v[132:135]
    v_mfma_f32_16x16x32_bf16 v[136:139], a[68:71], v[28:31], v[136:139]
    v_mfma_f32_16x16x32_bf16 v[140:143], a[68:71], v[84:87], v[140:143]
    v_mfma_f32_16x16x32_bf16 v[128:131], a[16:19], v[32:35], v[128:131]
    v_mfma_f32_16x16x32_bf16 v[132:135], a[16:19], v[88:91], v[132:135]
    v_mfma_f32_16x16x32_bf16 v[136:139], a[72:75], v[32:35], v[136:139]
    v_mfma_f32_16x16x32_bf16 v[140:143], a[72:75], v[88:91], v[140:143]
    v_mfma_f32_16x16x32_bf16 v[128:131], a[20:23], v[36:39], v[128:131]
    v_mfma_f32_16x16x32_bf16 v[132:135], a[20:23], v[92:95], v[132:135]
    v_mfma_f32_16x16x32_bf16 v[136:139], a[76:79], v[36:39], v[136:139]
    v_mfma_f32_16x16x32_bf16 v[140:143], a[76:79], v[92:95], v[140:143]
    v_mfma_f32_16x16x32_bf16 v[128:131], a[24:27], v[40:43], v[128:131]
    v_mfma_f32_16x16x32_bf16 v[132:135], a[24:27], v[96:99], v[132:135]
    v_mfma_f32_16x16x32_bf16 v[136:139], a[80:83], v[40:43], v[136:139]
    v_mfma_f32_16x16x32_bf16 v[140:143], a[80:83], v[96:99], v[140:143]
    v_mfma_f32_16x16x32_bf16 v[128:131], a[28:31], v[44:47], v[128:131]
    v_mfma_f32_16x16x32_bf16 v[132:135], a[28:31], v[100:103], v[132:135]
    v_mfma_f32_16x16x32_bf16 v[136:139], a[84:87], v[44:47], v[136:139]
    v_mfma_f32_16x16x32_bf16 v[140:143], a[84:87], v[100:103], v[140:143]
    v_mfma_f32_16x16x32_bf16 v[128:131], a[32:35], v[48:51], v[128:131]
    v_mfma_f32_16x16x32_bf16 v[132:135], a[32:35], v[104:107], v[132:135]
    v_mfma_f32_16x16x32_bf16 v[136:139], a[88:91], v[48:51], v[136:139]
    v_mfma_f32_16x16x32_bf16 v[140:143], a[88:91], v[104:107], v[140:143]
    v_mfma_f32_16x16x32_bf16 v[128:131], a[36:39], v[52:55], v[128:131]
    v_mfma_f32_16x16x32_bf16 v[132:135], a[36:39], v[108:111], v[132:135]
    v_mfma_f32_16x16x32_bf16 v[136:139], a[92:95], v[52:55], v[136:139]
    v_mfma_f32_16x16x32_bf16 v[140:143], a[92:95], v[108:111], v[140:143]
    v_mfma_f32_16x16x32_bf16 v[128:131], a[40:43], v[56:59], v[128:131]
    v_mfma_f32_16x16x32_bf16 v[132:135], a[40:43], v[112:115], v[132:135]
    v_mfma_f32_16x16x32_bf16 v[136:139], a[96:99], v[56:59], v[136:139]
    v_mfma_f32_16x16x32_bf16 v[140:143], a[96:99], v[112:115], v[140:143]
    v_mfma_f32_16x16x32_bf16 v[128:131], a[44:47], v[60:63], v[128:131]
    v_mfma_f32_16x16x32_bf16 v[132:135], a[44:47], v[116:119], v[132:135]
    v_mfma_f32_16x16x32_bf16 v[136:139], a[100:103], v[60:63], v[136:139]
    v_mfma_f32_16x16x32_bf16 v[140:143], a[100:103], v[116:119], v[140:143]
    v_mfma_f32_16x16x32_bf16 v[128:131], a[48:51], v[64:67], v[128:131]
    v_mfma_f32_16x16x32_bf16 v[132:135], a[48:51], v[120:123], v[132:135]
    v_mfma_f32_16x16x32_bf16 v[136:139], a[104:107], v[64:67], v[136:139]
    v_mfma_f32_16x16x32_bf16 v[140:143], a[104:107], v[120:123], v[140:143]
    v_mfma_f32_16x16x32_bf16 v[128:131], a[52:55], v[68:71], v[128:131]
    v_mfma_f32_16x16x32_bf16 v[132:135], a[52:55], v[124:127], v[132:135]
    v_mfma_f32_16x16x32_bf16 v[136:139], a[108:111], v[68:71], v[136:139]
    v_mfma_f32_16x16x32_bf16 v[140:143], a[108:111], v[124:127], v[140:143]
    v_cvt_pk_bf16_f32 v224, v192, v193
    v_cvt_pk_bf16_f32 v225, v194, v195
    v_cvt_pk_bf16_f32 v226, v196, v197
    v_cvt_pk_bf16_f32 v227, v198, v199
    v_cvt_pk_bf16_f32 v228, v200, v201
    v_cvt_pk_bf16_f32 v229, v202, v203
    v_cvt_pk_bf16_f32 v230, v204, v205
    v_cvt_pk_bf16_f32 v231, v206, v207
    v_cvt_pk_bf16_f32 v232, v208, v209
    v_cvt_pk_bf16_f32 v233, v210, v211
    v_cvt_pk_bf16_f32 v234, v212, v213
    v_cvt_pk_bf16_f32 v235, v214, v215
    v_cvt_pk_bf16_f32 v236, v216, v217
    v_cvt_pk_bf16_f32 v237, v218, v219
    v_cvt_pk_bf16_f32 v238, v220, v221
    v_cvt_pk_bf16_f32 v239, v222, v223
    v_max3_f32 v176, v136, v137, v138
    v_max_f32 v176, v176, v139
    v_min3_f32 v178, v136, v137, v138
    v_min_f32 v178, v178, v139
    v_mov_b32 v184, s42
    v_mov_b32 v185, s43
    v_cndmask_b32 v176, v184, v176, s[38:39]
    v_cndmask_b32 v178, v185, v178, s[38:39]
    v_max3_f32 v176, v176, v128, v129
    v_max3_f32 v176, v176, v130, v131
    v_min3_f32 v178, v178, v128, v129
    v_min3_f32 v178, v178, v130, v131
    v_max3_f32 v177, v140, v141, v142
    v_max_f32 v177, v177, v143
    v_min3_f32 v179, v140, v141, v142
    v_min_f32 v179, v179, v143
    v_mov_b32 v184, s42
    v_mov_b32 v185, s43
    v_cndmask_b32 v177, v184, v177, s[38:39]
    v_cndmask_b32 v179, v185, v179, s[38:39]
    v_max3_f32 v177, v177, v132, v133
    v_max3_f32 v177, v177, v134, v135
    v_min3_f32 v179, v179, v132, v133
    v_min3_f32 v179, v179, v134, v135
    v_mov_b32 v184, v176
    v_mov_b32 v185, v177
    s_nop 1
    v_permlane16_swap_b32 v176, v184
    v_permlane16_swap_b32 v177, v185
    s_nop 1
    v_max_f32 v176, v176, v184
    v_max_f32 v177, v177, v185
    v_mov_b32 v184, v176
    v_mov_b32 v185, v177
    s_nop 1
    v_permlane32_swap_b32 v176, v184
    v_permlane32_swap_b32 v177, v185
    s_nop 1
    v_max_f32 v176, v176, v184
    v_max_f32 v177, v177, v185
    v_mov_b32 v184, v178
    v_mov_b32 v185, v179
    s_nop 1
    v_permlane16_swap_b32 v178, v184
    v_permlane16_swap_b32 v179, v185
    s_nop 1
    v_min_f32 v178, v178, v184
    v_min_f32 v179, v179, v185
    v_mov_b32 v184, v178
    v_mov_b32 v185, v179
    s_nop 1
    v_permlane32_swap_b32 v178, v184
    v_permlane32_swap_b32 v179, v185
    s_nop 1
    v_min_f32 v178, v178, v184
    v_min_f32 v179, v179, v185
    v_sub_f32 v144, v128, v176
    v_sub_f32 v160, v178, v128
    v_sub_f32 v145, v129, v176
    v_sub_f32 v161, v178, v129
    v_sub_f32 v146, v130, v176
    v_sub_f32 v162, v178, v130
    v_sub_f32 v147, v131, v176
    v_sub_f32 v163, v178, v131
    v_sub_f32 v148, v136, v176
    v_sub_f32 v164, v178, v136
    v_sub_f32 v149, v137, v176
    v_sub_f32 v165, v178, v137
    v_sub_f32 v150, v138, v176
    v_sub_f32 v166, v178, v138
    v_sub_f32 v151, v139, v176
    v_sub_f32 v167, v178, v139
    v_sub_f32 v152, v132, v177
    v_sub_f32 v168, v179, v132
    v_sub_f32 v153, v133, v177
    v_sub_f32 v169, v179, v133
    v_sub_f32 v154, v134, v177
    v_sub_f32 v170, v179, v134
    v_sub_f32 v155, v135, v177
    v_sub_f32 v171, v179, v135
    v_sub_f32 v156, v140, v177
    v_sub_f32 v172, v179, v140
    v_sub_f32 v157, v141, v177
    v_sub_f32 v173, v179, v141
    v_sub_f32 v158, v142, v177
    v_sub_f32 v174, v179, v142
    v_sub_f32 v159, v143, v177
    v_sub_f32 v175, v179, v143
    v_exp_f32 v144, v144
    v_exp_f32 v145, v145
    v_exp_f32 v146, v146
    v_exp_f32 v147, v147
    v_exp_f32 v148, v148
    v_exp_f32 v149, v149
    v_exp_f32 v150, v150
    v_exp_f32 v151, v151
    v_exp_f32 v152, v152
    v_exp_f32 v153, v153
    v_exp_f32 v154, v154
    v_exp_f32 v155, v155
    v_exp_f32 v156, v156
    v_exp_f32 v157, v157
    v_exp_f32 v158, v158
    v_exp_f32 v159, v159
    v_exp_f32 v160, v160
    v_exp_f32 v161, v161
    v_exp_f32 v162, v162
    v_exp_f32 v163, v163
    v_exp_f32 v164, v164
    v_exp_f32 v165, v165
    v_exp_f32 v166, v166
    v_exp_f32 v167, v167
    v_exp_f32 v168, v168
    v_exp_f32 v169, v169
    v_exp_f32 v170, v170
    v_exp_f32 v171, v171
    v_exp_f32 v172, v172
    v_exp_f32 v173, v173
    v_exp_f32 v174, v174
    v_exp_f32 v175, v175
    s_nop 0
    v_cndmask_b32 v148, 0, v148, s[38:39]
    v_cndmask_b32 v164, 0, v164, s[38:39]
    v_cndmask_b32 v149, 0, v149, s[38:39]
    v_cndmask_b32 v165, 0, v165, s[38:39]
    v_cndmask_b32 v150, 0, v150, s[38:39]
    v_cndmask_b32 v166, 0, v166, s[38:39]
    v_cndmask_b32 v151, 0, v151, s[38:39]
    v_cndmask_b32 v167, 0, v167, s[38:39]
    v_cndmask_b32 v156, 0, v156, s[38:39]
    v_cndmask_b32 v172, 0, v172, s[38:39]
    v_cndmask_b32 v157, 0, v157, s[38:39]
    v_cndmask_b32 v173, 0, v173, s[38:39]
    v_cndmask_b32 v158, 0, v158, s[38:39]
    v_cndmask_b32 v174, 0, v174, s[38:39]
    v_cndmask_b32 v159, 0, v159, s[38:39]
    v_cndmask_b32 v175, 0, v175, s[38:39]
    v_add_f32 v176, v144, v145
    v_add_f32 v176, v176, v146
    v_add_f32 v176, v176, v147
    v_add_f32 v176, v176, v148
    v_add_f32 v176, v176, v149
    v_add_f32 v176, v176, v150
    v_add_f32 v176, v176, v151
    v_add_f32 v178, v160, v161
    v_add_f32 v178, v178, v162
    v_add_f32 v178, v178, v163
    v_add_f32 v178, v178, v164
    v_add_f32 v178, v178, v165
    v_add_f32 v178, v178, v166
    v_add_f32 v178, v178, v167
    v_add_f32 v177, v152, v153
    v_add_f32 v177, v177, v154
    v_add_f32 v177, v177, v155
    v_add_f32 v177, v177, v156
    v_add_f32 v177, v177, v157
    v_add_f32 v177, v177, v158
    v_add_f32 v177, v177, v159
    v_add_f32 v179, v168, v169
    v_add_f32 v179, v179, v170
    v_add_f32 v179, v179, v171
    v_add_f32 v179, v179, v172
    v_add_f32 v179, v179, v173
    v_add_f32 v179, v179, v174
    v_add_f32 v179, v179, v175
    v_mov_b32 v184, v176
    v_mov_b32 v185, v177
    v_mov_b32 v186, v178
    v_mov_b32 v187, v179
    s_nop 1
    v_permlane16_swap_b32 v176, v184
    v_permlane16_swap_b32 v177, v185
    v_permlane16_swap_b32 v178, v186
    v_permlane16_swap_b32 v179, v187
    s_nop 1
    v_add_f32 v176, v176, v184
    v_add_f32 v177, v177, v185
    v_add_f32 v178, v178, v186
    v_add_f32 v179, v179, v187
    v_mov_b32 v184, v176
    v_mov_b32 v185, v177
    v_mov_b32 v186, v178
    v_mov_b32 v187, v179
    s_nop 1
    v_permlane32_swap_b32 v176, v184
    v_permlane32_swap_b32 v177, v185
    v_permlane32_swap_b32 v178, v186
    v_permlane32_swap_b32 v179, v187
    s_nop 1
    v_add_f32 v176, v176, v184
    v_add_f32 v177, v177, v185
    v_add_f32 v178, v178, v186
    v_add_f32 v179, v179, v187
    v_rcp_f32 v176, v176
    v_rcp_f32 v177, v177
    v_rcp_f32 v178, v178
    v_rcp_f32 v179, v179
    s_nop 0
    v_mul_f32 v144, v144, v176
    v_mul_f32 v160, v160, v178
    v_mul_f32 v145, v145, v176
    v_mul_f32 v161, v161, v178
    v_mul_f32 v146, v146, v176
    v_mul_f32 v162, v162, v178
    v_mul_f32 v147, v147, v176
    v_mul_f32 v163, v163, v178
    v_mul_f32 v148, v148, v176
    v_mul_f32 v164, v164, v178
    v_mul_f32 v149, v149, v176
    v_mul_f32 v165, v165, v178
    v_mul_f32 v150, v150, v176
    v_mul_f32 v166, v166, v178
    v_mul_f32 v151, v151, v176
    v_mul_f32 v167, v167, v178
    v_mul_f32 v152, v152, v177
    v_mul_f32 v168, v168, v179
    v_mul_f32 v153, v153, v177
    v_mul_f32 v169, v169, v179
    v_mul_f32 v154, v154, v177
    v_mul_f32 v170, v170, v179
    v_mul_f32 v155, v155, v177
    v_mul_f32 v171, v171, v179
    v_mul_f32 v156, v156, v177
    v_mul_f32 v172, v172, v179
    v_mul_f32 v157, v157, v177
    v_mul_f32 v173, v173, v179
    v_mul_f32 v158, v158, v177
    v_mul_f32 v174, v174, v179
    v_mul_f32 v159, v159, v177
    v_mul_f32 v175, v175, v179
    v_cvt_pk_bf16_f32 v240, v144, v145
    v_cvt_pk_bf16_f32 v241, v146, v147
    v_cvt_pk_bf16_f32 v242, v148, v149
    v_cvt_pk_bf16_f32 v243, v150, v151
    v_cvt_pk_bf16_f32 v244, v152, v153
    v_cvt_pk_bf16_f32 v245, v154, v155
    v_cvt_pk_bf16_f32 v246, v156, v157
    v_cvt_pk_bf16_f32 v247, v158, v159
    v_cvt_pk_bf16_f32 v248, v160, v161
    v_cvt_pk_bf16_f32 v249, v162, v163
    v_cvt_pk_bf16_f32 v250, v164, v165
    v_cvt_pk_bf16_f32 v251, v166, v167
    v_cvt_pk_bf16_f32 v252, v168, v169
    v_cvt_pk_bf16_f32 v253, v170, v171
    v_cvt_pk_bf16_f32 v254, v172, v173
    v_cvt_pk_bf16_f32 v255, v174, v175
    s_nop 1
    v_mfma_f32_16x16x32_bf16 v[192:195], v[224:227], v[240:243], 0
    v_mfma_f32_16x16x32_bf16 v[196:199], v[224:227], v[244:247], 0
    v_mfma_f32_16x16x32_bf16 v[200:203], v[232:235], v[240:243], 0
    v_mfma_f32_16x16x32_bf16 v[204:207], v[232:235], v[244:247], 0
    v_mfma_f32_16x16x32_bf16 v[192:195], v[228:231], v[248:251], v[192:195]
    v_mfma_f32_16x16x32_bf16 v[196:199], v[228:231], v[252:255], v[196:199]
    v_mfma_f32_16x16x32_bf16 v[200:203], v[236:239], v[248:251], v[200:203]
    v_mfma_f32_16x16x32_bf16 v[204:207], v[236:239], v[252:255], v[204:207]
    s_nop 7
    v_cndmask_b32 v176, 0, v200, s[40:41]
    v_cndmask_b32 v177, 0, v204, s[40:41]
    v_mov_b32 v184, v176
    v_mov_b32 v185, v177
    s_nop 1
    v_permlane16_swap_b32 v176, v184
    v_permlane16_swap_b32 v177, v185
    s_nop 1
    v_add_f32 v176, v176, v184
    v_add_f32 v177, v177, v185
    v_mov_b32 v184, v176
    v_mov_b32 v185, v177
    s_nop 1
    v_permlane32_swap_b32 v176, v184
    v_permlane32_swap_b32 v177, v185
    s_nop 1
    v_add_f32 v176, v176, v184
    v_add_f32 v177, v177, v185
    v_add_f32 v176, s45, v176
    v_add_f32 v177, s45, v177
    v_rcp_f32 v176, v176
    v_rcp_f32 v177, v177
    s_nop 0
    v_mul_f32 v192, v192, v176
    v_mul_f32 v193, v193, v176
    v_mul_f32 v194, v194, v176
    v_mul_f32 v195, v195, v176
    v_mul_f32 v200, v200, v176
    v_mul_f32 v201, v201, v176
    v_mul_f32 v202, v202, v176
    v_mul_f32 v203, v203, v176
    v_cvt_pk_bf16_f32 v208, v192, v193
    v_cvt_pk_bf16_f32 v209, v194, v195
    v_cvt_pk_bf16_f32 v210, v200, v201
    v_cvt_pk_bf16_f32 v211, v202, v203
    v_mul_f32 v196, v196, v177
    v_mul_f32 v197, v197, v177
    v_mul_f32 v198, v198, v177
    v_mul_f32 v199, v199, v177
    v_mul_f32 v204, v204, v177
    v_mul_f32 v205, v205, v177
    v_mul_f32 v206, v206, v177
    v_mul_f32 v207, v207, v177
    v_cvt_pk_bf16_f32 v212, v196, v197
    v_cvt_pk_bf16_f32 v213, v198, v199
    v_cvt_pk_bf16_f32 v214, v204, v205
    v_cvt_pk_bf16_f32 v215, v206, v207

    s_lshl_b32 s28, s27, 11
    v_add_u32 v5, s28, v2
    ds_write_b128 v5, v[208:211]
    ds_write_b128 v5, v[212:215] offset:1024
    s_add_u32 s14, s14, 1
    s_cmp_lt_u32 s14, 4
    s_waitcnt lgkmcnt(0)
    s_cbranch_scc1 A2_loop
    s_barrier

    ds_read_b128 v[16:19], v2 offset:0
    ds_read_b128 v[20:23], v2 offset:1024
    ds_read_b128 v[24:27], v2 offset:2048
    ds_read_b128 v[28:31], v2 offset:3072
    ds_read_b128 v[32:35], v2 offset:4096
    ds_read_b128 v[36:39], v2 offset:5120
    ds_read_b128 v[40:43], v2 offset:6144
    ds_read_b128 v[44:47], v2 offset:7168
    ds_read_b128 v[48:51], v2 offset:8192
    ds_read_b128 v[52:55], v2 offset:9216
    ds_read_b128 v[56:59], v2 offset:10240
    ds_read_b128 v[60:63], v2 offset:11264
    ds_read_b128 v[64:67], v2 offset:12288
    ds_read_b128 v[68:71], v2 offset:13312
    ds_read_b128 v[72:75], v2 offset:14336
    ds_read_b128 v[76:79], v2 offset:15360
    ds_read_b128 v[80:83], v2 offset:16384
    ds_read_b128 v[84:87], v2 offset:17408
    ds_read_b128 v[88:91], v2 offset:18432
    ds_read_b128 v[92:95], v2 offset:19456
    ds_read_b128 v[96:99], v2 offset:20480
    ds_read_b128 v[100:103], v2 offset:21504
    ds_read_b128 v[104:107], v2 offset:22528
    ds_read_b128 v[108:111], v2 offset:23552
    ds_read_b128 v[112:115], v2 offset:24576
    ds_read_b128 v[116:119], v2 offset:25600
    ds_read_b128 v[120:123], v2 offset:26624
    ds_read_b128 v[124:127], v2 offset:27648
    ds_read_b128 v[128:131], v2 offset:28672
    ds_read_b128 v[132:135], v2 offset:29696
    ds_read_b128 v[136:139], v2 offset:30720
    ds_read_b128 v[140:143], v2 offset:31744

    v_mul_u32_u24 v3, 1792, v12
    v_lshl_add_u32 v3, v11, 3, v3
    s_mul_i32 s28, s26, 57344
    s_mul_i32 s29, s3, 224
    s_add_u32 s28, s28, s29
    v_add_u32 v3, s28, v3
    v_add_u32 v4, 28672, v3
    s_mul_i32 s28, s3, 7*16384
    s_add_u32 s28, s28, 0xe00000
    s_add_u32 s30, s4, s28
    s_addc_u32 s31, s5, 0
    v_mov_b32 v5, v2

    global_load_dwordx4 a[0:3], v5, s[30:31] offset:0
    global_load_dwordx4 a[4:7], v5, s[30:31] offset:1024
    global_load_dwordx4 a[8:11], v5, s[30:31] offset:2048
    global_load_dwordx4 a[12:15], v5, s[30:31] offset:3072
    v_add_u32 v5, 4096, v5
    global_load_dwordx4 a[16:19], v5, s[30:31] offset:0
    global_load_dwordx4 a[20:23], v5, s[30:31] offset:1024
    global_load_dwordx4 a[24:27], v5, s[30:31] offset:2048
    global_load_dwordx4 a[28:31], v5, s[30:31] offset:3072
    v_add_u32 v5, 4096, v5
    global_load_dwordx4 a[32:35], v5, s[30:31] offset:0
    global_load_dwordx4 a[36:39], v5, s[30:31] offset:1024
    global_load_dwordx4 a[40:43], v5, s[30:31] offset:2048
    global_load_dwordx4 a[44:47], v5, s[30:31] offset:3072
    v_add_u32 v5, 4096, v5
    global_load_dwordx4 a[48:51], v5, s[30:31] offset:0
    global_load_dwordx4 a[52:55], v5, s[30:31] offset:1024
    global_load_dwordx4 a[56:59], v5, s[30:31] offset:2048
    global_load_dwordx4 a[60:63], v5, s[30:31] offset:3072
    v_add_u32 v5, 4096, v5
    global_load_dwordx4 a[64:67], v5, s[30:31] offset:0
    global_load_dwordx4 a[68:71], v5, s[30:31] offset:1024
    global_load_dwordx4 a[72:75], v5, s[30:31] offset:2048
    global_load_dwordx4 a[76:79], v5, s[30:31] offset:3072
    v_add_u32 v5, 4096, v5
    global_load_dwordx4 a[80:83], v5, s[30:31] offset:0
    global_load_dwordx4 a[84:87], v5, s[30:31] offset:1024
    global_load_dwordx4 a[88:91], v5, s[30:31] offset:2048
    global_load_dwordx4 a[92:95], v5, s[30:31] offset:3072
    v_add_u32 v5, 4096, v5
    global_load_dwordx4 a[96:99], v5, s[30:31] offset:0
    global_load_dwordx4 a[100:103], v5, s[30:31] offset:1024
    global_load_dwordx4 a[104:107], v5, s[30:31] offset:2048
    global_load_dwordx4 a[108:111], v5, s[30:31] offset:3072
    v_add_u32 v5, 4096, v5
    global_load_dwordx4 a[112:115], v5, s[30:31] offset:0
    global_load_dwordx4 a[116:119], v5, s[30:31] offset:1024
    global_load_dwordx4 a[120:123], v5, s[30:31] offset:2048
    global_load_dwordx4 a[124:127], v5, s[30:31] offset:3072
    v_add_u32 v5, 4096, v5
    global_load_dwordx4 a[128:131], v5, s[30:31] offset:0
    global_load_dwordx4 a[132:135], v5, s[30:31] offset:1024
    global_load_dwordx4 a[136:139], v5, s[30:31] offset:2048
    global_load_dwordx4 a[140:143], v5, s[30:31] offset:3072
    v_add_u32 v5, 4096, v5
    global_load_dwordx4 a[144:147], v5, s[30:31] offset:0
    global_load_dwordx4 a[148:151], v5, s[30:31] offset:1024
    global_load_dwordx4 a[152:155], v5, s[30:31] offset:2048
    global_load_dwordx4 a[156:159], v5, s[30:31] offset:3072
    v_add_u32 v5, 4096, v5
    global_load_dwordx4 a[160:163], v5, s[30:31] offset:0
    global_load_dwordx4 a[164:167], v5, s[30:31] offset:1024
    global_load_dwordx4 a[168:171], v5, s[30:31] offset:2048
    global_load_dwordx4 a[172:175], v5, s[30:31] offset:3072
    v_add_u32 v5, 4096, v5
    global_load_dwordx4 a[176:179], v5, s[30:31] offset:0
    global_load_dwordx4 a[180:183], v5, s[30:31] offset:1024
    global_load_dwordx4 a[184:187], v5, s[30:31] offset:2048
    global_load_dwordx4 a[188:191], v5, s[30:31] offset:3072
    v_add_u32 v5, 4096, v5
    global_load_dwordx4 a[192:195], v5, s[30:31] offset:0
    global_load_dwordx4 a[196:199], v5, s[30:31] offset:1024
    global_load_dwordx4 a[200:203], v5, s[30:31] offset:2048
    global_load_dwordx4 a[204:207], v5, s[30:31] offset:3072
    v_add_u32 v5, 4096, v5
    global_load_dwordx4 a[208:211], v5, s[30:31] offset:0
    global_load_dwordx4 a[212:215], v5, s[30:31] offset:1024
    global_load_dwordx4 a[216:219], v5, s[30:31] offset:2048
    global_load_dwordx4 a[220:223], v5, s[30:31] offset:3072
    v_add_u32 v5, 4096, v5
    global_load_dwordx4 a[224:227], v5, s[30:31] offset:0
    global_load_dwordx4 a[228:231], v5, s[30:31] offset:1024
    global_load_dwordx4 a[232:235], v5, s[30:31] offset:2048
    global_load_dwordx4 a[236:239], v5, s[30:31] offset:3072
    v_add_u32 v5, 4096, v5
    global_load_dwordx4 a[240:243], v5, s[30:31] offset:0
    global_load_dwordx4 a[244:247], v5, s[30:31] offset:1024
    global_load_dwordx4 a[248:251], v5, s[30:31] offset:2048
    global_load_dwordx4 a[252:255], v5, s[30:31] offset:3072
    v_add_u32 v5, 4096, v5
    s_waitcnt lgkmcnt(0)
    s_waitcnt vmcnt(0)
    v_mfma_f32_16x16x32_bf16 v[160:163], a[0:3], v[16:19], 0
    v_mfma_f32_16x16x32_bf16 v[164:167], a[0:3], v[20:23], 0
    v_mfma_f32_16x16x32_bf16 v[160:163], a[4:7], v[24:27], v[160:163]
    v_mfma_f32_16x16x32_bf16 v[164:167], a[4:7], v[28:31], v[164:167]
    v_mfma_f32_16x16x32_bf16 v[160:163], a[8:11], v[32:35], v[160:163]
    v_mfma_f32_16x16x32_bf16 v[164:167], a[8:11], v[36:39], v[164:167]
    v_mfma_f32_16x16x32_bf16 v[160:163], a[12:15], v[40:43], v[160:163]
    v_mfma_f32_16x16x32_bf16 v[164:167], a[12:15], v[44:47], v[164:167]
    v_mfma_f32_16x16x32_bf16 v[160:163], a[16:19], v[48:51], v[160:163]
    v_mfma_f32_16x16x32_bf16 v[164:167], a[16:19], v[52:55], v[164:167]
    v_mfma_f32_16x16x32_bf16 v[160:163], a[20:23], v[56:59], v[160:163]
    v_mfma_f32_16x16x32_bf16 v[164:167], a[20:23], v[60:63], v[164:167]
    v_mfma_f32_16x16x32_bf16 v[160:163], a[24:27], v[64:67], v[160:163]
    v_mfma_f32_16x16x32_bf16 v[164:167], a[24:27], v[68:71], v[164:167]
    v_mfma_f32_16x16x32_bf16 v[160:163], a[28:31], v[72:75], v[160:163]
    v_mfma_f32_16x16x32_bf16 v[164:167], a[28:31], v[76:79], v[164:167]
    v_mfma_f32_16x16x32_bf16 v[160:163], a[32:35], v[80:83], v[160:163]
    v_mfma_f32_16x16x32_bf16 v[164:167], a[32:35], v[84:87], v[164:167]
    v_mfma_f32_16x16x32_bf16 v[160:163], a[36:39], v[88:91], v[160:163]
    v_mfma_f32_16x16x32_bf16 v[164:167], a[36:39], v[92:95], v[164:167]
    v_mfma_f32_16x16x32_bf16 v[160:163], a[40:43], v[96:99], v[160:163]
    v_mfma_f32_16x16x32_bf16 v[164:167], a[40:43], v[100:103], v[164:167]
    v_mfma_f32_16x16x32_bf16 v[160:163], a[44:47], v[104:107], v[160:163]
    v_mfma_f32_16x16x32_bf16 v[164:167], a[44:47], v[108:111], v[164:167]
    v_mfma_f32_16x16x32_bf16 v[160:163], a[48:51], v[112:115], v[160:163]
    v_mfma_f32_16x16x32_bf16 v[164:167], a[48:51], v[116:119], v[164:167]
    v_mfma_f32_16x16x32_bf16 v[160:163], a[52:55], v[120:123], v[160:163]
    v_mfma_f32_16x16x32_bf16 v[164:167], a[52:55], v[124:127], v[164:167]
    v_mfma_f32_16x16x32_bf16 v[160:163], a[56:59], v[128:131], v[160:163]
    v_mfma_f32_16x16x32_bf16 v[164:167], a[56:59], v[132:135], v[164:167]
    v_mfma_f32_16x16x32_bf16 v[160:163], a[60:63], v[136:139], v[160:163]
    v_mfma_f32_16x16x32_bf16 v[164:167], a[60:63], v[140:143], v[164:167]
    s_nop 7
    v_cvt_pk_bf16_f32 v168, v160, v161
    v_cvt_pk_bf16_f32 v169, v162, v163
    global_store_dwordx2 v3, v[168:169], s[10:11] offset:0
    v_cvt_pk_bf16_f32 v170, v164, v165
    v_cvt_pk_bf16_f32 v171, v166, v167
    global_store_dwordx2 v4, v[170:171], s[10:11] offset:0
    s_waitcnt vmcnt(0)
    v_mfma_f32_16x16x32_bf16 v[160:163], a[64:67], v[16:19], 0
    v_mfma_f32_16x16x32_bf16 v[164:167], a[64:67], v[20:23], 0
    v_mfma_f32_16x16x32_bf16 v[160:163], a[68:71], v[24:27], v[160:163]
    v_mfma_f32_16x16x32_bf16 v[164:167], a[68:71], v[28:31], v[164:167]
    v_mfma_f32_16x16x32_bf16 v[160:163], a[72:75], v[32:35], v[160:163]
    v_mfma_f32_16x16x32_bf16 v[164:167], a[72:75], v[36:39], v[164:167]
    v_mfma_f32_16x16x32_bf16 v[160:163], a[76:79], v[40:43], v[160:163]
    v_mfma_f32_16x16x32_bf16 v[164:167], a[76:79], v[44:47], v[164:167]
    v_mfma_f32_16x16x32_bf16 v[160:163], a[80:83], v[48:51], v[160:163]
    v_mfma_f32_16x16x32_bf16 v[164:167], a[80:83], v[52:55], v[164:167]
    v_mfma_f32_16x16x32_bf16 v[160:163], a[84:87], v[56:59], v[160:163]
    v_mfma_f32_16x16x32_bf16 v[164:167], a[84:87], v[60:63], v[164:167]
    v_mfma_f32_16x16x32_bf16 v[160:163], a[88:91], v[64:67], v[160:163]
    v_mfma_f32_16x16x32_bf16 v[164:167], a[88:91], v[68:71], v[164:167]
    v_mfma_f32_16x16x32_bf16 v[160:163], a[92:95], v[72:75], v[160:163]
    v_mfma_f32_16x16x32_bf16 v[164:167], a[92:95], v[76:79], v[164:167]
    v_mfma_f32_16x16x32_bf16 v[160:163], a[96:99], v[80:83], v[160:163]
    v_mfma_f32_16x16x32_bf16 v[164:167], a[96:99], v[84:87], v[164:167]
    v_mfma_f32_16x16x32_bf16 v[160:163], a[100:103], v[88:91], v[160:163]
    v_mfma_f32_16x16x32_bf16 v[164:167], a[100:103], v[92:95], v[164:167]
    v_mfma_f32_16x16x32_bf16 v[160:163], a[104:107], v[96:99], v[160:163]
    v_mfma_f32_16x16x32_bf16 v[164:167], a[104:107], v[100:103], v[164:167]
    v_mfma_f32_16x16x32_bf16 v[160:163], a[108:111], v[104:107], v[160:163]
    v_mfma_f32_16x16x32_bf16 v[164:167], a[108:111], v[108:111], v[164:167]
    v_mfma_f32_16x16x32_bf16 v[160:163], a[112:115], v[112:115], v[160:163]
    v_mfma_f32_16x16x32_bf16 v[164:167], a[112:115], v[116:119], v[164:167]
    v_mfma_f32_16x16x32_bf16 v[160:163], a[116:119], v[120:123], v[160:163]
    v_mfma_f32_16x16x32_bf16 v[164:167], a[116:119], v[124:127], v[164:167]
    v_mfma_f32_16x16x32_bf16 v[160:163], a[120:123], v[128:131], v[160:163]
    v_mfma_f32_16x16x32_bf16 v[164:167], a[120:123], v[132:135], v[164:167]
    v_mfma_f32_16x16x32_bf16 v[160:163], a[124:127], v[136:139], v[160:163]
    v_mfma_f32_16x16x32_bf16 v[164:167], a[124:127], v[140:143], v[164:167]
    s_nop 7
    v_cvt_pk_bf16_f32 v168, v160, v161
    v_cvt_pk_bf16_f32 v169, v162, v163
    global_store_dwordx2 v3, v[168:169], s[10:11] offset:32
    v_cvt_pk_bf16_f32 v170, v164, v165
    v_cvt_pk_bf16_f32 v171, v166, v167
    global_store_dwordx2 v4, v[170:171], s[10:11] offset:32
    s_waitcnt vmcnt(0)
    v_mfma_f32_16x16x32_bf16 v[160:163], a[128:131], v[16:19], 0
    v_mfma_f32_16x16x32_bf16 v[164:167], a[128:131], v[20:23], 0
    v_mfma_f32_16x16x32_bf16 v[160:163], a[132:135], v[24:27], v[160:163]
    v_mfma_f32_16x16x32_bf16 v[164:167], a[132:135], v[28:31], v[164:167]
    v_mfma_f32_16x16x32_bf16 v[160:163], a[136:139], v[32:35], v[160:163]
    v_mfma_f32_16x16x32_bf16 v[164:167], a[136:139], v[36:39], v[164:167]
    v_mfma_f32_16x16x32_bf16 v[160:163], a[140:143], v[40:43], v[160:163]
    v_mfma_f32_16x16x32_bf16 v[164:167], a[140:143], v[44:47], v[164:167]
    v_mfma_f32_16x16x32_bf16 v[160:163], a[144:147], v[48:51], v[160:163]
    v_mfma_f32_16x16x32_bf16 v[164:167], a[144:147], v[52:55], v[164:167]
    v_mfma_f32_16x16x32_bf16 v[160:163], a[148:151], v[56:59], v[160:163]
    v_mfma_f32_16x16x32_bf16 v[164:167], a[148:151], v[60:63], v[164:167]
    v_mfma_f32_16x16x32_bf16 v[160:163], a[152:155], v[64:67], v[160:163]
    v_mfma_f32_16x16x32_bf16 v[164:167], a[152:155], v[68:71], v[164:167]
    v_mfma_f32_16x16x32_bf16 v[160:163], a[156:159], v[72:75], v[160:163]
    v_mfma_f32_16x16x32_bf16 v[164:167], a[156:159], v[76:79], v[164:167]
    v_mfma_f32_16x16x32_bf16 v[160:163], a[160:163], v[80:83], v[160:163]
    v_mfma_f32_16x16x32_bf16 v[164:167], a[160:163], v[84:87], v[164:167]
    v_mfma_f32_16x16x32_bf16 v[160:163], a[164:167], v[88:91], v[160:163]
    v_mfma_f32_16x16x32_bf16 v[164:167], a[164:167], v[92:95], v[164:167]
    v_mfma_f32_16x16x32_bf16 v[160:163], a[168:171], v[96:99], v[160:163]
    v_mfma_f32_16x16x32_bf16 v[164:167], a[168:171], v[100:103], v[164:167]
    v_mfma_f32_16x16x32_bf16 v[160:163], a[172:175], v[104:107], v[160:163]
    v_mfma_f32_16x16x32_bf16 v[164:167], a[172:175], v[108:111], v[164:167]
    v_mfma_f32_16x16x32_bf16 v[160:163], a[176:179], v[112:115], v[160:163]
    v_mfma_f32_16x16x32_bf16 v[164:167], a[176:179], v[116:119], v[164:167]
    v_mfma_f32_16x16x32_bf16 v[160:163], a[180:183], v[120:123], v[160:163]
    v_mfma_f32_16x16x32_bf16 v[164:167], a[180:183], v[124:127], v[164:167]
    v_mfma_f32_16x16x32_bf16 v[160:163], a[184:187], v[128:131], v[160:163]
    v_mfma_f32_16x16x32_bf16 v[164:167], a[184:187], v[132:135], v[164:167]
    v_mfma_f32_16x16x32_bf16 v[160:163], a[188:191], v[136:139], v[160:163]
    v_mfma_f32_16x16x32_bf16 v[164:167], a[188:191], v[140:143], v[164:167]
    s_nop 7
    v_cvt_pk_bf16_f32 v168, v160, v161
    v_cvt_pk_bf16_f32 v169, v162, v163
    global_store_dwordx2 v3, v[168:169], s[10:11] offset:64
    v_cvt_pk_bf16_f32 v170, v164, v165
    v_cvt_pk_bf16_f32 v171, v166, v167
    global_store_dwordx2 v4, v[170:171], s[10:11] offset:64
    s_waitcnt vmcnt(0)
    v_mfma_f32_16x16x32_bf16 v[160:163], a[192:195], v[16:19], 0
    v_mfma_f32_16x16x32_bf16 v[164:167], a[192:195], v[20:23], 0
    v_mfma_f32_16x16x32_bf16 v[160:163], a[196:199], v[24:27], v[160:163]
    v_mfma_f32_16x16x32_bf16 v[164:167], a[196:199], v[28:31], v[164:167]
    v_mfma_f32_16x16x32_bf16 v[160:163], a[200:203], v[32:35], v[160:163]
    v_mfma_f32_16x16x32_bf16 v[164:167], a[200:203], v[36:39], v[164:167]
    v_mfma_f32_16x16x32_bf16 v[160:163], a[204:207], v[40:43], v[160:163]
    v_mfma_f32_16x16x32_bf16 v[164:167], a[204:207], v[44:47], v[164:167]
    v_mfma_f32_16x16x32_bf16 v[160:163], a[208:211], v[48:51], v[160:163]
    v_mfma_f32_16x16x32_bf16 v[164:167], a[208:211], v[52:55], v[164:167]
    v_mfma_f32_16x16x32_bf16 v[160:163], a[212:215], v[56:59], v[160:163]
    v_mfma_f32_16x16x32_bf16 v[164:167], a[212:215], v[60:63], v[164:167]
    v_mfma_f32_16x16x32_bf16 v[160:163], a[216:219], v[64:67], v[160:163]
    v_mfma_f32_16x16x32_bf16 v[164:167], a[216:219], v[68:71], v[164:167]
    v_mfma_f32_16x16x32_bf16 v[160:163], a[220:223], v[72:75], v[160:163]
    v_mfma_f32_16x16x32_bf16 v[164:167], a[220:223], v[76:79], v[164:167]
    v_mfma_f32_16x16x32_bf16 v[160:163], a[224:227], v[80:83], v[160:163]
    v_mfma_f32_16x16x32_bf16 v[164:167], a[224:227], v[84:87], v[164:167]
    v_mfma_f32_16x16x32_bf16 v[160:163], a[228:231], v[88:91], v[160:163]
    v_mfma_f32_16x16x32_bf16 v[164:167], a[228:231], v[92:95], v[164:167]
    v_mfma_f32_16x16x32_bf16 v[160:163], a[232:235], v[96:99], v[160:163]
    v_mfma_f32_16x16x32_bf16 v[164:167], a[232:235], v[100:103], v[164:167]
    v_mfma_f32_16x16x32_bf16 v[160:163], a[236:239], v[104:107], v[160:163]
    v_mfma_f32_16x16x32_bf16 v[164:167], a[236:239], v[108:111], v[164:167]
    v_mfma_f32_16x16x32_bf16 v[160:163], a[240:243], v[112:115], v[160:163]
    v_mfma_f32_16x16x32_bf16 v[164:167], a[240:243], v[116:119], v[164:167]
    v_mfma_f32_16x16x32_bf16 v[160:163], a[244:247], v[120:123], v[160:163]
    v_mfma_f32_16x16x32_bf16 v[164:167], a[244:247], v[124:127], v[164:167]
    v_mfma_f32_16x16x32_bf16 v[160:163], a[248:251], v[128:131], v[160:163]
    v_mfma_f32_16x16x32_bf16 v[164:167], a[248:251], v[132:135], v[164:167]
    v_mfma_f32_16x16x32_bf16 v[160:163], a[252:255], v[136:139], v[160:163]
    v_mfma_f32_16x16x32_bf16 v[164:167], a[252:255], v[140:143], v[164:167]
    s_nop 7
    v_cvt_pk_bf16_f32 v168, v160, v161
    v_cvt_pk_bf16_f32 v169, v162, v163
    global_store_dwordx2 v3, v[168:169], s[10:11] offset:96
    v_cvt_pk_bf16_f32 v170, v164, v165
    v_cvt_pk_bf16_f32 v171, v166, v167
    global_store_dwordx2 v4, v[170:171], s[10:11] offset:96
    global_load_dwordx4 a[0:3], v5, s[30:31] offset:0
    global_load_dwordx4 a[4:7], v5, s[30:31] offset:1024
    global_load_dwordx4 a[8:11], v5, s[30:31] offset:2048
    global_load_dwordx4 a[12:15], v5, s[30:31] offset:3072
    v_add_u32 v5, 4096, v5
    global_load_dwordx4 a[16:19], v5, s[30:31] offset:0
    global_load_dwordx4 a[20:23], v5, s[30:31] offset:1024
    global_load_dwordx4 a[24:27], v5, s[30:31] offset:2048
    global_load_dwordx4 a[28:31], v5, s[30:31] offset:3072
    v_add_u32 v5, 4096, v5
    global_load_dwordx4 a[32:35], v5, s[30:31] offset:0
    global_load_dwordx4 a[36:39], v5, s[30:31] offset:1024
    global_load_dwordx4 a[40:43], v5, s[30:31] offset:2048
    global_load_dwordx4 a[44:47], v5, s[30:31] offset:3072
    v_add_u32 v5, 4096, v5
    global_load_dwordx4 a[48:51], v5, s[30:31] offset:0
    global_load_dwordx4 a[52:55], v5, s[30:31] offset:1024
    global_load_dwordx4 a[56:59], v5, s[30:31] offset:2048
    global_load_dwordx4 a[60:63], v5, s[30:31] offset:3072
    v_add_u32 v5, 4096, v5
    global_load_dwordx4 a[64:67], v5, s[30:31] offset:0
    global_load_dwordx4 a[68:71], v5, s[30:31] offset:1024
    global_load_dwordx4 a[72:75], v5, s[30:31] offset:2048
    global_load_dwordx4 a[76:79], v5, s[30:31] offset:3072
    v_add_u32 v5, 4096, v5
    global_load_dwordx4 a[80:83], v5, s[30:31] offset:0
    global_load_dwordx4 a[84:87], v5, s[30:31] offset:1024
    global_load_dwordx4 a[88:91], v5, s[30:31] offset:2048
    global_load_dwordx4 a[92:95], v5, s[30:31] offset:3072
    v_add_u32 v5, 4096, v5
    global_load_dwordx4 a[96:99], v5, s[30:31] offset:0
    global_load_dwordx4 a[100:103], v5, s[30:31] offset:1024
    global_load_dwordx4 a[104:107], v5, s[30:31] offset:2048
    global_load_dwordx4 a[108:111], v5, s[30:31] offset:3072
    v_add_u32 v5, 4096, v5
    global_load_dwordx4 a[112:115], v5, s[30:31] offset:0
    global_load_dwordx4 a[116:119], v5, s[30:31] offset:1024
    global_load_dwordx4 a[120:123], v5, s[30:31] offset:2048
    global_load_dwordx4 a[124:127], v5, s[30:31] offset:3072
    v_add_u32 v5, 4096, v5
    global_load_dwordx4 a[128:131], v5, s[30:31] offset:0
    global_load_dwordx4 a[132:135], v5, s[30:31] offset:1024
    global_load_dwordx4 a[136:139], v5, s[30:31] offset:2048
    global_load_dwordx4 a[140:143], v5, s[30:31] offset:3072
    v_add_u32 v5, 4096, v5
    global_load_dwordx4 a[144:147], v5, s[30:31] offset:0
    global_load_dwordx4 a[148:151], v5, s[30:31] offset:1024
    global_load_dwordx4 a[152:155], v5, s[30:31] offset:2048
    global_load_dwordx4 a[156:159], v5, s[30:31] offset:3072
    v_add_u32 v5, 4096, v5
    global_load_dwordx4 a[160:163], v5, s[30:31] offset:0
    global_load_dwordx4 a[164:167], v5, s[30:31] offset:1024
    global_load_dwordx4 a[168:171], v5, s[30:31] offset:2048
    global_load_dwordx4 a[172:175], v5, s[30:31] offset:3072
    v_add_u32 v5, 4096, v5
    global_load_dwordx4 a[176:179], v5, s[30:31] offset:0
    global_load_dwordx4 a[180:183], v5, s[30:31] offset:1024
    global_load_dwordx4 a[184:187], v5, s[30:31] offset:2048
    global_load_dwordx4 a[188:191], v5, s[30:31] offset:3072
    v_add_u32 v5, 4096, v5
    s_waitcnt vmcnt(0)
    v_mfma_f32_16x16x32_bf16 v[160:163], a[0:3], v[16:19], 0
    v_mfma_f32_16x16x32_bf16 v[164:167], a[0:3], v[20:23], 0
    v_mfma_f32_16x16x32_bf16 v[160:163], a[4:7], v[24:27], v[160:163]
    v_mfma_f32_16x16x32_bf16 v[164:167], a[4:7], v[28:31], v[164:167]
    v_mfma_f32_16x16x32_bf16 v[160:163], a[8:11], v[32:35], v[160:163]
    v_mfma_f32_16x16x32_bf16 v[164:167], a[8:11], v[36:39], v[164:167]
    v_mfma_f32_16x16x32_bf16 v[160:163], a[12:15], v[40:43], v[160:163]
    v_mfma_f32_16x16x32_bf16 v[164:167], a[12:15], v[44:47], v[164:167]
    v_mfma_f32_16x16x32_bf16 v[160:163], a[16:19], v[48:51], v[160:163]
    v_mfma_f32_16x16x32_bf16 v[164:167], a[16:19], v[52:55], v[164:167]
    v_mfma_f32_16x16x32_bf16 v[160:163], a[20:23], v[56:59], v[160:163]
    v_mfma_f32_16x16x32_bf16 v[164:167], a[20:23], v[60:63], v[164:167]
    v_mfma_f32_16x16x32_bf16 v[160:163], a[24:27], v[64:67], v[160:163]
    v_mfma_f32_16x16x32_bf16 v[164:167], a[24:27], v[68:71], v[164:167]
    v_mfma_f32_16x16x32_bf16 v[160:163], a[28:31], v[72:75], v[160:163]
    v_mfma_f32_16x16x32_bf16 v[164:167], a[28:31], v[76:79], v[164:167]
    v_mfma_f32_16x16x32_bf16 v[160:163], a[32:35], v[80:83], v[160:163]
    v_mfma_f32_16x16x32_bf16 v[164:167], a[32:35], v[84:87], v[164:167]
    v_mfma_f32_16x16x32_bf16 v[160:163], a[36:39], v[88:91], v[160:163]
    v_mfma_f32_16x16x32_bf16 v[164:167], a[36:39], v[92:95], v[164:167]
    v_mfma_f32_16x16x32_bf16 v[160:163], a[40:43], v[96:99], v[160:163]
    v_mfma_f32_16x16x32_bf16 v[164:167], a[40:43], v[100:103], v[164:167]
    v_mfma_f32_16x16x32_bf16 v[160:163], a[44:47], v[104:107], v[160:163]
    v_mfma_f32_16x16x32_bf16 v[164:167], a[44:47], v[108:111], v[164:167]
    v_mfma_f32_16x16x32_bf16 v[160:163], a[48:51], v[112:115], v[160:163]
    v_mfma_f32_16x16x32_bf16 v[164:167], a[48:51], v[116:119], v[164:167]
    v_mfma_f32_16x16x32_bf16 v[160:163], a[52:55], v[120:123], v[160:163]
    v_mfma_f32_16x16x32_bf16 v[164:167], a[52:55], v[124:127], v[164:167]
    v_mfma_f32_16x16x32_bf16 v[160:163], a[56:59], v[128:131], v[160:163]
    v_mfma_f32_16x16x32_bf16 v[164:167], a[56:59], v[132:135], v[164:167]
    v_mfma_f32_16x16x32_bf16 v[160:163], a[60:63], v[136:139], v[160:163]
    v_mfma_f32_16x16x32_bf16 v[164:167], a[60:63], v[140:143], v[164:167]
    s_nop 7
    v_cvt_pk_bf16_f32 v168, v160, v161
    v_cvt_pk_bf16_f32 v169, v162, v163
    global_store_dwordx2 v3, v[168:169], s[10:11] offset:128
    v_cvt_pk_bf16_f32 v170, v164, v165
    v_cvt_pk_bf16_f32 v171, v166, v167
    global_store_dwordx2 v4, v[170:171], s[10:11] offset:128
    s_waitcnt vmcnt(0)
    v_mfma_f32_16x16x32_bf16 v[160:163], a[64:67], v[16:19], 0
    v_mfma_f32_16x16x32_bf16 v[164:167], a[64:67], v[20:23], 0
    v_mfma_f32_16x16x32_bf16 v[160:163], a[68:71], v[24:27], v[160:163]
    v_mfma_f32_16x16x32_bf16 v[164:167], a[68:71], v[28:31], v[164:167]
    v_mfma_f32_16x16x32_bf16 v[160:163], a[72:75], v[32:35], v[160:163]
    v_mfma_f32_16x16x32_bf16 v[164:167], a[72:75], v[36:39], v[164:167]
    v_mfma_f32_16x16x32_bf16 v[160:163], a[76:79], v[40:43], v[160:163]
    v_mfma_f32_16x16x32_bf16 v[164:167], a[76:79], v[44:47], v[164:167]
    v_mfma_f32_16x16x32_bf16 v[160:163], a[80:83], v[48:51], v[160:163]
    v_mfma_f32_16x16x32_bf16 v[164:167], a[80:83], v[52:55], v[164:167]
    v_mfma_f32_16x16x32_bf16 v[160:163], a[84:87], v[56:59], v[160:163]
    v_mfma_f32_16x16x32_bf16 v[164:167], a[84:87], v[60:63], v[164:167]
    v_mfma_f32_16x16x32_bf16 v[160:163], a[88:91], v[64:67], v[160:163]
    v_mfma_f32_16x16x32_bf16 v[164:167], a[88:91], v[68:71], v[164:167]
    v_mfma_f32_16x16x32_bf16 v[160:163], a[92:95], v[72:75], v[160:163]
    v_mfma_f32_16x16x32_bf16 v[164:167], a[92:95], v[76:79], v[164:167]
    v_mfma_f32_16x16x32_bf16 v[160:163], a[96:99], v[80:83], v[160:163]
    v_mfma_f32_16x16x32_bf16 v[164:167], a[96:99], v[84:87], v[164:167]
    v_mfma_f32_16x16x32_bf16 v[160:163], a[100:103], v[88:91], v[160:163]
    v_mfma_f32_16x16x32_bf16 v[164:167], a[100:103], v[92:95], v[164:167]
    v_mfma_f32_16x16x32_bf16 v[160:163], a[104:107], v[96:99], v[160:163]
    v_mfma_f32_16x16x32_bf16 v[164:167], a[104:107], v[100:103], v[164:167]
    v_mfma_f32_16x16x32_bf16 v[160:163], a[108:111], v[104:107], v[160:163]
    v_mfma_f32_16x16x32_bf16 v[164:167], a[108:111], v[108:111], v[164:167]
    v_mfma_f32_16x16x32_bf16 v[160:163], a[112:115], v[112:115], v[160:163]
    v_mfma_f32_16x16x32_bf16 v[164:167], a[112:115], v[116:119], v[164:167]
    v_mfma_f32_16x16x32_bf16 v[160:163], a[116:119], v[120:123], v[160:163]
    v_mfma_f32_16x16x32_bf16 v[164:167], a[116:119], v[124:127], v[164:167]
    v_mfma_f32_16x16x32_bf16 v[160:163], a[120:123], v[128:131], v[160:163]
    v_mfma_f32_16x16x32_bf16 v[164:167], a[120:123], v[132:135], v[164:167]
    v_mfma_f32_16x16x32_bf16 v[160:163], a[124:127], v[136:139], v[160:163]
    v_mfma_f32_16x16x32_bf16 v[164:167], a[124:127], v[140:143], v[164:167]
    s_nop 7
    v_cvt_pk_bf16_f32 v168, v160, v161
    v_cvt_pk_bf16_f32 v169, v162, v163
    global_store_dwordx2 v3, v[168:169], s[10:11] offset:160
    v_cvt_pk_bf16_f32 v170, v164, v165
    v_cvt_pk_bf16_f32 v171, v166, v167
    global_store_dwordx2 v4, v[170:171], s[10:11] offset:160
    s_waitcnt vmcnt(0)
    v_mfma_f32_16x16x32_bf16 v[160:163], a[128:131], v[16:19], 0
    v_mfma_f32_16x16x32_bf16 v[164:167], a[128:131], v[20:23], 0
    v_mfma_f32_16x16x32_bf16 v[160:163], a[132:135], v[24:27], v[160:163]
    v_mfma_f32_16x16x32_bf16 v[164:167], a[132:135], v[28:31], v[164:167]
    v_mfma_f32_16x16x32_bf16 v[160:163], a[136:139], v[32:35], v[160:163]
    v_mfma_f32_16x16x32_bf16 v[164:167], a[136:139], v[36:39], v[164:167]
    v_mfma_f32_16x16x32_bf16 v[160:163], a[140:143], v[40:43], v[160:163]
    v_mfma_f32_16x16x32_bf16 v[164:167], a[140:143], v[44:47], v[164:167]
    v_mfma_f32_16x16x32_bf16 v[160:163], a[144:147], v[48:51], v[160:163]
    v_mfma_f32_16x16x32_bf16 v[164:167], a[144:147], v[52:55], v[164:167]
    v_mfma_f32_16x16x32_bf16 v[160:163], a[148:151], v[56:59], v[160:163]
    v_mfma_f32_16x16x32_bf16 v[164:167], a[148:151], v[60:63], v[164:167]
    v_mfma_f32_16x16x32_bf16 v[160:163], a[152:155], v[64:67], v[160:163]
    v_mfma_f32_16x16x32_bf16 v[164:167], a[152:155], v[68:71], v[164:167]
    v_mfma_f32_16x16x32_bf16 v[160:163], a[156:159], v[72:75], v[160:163]
    v_mfma_f32_16x16x32_bf16 v[164:167], a[156:159], v[76:79], v[164:167]
    v_mfma_f32_16x16x32_bf16 v[160:163], a[160:163], v[80:83], v[160:163]
    v_mfma_f32_16x16x32_bf16 v[164:167], a[160:163], v[84:87], v[164:167]
    v_mfma_f32_16x16x32_bf16 v[160:163], a[164:167], v[88:91], v[160:163]
    v_mfma_f32_16x16x32_bf16 v[164:167], a[164:167], v[92:95], v[164:167]
    v_mfma_f32_16x16x32_bf16 v[160:163], a[168:171], v[96:99], v[160:163]
    v_mfma_f32_16x16x32_bf16 v[164:167], a[168:171], v[100:103], v[164:167]
    v_mfma_f32_16x16x32_bf16 v[160:163], a[172:175], v[104:107], v[160:163]
    v_mfma_f32_16x16x32_bf16 v[164:167], a[172:175], v[108:111], v[164:167]
    v_mfma_f32_16x16x32_bf16 v[160:163], a[176:179], v[112:115], v[160:163]
    v_mfma_f32_16x16x32_bf16 v[164:167], a[176:179], v[116:119], v[164:167]
    v_mfma_f32_16x16x32_bf16 v[160:163], a[180:183], v[120:123], v[160:163]
    v_mfma_f32_16x16x32_bf16 v[164:167], a[180:183], v[124:127], v[164:167]
    v_mfma_f32_16x16x32_bf16 v[160:163], a[184:187], v[128:131], v[160:163]
    v_mfma_f32_16x16x32_bf16 v[164:167], a[184:187], v[132:135], v[164:167]
    v_mfma_f32_16x16x32_bf16 v[160:163], a[188:191], v[136:139], v[160:163]
    v_mfma_f32_16x16x32_bf16 v[164:167], a[188:191], v[140:143], v[164:167]
    s_nop 7
    v_cvt_pk_bf16_f32 v168, v160, v161
    v_cvt_pk_bf16_f32 v169, v162, v163
    global_store_dwordx2 v3, v[168:169], s[10:11] offset:192
    v_cvt_pk_bf16_f32 v170, v164, v165
    v_cvt_pk_bf16_f32 v171, v166, v167
    global_store_dwordx2 v4, v[170:171], s[10:11] offset:192
    s_branch M_end
G_pr_0:
    s_sub_u32 s15, s15, 1
    s_cbranch_scc1 M_end
    global_load_dwordx4 v[16:19], v3, s[16:17] sc1
    global_load_dwordx4 v[20:23], v4, s[16:17] sc1
    s_branch G_pl_0

G_slowst_0:
    global_store_dword v13, v36, s[18:19] sc1
    s_mov_b64 exec, 0x000f000f
    global_store_dword v14, v37, s[18:19] sc1
    s_branch G_stdone_0

G_pr_1:
    s_sub_u32 s15, s15, 1
    s_cbranch_scc1 M_end
    global_load_dwordx4 v[16:19], v3, s[16:17] sc1
    global_load_dwordx4 v[20:23], v4, s[16:17] sc1
    s_branch G_pl_1

G_slowst_1:
    global_store_dword v13, v36, s[18:19] sc1
    s_mov_b64 exec, 0x000f000f
    global_store_dword v14, v37, s[18:19] sc1
    s_branch G_stdone_1

G_pr_2:
    s_sub_u32 s15, s15, 1
    s_cbranch_scc1 M_end
    global_load_dwordx4 v[16:19], v3, s[16:17] sc1
    global_load_dwordx4 v[20:23], v4, s[16:17] sc1
    s_branch G_pl_2

G_slowst_2:
    global_store_dword v13, v36, s[18:19] sc1
    s_mov_b64 exec, 0x000f000f
    global_store_dword v14, v37, s[18:19] sc1
    s_branch G_stdone_2

G_pr_3:
    s_sub_u32 s15, s15, 1
    s_cbranch_scc1 M_end
    global_load_dwordx4 v[16:19], v3, s[16:17] sc1
    global_load_dwordx4 v[20:23], v4, s[16:17] sc1
    s_branch G_pl_3

G_slowst_3:
    global_store_dword v13, v36, s[18:19] sc1
    s_mov_b64 exec, 0x000f000f
    global_store_dword v14, v37, s[18:19] sc1
    s_branch G_stdone_3

U_fl:
    global_load_dwordx2 v[64:65], v14, s[4:5] sc1
    s_waitcnt vmcnt(0)
    v_lshlrev_b32 v64, 1, v64
    v_lshl_add_u32 v65, v65, 1, 1
    v_min_u32 v64, v64, v65
    s_nop 0
    v_readlane_b32 s28, v64, 0
    v_readlane_b32 s29, v64, 1
    s_min_u32 s22, s28, s29

    v_readlane_b32 s28, v64, 2
    v_readlane_b32 s29, v64, 3
    s_min_u32 s22, s22, s28
    s_min_u32 s22, s22, s29

    s_cmp_gt_u32 s22, s14
    s_cbranch_scc1 U_flok
    s_sub_u32 s15, s15, 1
    s_cbranch_scc1 M_end
    s_branch U_fl

UF_pr:
    s_sub_u32 s15, s15, 1
    s_cbranch_scc1 M_end
    global_load_dwordx4 v[44:47], v3, s[16:17] sc1
    global_load_dwordx4 v[48:51], v4, s[16:17] sc1
    s_branch UF_pl
U_fa:
    global_load_dwordx2 v[64:65], v14, s[4:5] sc1
    s_mov_b32 s23, 1
    s_branch U_fab
Up_ad:
    s_sleep 9
    s_branch Up_adr
Up_R0:
    s_sub_u32 s15, s15, 1
    s_cbranch_scc1 M_end
    s_mov_b32 s91, 1
    s_sleep 1
    global_load_dwordx4 v[16:19], v60, s[18:19] offset:-4096 sc1
    global_load_dwordx4 v[20:23], v60, s[18:19] offset:-3072 sc1
    global_load_dwordx4 v[24:27], v60, s[18:19] offset:-2048 sc1
    global_load_dwordx4 v[28:31], v60, s[18:19] offset:-1024 sc1
    global_load_dwordx4 v[32:35], v60, s[18:19] offset:0 sc1
    global_load_dwordx4 v[36:39], v60, s[18:19] offset:1024 sc1
    global_load_dwordx4 v[40:43], v60, s[18:19] offset:2048 sc1
    global_load_dwordx4 v[104:107], v60, s[18:19] offset:3072 sc1
    global_load_dwordx4 v[108:111], v62, s[18:19] offset:-4096 sc1
    global_load_dwordx4 v[112:115], v62, s[18:19] offset:-3072 sc1
    s_waitcnt vmcnt(7)
    v_max3_u32 v15, v16, v20, v24
    v_cmp_eq_u32 vcc, -1, v15
    s_cbranch_vccnz Up_R0
    s_branch Up_S0
Up_R1:
    s_sub_u32 s15, s15, 1
    s_cbranch_scc1 M_end
    s_mov_b32 s91, 1
    global_load_dwordx4 v[28:31], v60, s[18:19] offset:-1024 sc1
    global_load_dwordx4 v[32:35], v60, s[18:19] offset:0 sc1
    global_load_dwordx4 v[36:39], v60, s[18:19] offset:1024 sc1
    global_load_dwordx4 v[40:43], v60, s[18:19] offset:2048 sc1
    global_load_dwordx4 v[104:107], v60, s[18:19] offset:3072 sc1
    global_load_dwordx4 v[108:111], v62, s[18:19] offset:-4096 sc1
    global_load_dwordx4 v[112:115], v62, s[18:19] offset:-3072 sc1
    s_waitcnt vmcnt(4)
    v_max3_u32 v15, v28, v32, v36
    v_cmp_eq_u32 vcc, -1, v15
    s_cbranch_vccnz Up_R1
    s_branch Up_S1
Up_R2:
    s_sub_u32 s15, s15, 1
    s_cbranch_scc1 M_end
    s_mov_b32 s91, 1
    global_load_dwordx4 v[40:43], v60, s[18:19] offset:2048 sc1
    global_load_dwordx4 v[104:107], v60, s[18:19] offset:3072 sc1
    global_load_dwordx4 v[108:111], v62, s[18:19] offset:-4096 sc1
    global_load_dwordx4 v[112:115], v62, s[18:19] offset:-3072 sc1
    s_waitcnt vmcnt(2)
    v_max_u32 v15, v40, v104
    v_cmp_eq_u32 vcc, -1, v15
    s_cbranch_vccnz Up_R2
    s_branch Up_S2
Up_R3:
    s_sub_u32 s15, s15, 1
    s_cbranch_scc1 M_end
    s_mov_b32 s91, 1
    global_load_dwordx4 v[108:111], v62, s[18:19] offset:-4096 sc1
    global_load_dwordx4 v[112:115], v62, s[18:19] offset:-3072 sc1
    s_waitcnt vmcnt(1)
    v_max_u32 v15, v108, v109
    v_cmp_eq_u32 vcc, -1, v15
    s_cbranch_vccnz Up_R3
    s_branch Up_S3
Up_R4:
    s_sub_u32 s15, s15, 1
    s_cbranch_scc1 M_end
    s_mov_b32 s91, 1
    global_load_dwordx4 v[112:115], v62, s[18:19] offset:-3072 sc1
    s_waitcnt vmcnt(0)
    v_max_u32 v15, v112, v113
    v_cmp_eq_u32 vcc, -1, v15
    s_cbranch_vccnz Up_R4
    s_branch Up_S4
Up_redo:
    s_sub_u32 s15, s15, 1
    s_cbranch_scc1 M_end
    global_load_dwordx4 v[16:19], v60, s[18:19] offset:-4096 sc1
    global_load_dwordx4 v[20:23], v60, s[18:19] offset:-3072 sc1
    global_load_dwordx4 v[24:27], v60, s[18:19] offset:-2048 sc1
    global_load_dwordx4 v[28:31], v60, s[18:19] offset:-1024 sc1
    global_load_dwordx4 v[32:35], v60, s[18:19] offset:0 sc1
    global_load_dwordx4 v[36:39], v60, s[18:19] offset:1024 sc1
    global_load_dwordx4 v[40:43], v60, s[18:19] offset:2048 sc1
    global_load_dwordx4 v[104:107], v60, s[18:19] offset:3072 sc1
    global_load_dwordx4 v[108:111], v62, s[18:19] offset:-4096 sc1
    global_load_dwordx4 v[112:115], v62, s[18:19] offset:-3072 sc1
    v_mov_b32 v124, 0
    v_mov_b32 v125, 0
    v_mov_b32 v126, 0
    v_mov_b32 v127, 0
    s_nop 1
    s_branch Up_C0

U_fu:
    v_lshlrev_b32 v64, 1, v64
    v_lshl_add_u32 v65, v65, 1, 1
    v_min_u32 v64, v64, v65
    s_mov_b32 s23, 0
    v_readlane_b32 s28, v64, 0
    v_readlane_b32 s29, v64, 1
    s_min_u32 s22, s28, s29
    v_readlane_b32 s28, v64, 2
    v_readlane_b32 s29, v64, 3
    s_min_u32 s22, s22, s28
    s_min_u32 s22, s22, s29
    s_branch U_fub

U_last:
    global_store_dword v61, v9, s[40:41] sc1
    s_branch M_end

U_slowst:
    global_store_dword v12, v9, s[38:39] sc1
    global_store_dword v12, v9, s[38:39] sc1
    s_branch U_stdone

UP_pr:
    s_sub_u32 s15, s15, 1
    s_cbranch_scc1 M_end
    global_load_dwordx4 v[8:11], v3, s[16:17] sc1
    global_load_dwordx4 v[12:15], v4, s[16:17] sc1
    s_branch UP_poll
Gxm_R0:
    s_sub_u32 s15, s15, 1
    s_cbranch_scc1 M_end
    global_load_dwordx2 v[72:73], v5, s[16:17] offset:0 sc1
    global_load_dwordx2 v[74:75], v5, s[16:17] offset:256 sc1
    global_load_dwordx2 v[76:77], v5, s[16:17] offset:512 sc1
    global_load_dwordx2 v[78:79], v5, s[16:17] offset:768 sc1
    global_load_dwordx2 v[80:81], v5, s[16:17] offset:1024 sc1
    global_load_dwordx2 v[82:83], v5, s[16:17] offset:1280 sc1
    global_load_dwordx2 v[84:85], v5, s[16:17] offset:1536 sc1
    s_branch Gxm_C0
Gxm_R1:
    s_sub_u32 s15, s15, 1
    s_cbranch_scc1 M_end
    global_load_dwordx2 v[76:77], v5, s[16:17] offset:512 sc1
    global_load_dwordx2 v[78:79], v5, s[16:17] offset:768 sc1
    global_load_dwordx2 v[80:81], v5, s[16:17] offset:1024 sc1
    global_load_dwordx2 v[82:83], v5, s[16:17] offset:1280 sc1
    global_load_dwordx2 v[84:85], v5, s[16:17] offset:1536 sc1
    s_waitcnt vmcnt(3)
    v_max3_u32 v15, v76, v77, v78
    v_max_u32 v15, v15, v79
    v_cmp_eq_u32 vcc, -1, v15
    s_cbranch_vccnz Gxm_R1
    s_branch Gxm_S1
Gxm_R2:
    s_sub_u32 s15, s15, 1
    s_cbranch_scc1 M_end
    global_load_dwordx2 v[80:81], v5, s[16:17] offset:1024 sc1
    global_load_dwordx2 v[82:83], v5, s[16:17] offset:1280 sc1
    global_load_dwordx2 v[84:85], v5, s[16:17] offset:1536 sc1
    s_waitcnt vmcnt(1)
    v_max3_u32 v15, v80, v81, v82
    v_max_u32 v15, v15, v83
    v_cmp_eq_u32 vcc, -1, v15
    s_cbranch_vccnz Gxm_R2
    s_branch Gxm_S2
Gxm_R3:
    s_sub_u32 s15, s15, 1
    s_cbranch_scc1 M_end
    global_load_dwordx2 v[84:85], v5, s[16:17] offset:1536 sc1
    s_waitcnt vmcnt(0)
    v_max3_u32 v15, v84, v85, v86
    v_max_u32 v15, v15, v87
    v_cmp_eq_u32 vcc, -1, v15
    s_cbranch_vccnz Gxm_R3
    s_branch Gxm_S3

X2_fl:
    global_load_dwordx2 v[92:93], v14, s[4:5] sc1
    s_waitcnt vmcnt(0)
    v_lshlrev_b32 v92, 1, v92
    v_lshl_add_u32 v93, v93, 1, 1
    v_min_u32 v92, v92, v93
    s_nop 0
    v_readlane_b32 s28, v92, 0
    v_readlane_b32 s29, v92, 1
    s_min_u32 s22, s28, s29

    s_cmp_gt_u32 s22, s14
    s_cbranch_scc1 X2_flok
    s_sub_u32 s15, s15, 1
    s_cbranch_scc1 M_end
    s_branch X2_fl

Xm_R0:
    s_sub_u32 s15, s15, 1
    s_cbranch_scc1 M_end
    global_load_dwordx4 v[16:19], v3, s[16:17] offset:0 sc1
    global_load_dwordx4 v[20:23], v3, s[16:17] offset:512 sc1
    global_load_dwordx4 v[24:27], v3, s[16:17] offset:1024 sc1
    global_load_dwordx4 v[28:31], v3, s[16:17] offset:1536 sc1
    global_load_dwordx4 v[32:35], v3, s[16:17] offset:2048 sc1
    global_load_dwordx4 v[36:39], v3, s[16:17] offset:2560 sc1
    global_load_dwordx4 v[40:43], v3, s[16:17] offset:3072 sc1
    global_load_dwordx4 v[44:47], v3, s[16:17] offset:3584 sc1
    global_load_dwordx4 v[48:51], v4, s[16:17] offset:0 sc1
    global_load_dwordx4 v[52:55], v4, s[16:17] offset:512 sc1
    global_load_dwordx4 v[56:59], v4, s[16:17] offset:1024 sc1
    global_load_dwordx4 v[60:63], v4, s[16:17] offset:1536 sc1
    global_load_dwordx4 v[64:67], v4, s[16:17] offset:2048 sc1
    global_load_dwordx4 v[68:71], v4, s[16:17] offset:2560 sc1
    global_load_dwordx4 v[176:179], v6, s[18:19] offset:0 sc1
    global_load_dwordx4 v[180:183], v7, s[18:19] offset:0 sc1
    global_load_dwordx4 v[184:187], v8, s[18:19] offset:0 sc1
    global_load_dwordx4 v[188:191], v9, s[18:19] offset:0 sc1
    global_load_dwordx2 v[192:193], v10, s[18:19] offset:0 sc1
    global_load_dwordx2 v[194:195], v10, s[18:19] offset:2560 sc1
    global_load_dwordx4 v[196:199], v6, s[18:19] offset:1024 sc1
    global_load_dwordx4 v[200:203], v7, s[18:19] offset:1024 sc1
    global_load_dwordx4 v[204:207], v8, s[18:19] offset:1024 sc1
    global_load_dwordx4 v[208:211], v9, s[18:19] offset:1024 sc1
    global_load_dwordx2 v[212:213], v10, s[18:19] offset:256 sc1
    global_load_dwordx2 v[214:215], v10, s[18:19] offset:2816 sc1
    s_branch Xm_C0
Xm_R1:
    s_sub_u32 s15, s15, 1
    s_cbranch_scc1 M_end
    global_load_dwordx4 v[20:23], v3, s[16:17] offset:512 sc1
    global_load_dwordx4 v[24:27], v3, s[16:17] offset:1024 sc1
    global_load_dwordx4 v[28:31], v3, s[16:17] offset:1536 sc1
    global_load_dwordx4 v[32:35], v3, s[16:17] offset:2048 sc1
    global_load_dwordx4 v[36:39], v3, s[16:17] offset:2560 sc1
    global_load_dwordx4 v[40:43], v3, s[16:17] offset:3072 sc1
    global_load_dwordx4 v[44:47], v3, s[16:17] offset:3584 sc1
    global_load_dwordx4 v[48:51], v4, s[16:17] offset:0 sc1
    global_load_dwordx4 v[52:55], v4, s[16:17] offset:512 sc1
    global_load_dwordx4 v[56:59], v4, s[16:17] offset:1024 sc1
    global_load_dwordx4 v[60:63], v4, s[16:17] offset:1536 sc1
    global_load_dwordx4 v[64:67], v4, s[16:17] offset:2048 sc1
    global_load_dwordx4 v[68:71], v4, s[16:17] offset:2560 sc1
    global_load_dwordx4 v[176:179], v6, s[18:19] offset:0 sc1
    global_load_dwordx4 v[180:183], v7, s[18:19] offset:0 sc1
    global_load_dwordx4 v[184:187], v8, s[18:19] offset:0 sc1
    global_load_dwordx4 v[188:191], v9, s[18:19] offset:0 sc1
    global_load_dwordx2 v[192:193], v10, s[18:19] offset:0 sc1
    global_load_dwordx2 v[194:195], v10, s[18:19] offset:2560 sc1
    global_load_dwordx4 v[196:199], v6, s[18:19] offset:1024 sc1
    global_load_dwordx4 v[200:203], v7, s[18:19] offset:1024 sc1
    global_load_dwordx4 v[204:207], v8, s[18:19] offset:1024 sc1
    global_load_dwordx4 v[208:211], v9, s[18:19] offset:1024 sc1
    global_load_dwordx2 v[212:213], v10, s[18:19] offset:256 sc1
    global_load_dwordx2 v[214:215], v10, s[18:19] offset:2816 sc1
    s_waitcnt vmcnt(24)
    v_max3_u32 v15, v20, v21, v22
    v_max_u32 v15, v15, v23
    v_cmp_eq_u32 vcc, -1, v15
    s_cbranch_vccnz Xm_R1
    s_branch Xm_S1
Xm_R2:
    s_sub_u32 s15, s15, 1
    s_cbranch_scc1 M_end
    global_load_dwordx4 v[24:27], v3, s[16:17] offset:1024 sc1
    global_load_dwordx4 v[28:31], v3, s[16:17] offset:1536 sc1
    global_load_dwordx4 v[32:35], v3, s[16:17] offset:2048 sc1
    global_load_dwordx4 v[36:39], v3, s[16:17] offset:2560 sc1
    global_load_dwordx4 v[40:43], v3, s[16:17] offset:3072 sc1
    global_load_dwordx4 v[44:47], v3, s[16:17] offset:3584 sc1
    global_load_dwordx4 v[48:51], v4, s[16:17] offset:0 sc1
    global_load_dwordx4 v[52:55], v4, s[16:17] offset:512 sc1
    global_load_dwordx4 v[56:59], v4, s[16:17] offset:1024 sc1
    global_load_dwordx4 v[60:63], v4, s[16:17] offset:1536 sc1
    global_load_dwordx4 v[64:67], v4, s[16:17] offset:2048 sc1
    global_load_dwordx4 v[68:71], v4, s[16:17] offset:2560 sc1
    global_load_dwordx4 v[176:179], v6, s[18:19] offset:0 sc1
    global_load_dwordx4 v[180:183], v7, s[18:19] offset:0 sc1
    global_load_dwordx4 v[184:187], v8, s[18:19] offset:0 sc1
    global_load_dwordx4 v[188:191], v9, s[18:19] offset:0 sc1
    global_load_dwordx2 v[192:193], v10, s[18:19] offset:0 sc1
    global_load_dwordx2 v[194:195], v10, s[18:19] offset:2560 sc1
    global_load_dwordx4 v[196:199], v6, s[18:19] offset:1024 sc1
    global_load_dwordx4 v[200:203], v7, s[18:19] offset:1024 sc1
    global_load_dwordx4 v[204:207], v8, s[18:19] offset:1024 sc1
    global_load_dwordx4 v[208:211], v9, s[18:19] offset:1024 sc1
    global_load_dwordx2 v[212:213], v10, s[18:19] offset:256 sc1
    global_load_dwordx2 v[214:215], v10, s[18:19] offset:2816 sc1
    s_waitcnt vmcnt(23)
    v_max3_u32 v15, v24, v25, v26
    v_max_u32 v15, v15, v27
    v_cmp_eq_u32 vcc, -1, v15
    s_cbranch_vccnz Xm_R2
    s_branch Xm_S2
Xm_R3:
    s_sub_u32 s15, s15, 1
    s_cbranch_scc1 M_end
    global_load_dwordx4 v[28:31], v3, s[16:17] offset:1536 sc1
    global_load_dwordx4 v[32:35], v3, s[16:17] offset:2048 sc1
    global_load_dwordx4 v[36:39], v3, s[16:17] offset:2560 sc1
    global_load_dwordx4 v[40:43], v3, s[16:17] offset:3072 sc1
    global_load_dwordx4 v[44:47], v3, s[16:17] offset:3584 sc1
    global_load_dwordx4 v[48:51], v4, s[16:17] offset:0 sc1
    global_load_dwordx4 v[52:55], v4, s[16:17] offset:512 sc1
    global_load_dwordx4 v[56:59], v4, s[16:17] offset:1024 sc1
    global_load_dwordx4 v[60:63], v4, s[16:17] offset:1536 sc1
    global_load_dwordx4 v[64:67], v4, s[16:17] offset:2048 sc1
    global_load_dwordx4 v[68:71], v4, s[16:17] offset:2560 sc1
    global_load_dwordx4 v[176:179], v6, s[18:19] offset:0 sc1
    global_load_dwordx4 v[180:183], v7, s[18:19] offset:0 sc1
    global_load_dwordx4 v[184:187], v8, s[18:19] offset:0 sc1
    global_load_dwordx4 v[188:191], v9, s[18:19] offset:0 sc1
    global_load_dwordx2 v[192:193], v10, s[18:19] offset:0 sc1
    global_load_dwordx2 v[194:195], v10, s[18:19] offset:2560 sc1
    global_load_dwordx4 v[196:199], v6, s[18:19] offset:1024 sc1
    global_load_dwordx4 v[200:203], v7, s[18:19] offset:1024 sc1
    global_load_dwordx4 v[204:207], v8, s[18:19] offset:1024 sc1
    global_load_dwordx4 v[208:211], v9, s[18:19] offset:1024 sc1
    global_load_dwordx2 v[212:213], v10, s[18:19] offset:256 sc1
    global_load_dwordx2 v[214:215], v10, s[18:19] offset:2816 sc1
    s_waitcnt vmcnt(22)
    v_max3_u32 v15, v28, v29, v30
    v_max_u32 v15, v15, v31
    v_cmp_eq_u32 vcc, -1, v15
    s_cbranch_vccnz Xm_R3
    s_branch Xm_S3
Xm_R4:
    s_sub_u32 s15, s15, 1
    s_cbranch_scc1 M_end
    global_load_dwordx4 v[32:35], v3, s[16:17] offset:2048 sc1
    global_load_dwordx4 v[36:39], v3, s[16:17] offset:2560 sc1
    global_load_dwordx4 v[40:43], v3, s[16:17] offset:3072 sc1
    global_load_dwordx4 v[44:47], v3, s[16:17] offset:3584 sc1
    global_load_dwordx4 v[48:51], v4, s[16:17] offset:0 sc1
    global_load_dwordx4 v[52:55], v4, s[16:17] offset:512 sc1
    global_load_dwordx4 v[56:59], v4, s[16:17] offset:1024 sc1
    global_load_dwordx4 v[60:63], v4, s[16:17] offset:1536 sc1
    global_load_dwordx4 v[64:67], v4, s[16:17] offset:2048 sc1
    global_load_dwordx4 v[68:71], v4, s[16:17] offset:2560 sc1
    global_load_dwordx4 v[176:179], v6, s[18:19] offset:0 sc1
    global_load_dwordx4 v[180:183], v7, s[18:19] offset:0 sc1
    global_load_dwordx4 v[184:187], v8, s[18:19] offset:0 sc1
    global_load_dwordx4 v[188:191], v9, s[18:19] offset:0 sc1
    global_load_dwordx2 v[192:193], v10, s[18:19] offset:0 sc1
    global_load_dwordx2 v[194:195], v10, s[18:19] offset:2560 sc1
    global_load_dwordx4 v[196:199], v6, s[18:19] offset:1024 sc1
    global_load_dwordx4 v[200:203], v7, s[18:19] offset:1024 sc1
    global_load_dwordx4 v[204:207], v8, s[18:19] offset:1024 sc1
    global_load_dwordx4 v[208:211], v9, s[18:19] offset:1024 sc1
    global_load_dwordx2 v[212:213], v10, s[18:19] offset:256 sc1
    global_load_dwordx2 v[214:215], v10, s[18:19] offset:2816 sc1
    s_waitcnt vmcnt(21)
    v_max3_u32 v15, v32, v33, v34
    v_max_u32 v15, v15, v35
    v_cmp_eq_u32 vcc, -1, v15
    s_cbranch_vccnz Xm_R4
    s_branch Xm_S4
Xm_R5:
    s_sub_u32 s15, s15, 1
    s_cbranch_scc1 M_end
    global_load_dwordx4 v[36:39], v3, s[16:17] offset:2560 sc1
    global_load_dwordx4 v[40:43], v3, s[16:17] offset:3072 sc1
    global_load_dwordx4 v[44:47], v3, s[16:17] offset:3584 sc1
    global_load_dwordx4 v[48:51], v4, s[16:17] offset:0 sc1
    global_load_dwordx4 v[52:55], v4, s[16:17] offset:512 sc1
    global_load_dwordx4 v[56:59], v4, s[16:17] offset:1024 sc1
    global_load_dwordx4 v[60:63], v4, s[16:17] offset:1536 sc1
    global_load_dwordx4 v[64:67], v4, s[16:17] offset:2048 sc1
    global_load_dwordx4 v[68:71], v4, s[16:17] offset:2560 sc1
    global_load_dwordx4 v[176:179], v6, s[18:19] offset:0 sc1
    global_load_dwordx4 v[180:183], v7, s[18:19] offset:0 sc1
    global_load_dwordx4 v[184:187], v8, s[18:19] offset:0 sc1
    global_load_dwordx4 v[188:191], v9, s[18:19] offset:0 sc1
    global_load_dwordx2 v[192:193], v10, s[18:19] offset:0 sc1
    global_load_dwordx2 v[194:195], v10, s[18:19] offset:2560 sc1
    global_load_dwordx4 v[196:199], v6, s[18:19] offset:1024 sc1
    global_load_dwordx4 v[200:203], v7, s[18:19] offset:1024 sc1
    global_load_dwordx4 v[204:207], v8, s[18:19] offset:1024 sc1
    global_load_dwordx4 v[208:211], v9, s[18:19] offset:1024 sc1
    global_load_dwordx2 v[212:213], v10, s[18:19] offset:256 sc1
    global_load_dwordx2 v[214:215], v10, s[18:19] offset:2816 sc1
    s_waitcnt vmcnt(20)
    v_max3_u32 v15, v36, v37, v38
    v_max_u32 v15, v15, v39
    v_cmp_eq_u32 vcc, -1, v15
    s_cbranch_vccnz Xm_R5
    s_branch Xm_S5
Xm_R6:
    s_sub_u32 s15, s15, 1
    s_cbranch_scc1 M_end
    global_load_dwordx4 v[40:43], v3, s[16:17] offset:3072 sc1
    global_load_dwordx4 v[44:47], v3, s[16:17] offset:3584 sc1
    global_load_dwordx4 v[48:51], v4, s[16:17] offset:0 sc1
    global_load_dwordx4 v[52:55], v4, s[16:17] offset:512 sc1
    global_load_dwordx4 v[56:59], v4, s[16:17] offset:1024 sc1
    global_load_dwordx4 v[60:63], v4, s[16:17] offset:1536 sc1
    global_load_dwordx4 v[64:67], v4, s[16:17] offset:2048 sc1
    global_load_dwordx4 v[68:71], v4, s[16:17] offset:2560 sc1
    global_load_dwordx4 v[176:179], v6, s[18:19] offset:0 sc1
    global_load_dwordx4 v[180:183], v7, s[18:19] offset:0 sc1
    global_load_dwordx4 v[184:187], v8, s[18:19] offset:0 sc1
    global_load_dwordx4 v[188:191], v9, s[18:19] offset:0 sc1
    global_load_dwordx2 v[192:193], v10, s[18:19] offset:0 sc1
    global_load_dwordx2 v[194:195], v10, s[18:19] offset:2560 sc1
    global_load_dwordx4 v[196:199], v6, s[18:19] offset:1024 sc1
    global_load_dwordx4 v[200:203], v7, s[18:19] offset:1024 sc1
    global_load_dwordx4 v[204:207], v8, s[18:19] offset:1024 sc1
    global_load_dwordx4 v[208:211], v9, s[18:19] offset:1024 sc1
    global_load_dwordx2 v[212:213], v10, s[18:19] offset:256 sc1
    global_load_dwordx2 v[214:215], v10, s[18:19] offset:2816 sc1
    s_waitcnt vmcnt(19)
    v_max3_u32 v15, v40, v41, v42
    v_max_u32 v15, v15, v43
    v_cmp_eq_u32 vcc, -1, v15
    s_cbranch_vccnz Xm_R6
    s_branch Xm_S6
Xm_R7:
    s_sub_u32 s15, s15, 1
    s_cbranch_scc1 M_end
    global_load_dwordx4 v[44:47], v3, s[16:17] offset:3584 sc1
    global_load_dwordx4 v[48:51], v4, s[16:17] offset:0 sc1
    global_load_dwordx4 v[52:55], v4, s[16:17] offset:512 sc1
    global_load_dwordx4 v[56:59], v4, s[16:17] offset:1024 sc1
    global_load_dwordx4 v[60:63], v4, s[16:17] offset:1536 sc1
    global_load_dwordx4 v[64:67], v4, s[16:17] offset:2048 sc1
    global_load_dwordx4 v[68:71], v4, s[16:17] offset:2560 sc1
    global_load_dwordx4 v[176:179], v6, s[18:19] offset:0 sc1
    global_load_dwordx4 v[180:183], v7, s[18:19] offset:0 sc1
    global_load_dwordx4 v[184:187], v8, s[18:19] offset:0 sc1
    global_load_dwordx4 v[188:191], v9, s[18:19] offset:0 sc1
    global_load_dwordx2 v[192:193], v10, s[18:19] offset:0 sc1
    global_load_dwordx2 v[194:195], v10, s[18:19] offset:2560 sc1
    global_load_dwordx4 v[196:199], v6, s[18:19] offset:1024 sc1
    global_load_dwordx4 v[200:203], v7, s[18:19] offset:1024 sc1
    global_load_dwordx4 v[204:207], v8, s[18:19] offset:1024 sc1
    global_load_dwordx4 v[208:211], v9, s[18:19] offset:1024 sc1
    global_load_dwordx2 v[212:213], v10, s[18:19] offset:256 sc1
    global_load_dwordx2 v[214:215], v10, s[18:19] offset:2816 sc1
    s_waitcnt vmcnt(18)
    v_max3_u32 v15, v44, v45, v46
    v_max_u32 v15, v15, v47
    v_cmp_eq_u32 vcc, -1, v15
    s_cbranch_vccnz Xm_R7
    s_branch Xm_S7
Xm_R8:
    s_sub_u32 s15, s15, 1
    s_cbranch_scc1 M_end
    global_load_dwordx4 v[48:51], v4, s[16:17] offset:0 sc1
    global_load_dwordx4 v[52:55], v4, s[16:17] offset:512 sc1
    global_load_dwordx4 v[56:59], v4, s[16:17] offset:1024 sc1
    global_load_dwordx4 v[60:63], v4, s[16:17] offset:1536 sc1
    global_load_dwordx4 v[64:67], v4, s[16:17] offset:2048 sc1
    global_load_dwordx4 v[68:71], v4, s[16:17] offset:2560 sc1
    global_load_dwordx4 v[176:179], v6, s[18:19] offset:0 sc1
    global_load_dwordx4 v[180:183], v7, s[18:19] offset:0 sc1
    global_load_dwordx4 v[184:187], v8, s[18:19] offset:0 sc1
    global_load_dwordx4 v[188:191], v9, s[18:19] offset:0 sc1
    global_load_dwordx2 v[192:193], v10, s[18:19] offset:0 sc1
    global_load_dwordx2 v[194:195], v10, s[18:19] offset:2560 sc1
    global_load_dwordx4 v[196:199], v6, s[18:19] offset:1024 sc1
    global_load_dwordx4 v[200:203], v7, s[18:19] offset:1024 sc1
    global_load_dwordx4 v[204:207], v8, s[18:19] offset:1024 sc1
    global_load_dwordx4 v[208:211], v9, s[18:19] offset:1024 sc1
    global_load_dwordx2 v[212:213], v10, s[18:19] offset:256 sc1
    global_load_dwordx2 v[214:215], v10, s[18:19] offset:2816 sc1
    s_waitcnt vmcnt(17)
    v_max3_u32 v15, v48, v49, v50
    v_max_u32 v15, v15, v51
    v_cmp_eq_u32 vcc, -1, v15
    s_cbranch_vccnz Xm_R8
    s_branch Xm_S8
Xm_R9:
    s_sub_u32 s15, s15, 1
    s_cbranch_scc1 M_end
    global_load_dwordx4 v[52:55], v4, s[16:17] offset:512 sc1
    global_load_dwordx4 v[56:59], v4, s[16:17] offset:1024 sc1
    global_load_dwordx4 v[60:63], v4, s[16:17] offset:1536 sc1
    global_load_dwordx4 v[64:67], v4, s[16:17] offset:2048 sc1
    global_load_dwordx4 v[68:71], v4, s[16:17] offset:2560 sc1
    global_load_dwordx4 v[176:179], v6, s[18:19] offset:0 sc1
    global_load_dwordx4 v[180:183], v7, s[18:19] offset:0 sc1
    global_load_dwordx4 v[184:187], v8, s[18:19] offset:0 sc1
    global_load_dwordx4 v[188:191], v9, s[18:19] offset:0 sc1
    global_load_dwordx2 v[192:193], v10, s[18:19] offset:0 sc1
    global_load_dwordx2 v[194:195], v10, s[18:19] offset:2560 sc1
    global_load_dwordx4 v[196:199], v6, s[18:19] offset:1024 sc1
    global_load_dwordx4 v[200:203], v7, s[18:19] offset:1024 sc1
    global_load_dwordx4 v[204:207], v8, s[18:19] offset:1024 sc1
    global_load_dwordx4 v[208:211], v9, s[18:19] offset:1024 sc1
    global_load_dwordx2 v[212:213], v10, s[18:19] offset:256 sc1
    global_load_dwordx2 v[214:215], v10, s[18:19] offset:2816 sc1
    s_waitcnt vmcnt(16)
    v_max3_u32 v15, v52, v53, v54
    v_max_u32 v15, v15, v55
    v_cmp_eq_u32 vcc, -1, v15
    s_cbranch_vccnz Xm_R9
    s_branch Xm_S9
Xm_R10:
    s_sub_u32 s15, s15, 1
    s_cbranch_scc1 M_end
    global_load_dwordx4 v[56:59], v4, s[16:17] offset:1024 sc1
    global_load_dwordx4 v[60:63], v4, s[16:17] offset:1536 sc1
    global_load_dwordx4 v[64:67], v4, s[16:17] offset:2048 sc1
    global_load_dwordx4 v[68:71], v4, s[16:17] offset:2560 sc1
    global_load_dwordx4 v[176:179], v6, s[18:19] offset:0 sc1
    global_load_dwordx4 v[180:183], v7, s[18:19] offset:0 sc1
    global_load_dwordx4 v[184:187], v8, s[18:19] offset:0 sc1
    global_load_dwordx4 v[188:191], v9, s[18:19] offset:0 sc1
    global_load_dwordx2 v[192:193], v10, s[18:19] offset:0 sc1
    global_load_dwordx2 v[194:195], v10, s[18:19] offset:2560 sc1
    global_load_dwordx4 v[196:199], v6, s[18:19] offset:1024 sc1
    global_load_dwordx4 v[200:203], v7, s[18:19] offset:1024 sc1
    global_load_dwordx4 v[204:207], v8, s[18:19] offset:1024 sc1
    global_load_dwordx4 v[208:211], v9, s[18:19] offset:1024 sc1
    global_load_dwordx2 v[212:213], v10, s[18:19] offset:256 sc1
    global_load_dwordx2 v[214:215], v10, s[18:19] offset:2816 sc1
    s_waitcnt vmcnt(15)
    v_max3_u32 v15, v56, v57, v58
    v_max_u32 v15, v15, v59
    v_cmp_eq_u32 vcc, -1, v15
    s_cbranch_vccnz Xm_R10
    s_branch Xm_S10
Xm_R11:
    s_sub_u32 s15, s15, 1
    s_cbranch_scc1 M_end
    global_load_dwordx4 v[60:63], v4, s[16:17] offset:1536 sc1
    global_load_dwordx4 v[64:67], v4, s[16:17] offset:2048 sc1
    global_load_dwordx4 v[68:71], v4, s[16:17] offset:2560 sc1
    global_load_dwordx4 v[176:179], v6, s[18:19] offset:0 sc1
    global_load_dwordx4 v[180:183], v7, s[18:19] offset:0 sc1
    global_load_dwordx4 v[184:187], v8, s[18:19] offset:0 sc1
    global_load_dwordx4 v[188:191], v9, s[18:19] offset:0 sc1
    global_load_dwordx2 v[192:193], v10, s[18:19] offset:0 sc1
    global_load_dwordx2 v[194:195], v10, s[18:19] offset:2560 sc1
    global_load_dwordx4 v[196:199], v6, s[18:19] offset:1024 sc1
    global_load_dwordx4 v[200:203], v7, s[18:19] offset:1024 sc1
    global_load_dwordx4 v[204:207], v8, s[18:19] offset:1024 sc1
    global_load_dwordx4 v[208:211], v9, s[18:19] offset:1024 sc1
    global_load_dwordx2 v[212:213], v10, s[18:19] offset:256 sc1
    global_load_dwordx2 v[214:215], v10, s[18:19] offset:2816 sc1
    s_waitcnt vmcnt(14)
    v_max3_u32 v15, v60, v61, v62
    v_max_u32 v15, v15, v63
    v_cmp_eq_u32 vcc, -1, v15
    s_cbranch_vccnz Xm_R11
    s_branch Xm_S11
Xm_R12:
    s_sub_u32 s15, s15, 1
    s_cbranch_scc1 M_end
    global_load_dwordx4 v[64:67], v4, s[16:17] offset:2048 sc1
    global_load_dwordx4 v[68:71], v4, s[16:17] offset:2560 sc1
    global_load_dwordx4 v[176:179], v6, s[18:19] offset:0 sc1
    global_load_dwordx4 v[180:183], v7, s[18:19] offset:0 sc1
    global_load_dwordx4 v[184:187], v8, s[18:19] offset:0 sc1
    global_load_dwordx4 v[188:191], v9, s[18:19] offset:0 sc1
    global_load_dwordx2 v[192:193], v10, s[18:19] offset:0 sc1
    global_load_dwordx2 v[194:195], v10, s[18:19] offset:2560 sc1
    global_load_dwordx4 v[196:199], v6, s[18:19] offset:1024 sc1
    global_load_dwordx4 v[200:203], v7, s[18:19] offset:1024 sc1
    global_load_dwordx4 v[204:207], v8, s[18:19] offset:1024 sc1
    global_load_dwordx4 v[208:211], v9, s[18:19] offset:1024 sc1
    global_load_dwordx2 v[212:213], v10, s[18:19] offset:256 sc1
    global_load_dwordx2 v[214:215], v10, s[18:19] offset:2816 sc1
    s_waitcnt vmcnt(13)
    v_max3_u32 v15, v64, v65, v66
    v_max_u32 v15, v15, v67
    v_cmp_eq_u32 vcc, -1, v15
    s_cbranch_vccnz Xm_R12
    s_branch Xm_S12
Xm_R13:
    s_sub_u32 s15, s15, 1
    s_cbranch_scc1 M_end
    global_load_dwordx4 v[68:71], v4, s[16:17] offset:2560 sc1
    global_load_dwordx4 v[176:179], v6, s[18:19] offset:0 sc1
    global_load_dwordx4 v[180:183], v7, s[18:19] offset:0 sc1
    global_load_dwordx4 v[184:187], v8, s[18:19] offset:0 sc1
    global_load_dwordx4 v[188:191], v9, s[18:19] offset:0 sc1
    global_load_dwordx2 v[192:193], v10, s[18:19] offset:0 sc1
    global_load_dwordx2 v[194:195], v10, s[18:19] offset:2560 sc1
    global_load_dwordx4 v[196:199], v6, s[18:19] offset:1024 sc1
    global_load_dwordx4 v[200:203], v7, s[18:19] offset:1024 sc1
    global_load_dwordx4 v[204:207], v8, s[18:19] offset:1024 sc1
    global_load_dwordx4 v[208:211], v9, s[18:19] offset:1024 sc1
    global_load_dwordx2 v[212:213], v10, s[18:19] offset:256 sc1
    global_load_dwordx2 v[214:215], v10, s[18:19] offset:2816 sc1
    s_waitcnt vmcnt(12)
    v_max3_u32 v15, v68, v69, v70
    v_max_u32 v15, v15, v71
    v_cmp_eq_u32 vcc, -1, v15
    s_cbranch_vccnz Xm_R13
    s_branch Xm_S13
Xm_R14:
    s_sub_u32 s15, s15, 1
    s_cbranch_scc1 M_end
    global_load_dwordx4 v[176:179], v6, s[18:19] offset:0 sc1
    global_load_dwordx4 v[180:183], v7, s[18:19] offset:0 sc1
    global_load_dwordx4 v[184:187], v8, s[18:19] offset:0 sc1
    global_load_dwordx4 v[188:191], v9, s[18:19] offset:0 sc1
    global_load_dwordx2 v[192:193], v10, s[18:19] offset:0 sc1
    global_load_dwordx2 v[194:195], v10, s[18:19] offset:2560 sc1
    global_load_dwordx4 v[196:199], v6, s[18:19] offset:1024 sc1
    global_load_dwordx4 v[200:203], v7, s[18:19] offset:1024 sc1
    global_load_dwordx4 v[204:207], v8, s[18:19] offset:1024 sc1
    global_load_dwordx4 v[208:211], v9, s[18:19] offset:1024 sc1
    global_load_dwordx2 v[212:213], v10, s[18:19] offset:256 sc1
    global_load_dwordx2 v[214:215], v10, s[18:19] offset:2816 sc1
    s_waitcnt vmcnt(11)
    v_max3_u32 v15, v176, v177, v178
    v_max_u32 v15, v15, v179
    v_cmp_eq_u32 vcc, -1, v15
    s_cbranch_vccnz Xm_R14
    s_branch Xm_S14
Xm_R15:
    s_sub_u32 s15, s15, 1
    s_cbranch_scc1 M_end
    global_load_dwordx4 v[180:183], v7, s[18:19] offset:0 sc1
    global_load_dwordx4 v[184:187], v8, s[18:19] offset:0 sc1
    global_load_dwordx4 v[188:191], v9, s[18:19] offset:0 sc1
    global_load_dwordx2 v[192:193], v10, s[18:19] offset:0 sc1
    global_load_dwordx2 v[194:195], v10, s[18:19] offset:2560 sc1
    global_load_dwordx4 v[196:199], v6, s[18:19] offset:1024 sc1
    global_load_dwordx4 v[200:203], v7, s[18:19] offset:1024 sc1
    global_load_dwordx4 v[204:207], v8, s[18:19] offset:1024 sc1
    global_load_dwordx4 v[208:211], v9, s[18:19] offset:1024 sc1
    global_load_dwordx2 v[212:213], v10, s[18:19] offset:256 sc1
    global_load_dwordx2 v[214:215], v10, s[18:19] offset:2816 sc1
    s_waitcnt vmcnt(10)
    v_max3_u32 v15, v180, v181, v182
    v_max_u32 v15, v15, v183
    v_cmp_eq_u32 vcc, -1, v15
    s_cbranch_vccnz Xm_R15
    s_branch Xm_S15
Xm_R16:
    s_sub_u32 s15, s15, 1
    s_cbranch_scc1 M_end
    global_load_dwordx4 v[184:187], v8, s[18:19] offset:0 sc1
    global_load_dwordx4 v[188:191], v9, s[18:19] offset:0 sc1
    global_load_dwordx2 v[192:193], v10, s[18:19] offset:0 sc1
    global_load_dwordx2 v[194:195], v10, s[18:19] offset:2560 sc1
    global_load_dwordx4 v[196:199], v6, s[18:19] offset:1024 sc1
    global_load_dwordx4 v[200:203], v7, s[18:19] offset:1024 sc1
    global_load_dwordx4 v[204:207], v8, s[18:19] offset:1024 sc1
    global_load_dwordx4 v[208:211], v9, s[18:19] offset:1024 sc1
    global_load_dwordx2 v[212:213], v10, s[18:19] offset:256 sc1
    global_load_dwordx2 v[214:215], v10, s[18:19] offset:2816 sc1
    s_waitcnt vmcnt(9)
    v_max3_u32 v15, v184, v185, v186
    v_max_u32 v15, v15, v187
    v_cmp_eq_u32 vcc, -1, v15
    s_cbranch_vccnz Xm_R16
    s_branch Xm_S16
Xm_R17:
    s_sub_u32 s15, s15, 1
    s_cbranch_scc1 M_end
    global_load_dwordx4 v[188:191], v9, s[18:19] offset:0 sc1
    global_load_dwordx2 v[192:193], v10, s[18:19] offset:0 sc1
    global_load_dwordx2 v[194:195], v10, s[18:19] offset:2560 sc1
    global_load_dwordx4 v[196:199], v6, s[18:19] offset:1024 sc1
    global_load_dwordx4 v[200:203], v7, s[18:19] offset:1024 sc1
    global_load_dwordx4 v[204:207], v8, s[18:19] offset:1024 sc1
    global_load_dwordx4 v[208:211], v9, s[18:19] offset:1024 sc1
    global_load_dwordx2 v[212:213], v10, s[18:19] offset:256 sc1
    global_load_dwordx2 v[214:215], v10, s[18:19] offset:2816 sc1
    s_waitcnt vmcnt(8)
    v_max3_u32 v15, v188, v189, v190
    v_max_u32 v15, v15, v191
    v_cmp_eq_u32 vcc, -1, v15
    s_cbranch_vccnz Xm_R17
    s_branch Xm_S17
Xm_R18:
    s_sub_u32 s15, s15, 1
    s_cbranch_scc1 M_end
    global_load_dwordx2 v[192:193], v10, s[18:19] offset:0 sc1
    global_load_dwordx2 v[194:195], v10, s[18:19] offset:2560 sc1
    global_load_dwordx4 v[196:199], v6, s[18:19] offset:1024 sc1
    global_load_dwordx4 v[200:203], v7, s[18:19] offset:1024 sc1
    global_load_dwordx4 v[204:207], v8, s[18:19] offset:1024 sc1
    global_load_dwordx4 v[208:211], v9, s[18:19] offset:1024 sc1
    global_load_dwordx2 v[212:213], v10, s[18:19] offset:256 sc1
    global_load_dwordx2 v[214:215], v10, s[18:19] offset:2816 sc1
    s_waitcnt vmcnt(6)
    v_max3_u32 v15, v192, v193, v194
    v_max_u32 v15, v15, v195
    v_cmp_eq_u32 vcc, -1, v15
    s_cbranch_vccnz Xm_R18
    s_branch Xm_S18
Xm_R19:
    s_sub_u32 s15, s15, 1
    s_cbranch_scc1 M_end
    global_load_dwordx4 v[196:199], v6, s[18:19] offset:1024 sc1
    global_load_dwordx4 v[200:203], v7, s[18:19] offset:1024 sc1
    global_load_dwordx4 v[204:207], v8, s[18:19] offset:1024 sc1
    global_load_dwordx4 v[208:211], v9, s[18:19] offset:1024 sc1
    global_load_dwordx2 v[212:213], v10, s[18:19] offset:256 sc1
    global_load_dwordx2 v[214:215], v10, s[18:19] offset:2816 sc1
    s_waitcnt vmcnt(5)
    v_max3_u32 v15, v196, v197, v198
    v_max_u32 v15, v15, v199
    v_cmp_eq_u32 vcc, -1, v15
    s_cbranch_vccnz Xm_R19
    s_branch Xm_S19
Xm_R20:
    s_sub_u32 s15, s15, 1
    s_cbranch_scc1 M_end
    global_load_dwordx4 v[200:203], v7, s[18:19] offset:1024 sc1
    global_load_dwordx4 v[204:207], v8, s[18:19] offset:1024 sc1
    global_load_dwordx4 v[208:211], v9, s[18:19] offset:1024 sc1
    global_load_dwordx2 v[212:213], v10, s[18:19] offset:256 sc1
    global_load_dwordx2 v[214:215], v10, s[18:19] offset:2816 sc1
    s_waitcnt vmcnt(4)
    v_max3_u32 v15, v200, v201, v202
    v_max_u32 v15, v15, v203
    v_cmp_eq_u32 vcc, -1, v15
    s_cbranch_vccnz Xm_R20
    s_branch Xm_S20
Xm_R21:
    s_sub_u32 s15, s15, 1
    s_cbranch_scc1 M_end
    global_load_dwordx4 v[204:207], v8, s[18:19] offset:1024 sc1
    global_load_dwordx4 v[208:211], v9, s[18:19] offset:1024 sc1
    global_load_dwordx2 v[212:213], v10, s[18:19] offset:256 sc1
    global_load_dwordx2 v[214:215], v10, s[18:19] offset:2816 sc1
    s_waitcnt vmcnt(3)
    v_max3_u32 v15, v204, v205, v206
    v_max_u32 v15, v15, v207
    v_cmp_eq_u32 vcc, -1, v15
    s_cbranch_vccnz Xm_R21
    s_branch Xm_S21
Xm_R22:
    s_sub_u32 s15, s15, 1
    s_cbranch_scc1 M_end
    global_load_dwordx4 v[208:211], v9, s[18:19] offset:1024 sc1
    global_load_dwordx2 v[212:213], v10, s[18:19] offset:256 sc1
    global_load_dwordx2 v[214:215], v10, s[18:19] offset:2816 sc1
    s_waitcnt vmcnt(2)
    v_max3_u32 v15, v208, v209, v210
    v_max_u32 v15, v15, v211
    v_cmp_eq_u32 vcc, -1, v15
    s_cbranch_vccnz Xm_R22
    s_branch Xm_S22
Xm_R23:
    s_sub_u32 s15, s15, 1
    s_cbranch_scc1 M_end
    global_load_dwordx2 v[212:213], v10, s[18:19] offset:256 sc1
    global_load_dwordx2 v[214:215], v10, s[18:19] offset:2816 sc1
    s_waitcnt vmcnt(0)
    v_max3_u32 v15, v212, v213, v214
    v_max_u32 v15, v15, v215
    v_cmp_eq_u32 vcc, -1, v15
    s_cbranch_vccnz Xm_R23
    s_branch Xm_S23
.section .rodata,"a"
.p2align 6
.amdhsa_kernel concat_heads__linear_kernel_hedgehog__memory_aug_recurrent_mem_tr__prompt_kernel
  .amdhsa_next_free_vgpr 512
  .amdhsa_next_free_sgpr 102
  .amdhsa_accum_offset 256
  .amdhsa_group_segment_fixed_size 0
  .amdhsa_kernarg_size 112
  .amdhsa_user_sgpr_count 2
  .amdhsa_user_sgpr_kernarg_segment_ptr 1
  .amdhsa_system_sgpr_workgroup_id_x 1
.end_amdhsa_kernel
```
